```python
import torch

def _softmax(x, axis=-1):
    return torch.softmax(x, dim=axis)

def _gelu(x):
    return torch.nn.functional.gelu(x, approximate='tanh')

def _silu(x):
    return torch.nn.functional.silu(x)

def _sigmoid(x):
    return torch.sigmoid(x)

def _layernorm(x, axis=-1, eps=1e-05):
    m = x.mean(dim=axis, keepdim=True)
    v = x.var(dim=axis, keepdim=True, unbiased=False)
    return (x - m) / torch.sqrt(v + eps)

def _scatter_add(tgt, idx, src, axis=0):
    return tgt.clone().index_add_(axis, idx, src)

def _segment_sum(src, seg, n):
    out = torch.zeros((n,) + src.shape[1:], dtype=src.dtype)
    return out.index_add_(0, seg, src)

def _pad(x, pw):
    flat = tuple((v for pair in reversed(pw) for v in pair))
    return torch.nn.functional.pad(x, flat)
kernel_name = 'adaLN_cond__sliding_block__glu_gated_reglu__prompt'

def setup_inputs():

    _w = lambda a: (lambda t: t.to(torch.bfloat16) if t.is_floating_point() else t)(torch.as_tensor(a))

    def _A_setup():
        B, S, D = (1, 2048, 448)
        return {'x': _w((lambda *s: torch.randn(*s, dtype=torch.bfloat16) * 0.05)(B, S, D)), 'wqkv': _w((lambda *s: torch.randn(*s, dtype=torch.bfloat16) * 0.05)(D, 3 * D)), 'wo': _w((lambda *s: torch.randn(*s, dtype=torch.bfloat16) * 0.05)(D, D))}
    _A_in = _A_setup()

    def _B_setup():
        B, S, D, F = (1, 2048, 448, 1792)
        return {'x': _w((lambda *s: torch.randn(*s, dtype=torch.bfloat16) * 0.05)(B, S, D)), 'W_gate': _w((lambda *s: torch.randn(*s, dtype=torch.bfloat16) * 0.8)(D, F) * (2.0 / D) ** 0.5), 'W_up': _w((lambda *s: torch.randn(*s, dtype=torch.bfloat16) * 0.8)(D, F) * (2.0 / D) ** 0.5), 'W_down': _w((lambda *s: torch.randn(*s, dtype=torch.bfloat16) * 0.8)(F, D) * (1.0 / F) ** 0.5)}
    _B_in = _B_setup()
    return {'A_x': _A_in['x'], 'A_wqkv': _A_in['wqkv'], 'A_wo': _A_in['wo'], 'B_x': _B_in['x'], 'B_W_gate': _B_in['W_gate'], 'B_W_up': _B_in['W_up'], 'B_W_down': _B_in['W_down'], 'c': _w((lambda *s: torch.randn(*s, dtype=torch.bfloat16) * 0.1)(1, 448) * 8.0), 'w_mod': _w((lambda *s: torch.randn(*s, dtype=torch.bfloat16) * 0.1)(448, 6 * 448) * 448 ** (-0.5) * 8.0)}

def reference(A_x, A_wqkv, A_wo, B_x, B_W_gate, B_W_up, B_W_down, c, w_mod):

    def _A_ref(x, wqkv, wo):
        B, S, D = x.shape
        H = 16
        Dh = D // H
        W = 256
        qkv = (lambda x, *d: x.permute(*d))((x @ wqkv).reshape(B, S, 3, H, Dh), 2, 0, 3, 1, 4)
        q, k, v = (qkv[0], qkv[1], qkv[2])
        scores = torch.einsum('bhqd,bhkd->bhqk', q, k) * Dh ** (-0.5)
        idx = torch.arange(S)
        mask = (idx[:, None] - idx[None, :] >= 0) & (idx[:, None] - idx[None, :] < W)
        scores = torch.where(mask[None, None], scores, -1000000000.0)
        p = _softmax(scores, axis=-1)
        o = torch.einsum('bhqk,bhkd->bhqd', p, v)
        return (lambda x, *d: x.permute(*d))(o, 0, 2, 1, 3).reshape(B, S, D) @ wo

    def _B_ref(x, W_gate, W_up, W_down):
        gate = torch.einsum('bsd,df->bsf', x, W_gate)
        up = torch.einsum('bsd,df->bsf', x, W_up)
        gate = gate * (lambda x, dt: x.to(dt))(gate > 0, gate.dtype)
        h = gate * up
        return torch.einsum('bsf,fd->bsd', h, W_down)
    x = A_x
    mod = (_silu(c) @ w_mod).reshape(c.shape[0], 6, 1, -1)
    sa, ca, ga, sb, cb, gb = (mod[:, 0].clone(), mod[:, 1].clone(), mod[:, 2].clone(), mod[:, 3].clone(), mod[:, 4].clone(), mod[:, 5].clone())
    h = _layernorm(x, axis=-1) * (1 + ca) + sa
    x = x + ga * _A_ref(h, A_wqkv, A_wo)
    h = _layernorm(x, axis=-1) * (1 + cb) + sb
    x = x + gb * _B_ref(h, B_W_gate, B_W_up, B_W_down)
    return x
```

```asm
; @launch grid=(256,1,1) block=(256,1,1) lds=163840
.amdgcn_target "amdgcn-amd-amdhsa--gfx950"
.text
.globl adaLN_cond__sliding_block__glu_gated_reglu__prompt_kernel
.p2align 8
.type adaLN_cond__sliding_block__glu_gated_reglu__prompt_kernel,@function
adaLN_cond__sliding_block__glu_gated_reglu__prompt_kernel:
    s_cmp_ge_u32 s2, 256
    s_cbranch_scc1 L_end
    s_load_dwordx16 s[64:79], s[0:1], 0
    s_load_dwordx8 s[80:87], s[0:1], 64
    s_getpc_b64 s[88:89]
L_pc:
    s_lshr_b32 s49, s2, 3
    s_add_u32 s49, s49, 28
    s_and_b32 s49, s49, 31
    s_mul_i32 s56, s49, 12
    s_cmp_ge_u32 s49, 28
    s_cselect_b32 s57, (L_helper-L_pc)/128, 0
    v_min_u32 v4, 11, v0
    v_add_u32 v4, s56, v4
    v_and_b32 v5, 63, v0
    v_add_u32 v5, s57, v5
    v_cmp_gt_u32 vcc, 64, v0
    s_nop 1
    v_cndmask_b32 v4, v5, v4, vcc
    v_lshlrev_b32 v4, 7, v4
    v_min_u32 v4, L_end-L_pc, v4
    v_cmp_gt_u32 vcc, 128, v0
    s_nop 0
    s_and_saveexec_b64 s[90:91], vcc
    s_cbranch_execz L_nopf
    global_load_dword v127, v4, s[88:89]
L_nopf:
    s_mov_b64 exec, -1
    v_lshrrev_b32 v4, 6, v0
    v_and_b32 v0, 63, v0
    v_readfirstlane_b32 s50, v4
    v_lshlrev_b32 v1, 4, v0
    s_and_b32 s48, s2, 7
    s_lshr_b32 s51, s49, 1
    s_sub_u32 s56, s49, 28
    s_lshl_b32 s56, s56, 3
    s_add_u32 s56, s56, s48
    s_min_u32 s56, s56, 27
    s_cmp_lt_u32 s49, 28
    s_cselect_b32 s98, s49, s56
    s_and_b32 s52, s49, 1
    s_lshl_b32 s53, s48, 1
    s_add_u32 s53, s53, s52
    s_lshl_b32 s53, s53, 2
    s_add_u32 s53, s53, s50
    s_mul_i32 s61, s49, 37
    s_lshr_b32 s61, s61, 8
    s_mul_i32 s56, s61, 7
    s_sub_u32 s62, s49, s56
    s_cmp_eq_u32 s51, 15
    s_cselect_b32 s3, 8, 0
    s_mov_b32 s96, 0
    s_mov_b32 s97, -1
    s_mov_b32 s6, 1835008
    s_mov_b32 s7, 0x00020000
    s_mov_b32 s10, 1204224
    s_mov_b32 s11, 0x00020000
    s_mov_b32 s14, 401408
    s_mov_b32 s15, 0x00020000
    s_mov_b32 s18, 1605632
    s_mov_b32 s19, 0x00020000
    s_mov_b32 s22, 1605632
    s_mov_b32 s23, 0x00020000
    s_mov_b32 s26, 1605632
    s_mov_b32 s27, 0x00020000
    s_mov_b32 s30, 896
    s_mov_b32 s31, 0x00020000
    s_mov_b32 s34, 2408448
    s_mov_b32 s35, 0x00020000
    s_mov_b32 s38, 1835008
    s_mov_b32 s39, 0x00020000
    s_mov_b32 s46, 18874368
    s_mov_b32 s47, 0x00020000
    s_waitcnt lgkmcnt(0)
    s_mov_b64 s[44:45], s[86:87]
    s_mov_b64 s[28:29], s[78:79]
    s_mov_b64 s[32:33], s[80:81]
    s_mov_b64 s[4:5], s[64:65]
    s_mov_b64 s[8:9], s[66:67]
    s_mov_b64 s[12:13], s[68:69]
    s_mov_b64 s[16:17], s[72:73]
    s_mov_b64 s[20:21], s[74:75]
    s_mov_b64 s[24:25], s[76:77]
    s_mov_b64 s[36:37], s[82:83]
    buffer_load_dword v3, off, s[44:47], 0 sc1
    s_cmp_ge_u32 s49, 28
    s_cbranch_scc1 L_helper
    s_mov_b32 s88, 0x3020100
    s_mov_b32 s89, 0x504ff10
    s_mov_b32 s90, 0x706ff11
    s_mov_b32 s91, 0x908ff12
    s_bitcmp1_b32 s49, 3
    s_cselect_b64 s[92:93], s[90:91], s[88:89]
    s_mov_b32 s88, 0xff130b0a
    s_mov_b32 s89, 0xff140d0c
    s_mov_b32 s90, 0xffff0f0e
    s_mov_b32 s91, 0xffffffff
    s_bitcmp1_b32 s49, 3
    s_cselect_b64 s[94:95], s[90:91], s[88:89]
    s_bitcmp1_b32 s49, 4
    s_cselect_b64 s[92:93], s[94:95], s[92:93]
    s_and_b32 s56, s49, 7
    s_lshl_b32 s56, s56, 3
    s_lshr_b64 s[92:93], s[92:93], s56
    s_and_b32 s93, s92, 255
    s_cmp_ge_u32 s93, 21
    s_cbranch_scc1 L_nomod1
    v_lshrrev_b32 v4, 4, v0
    v_and_b32 v5, 15, v0
    s_and_b32 s56, s48, 3
    s_mul_i32 s56, s56, 112
    s_mul_i32 s57, s50, 28
    s_add_u32 s56, s56, s57
    v_lshl_add_u32 v6, v5, 2, v4
    v_add_u32 v6, s56, v6
    v_lshlrev_b32 v6, 1, v6
    v_mul_u32_u24 v7, 5376, v4
    v_lshl_add_u32 v7, v5, 3, v7
    s_lshr_b32 s57, s48, 2
    s_lshl_b32 s58, s93, 1
    s_add_u32 s57, s57, s58
    s_mul_i32 s56, s56, 5376
    s_lshl_b32 s58, s57, 7
    s_add_u32 s56, s56, s58
    buffer_load_dwordx2 v[18:19], v7, s[32:35], s56 offen
    s_add_u32 s56, s56, 21504
    buffer_load_dwordx2 v[20:21], v7, s[32:35], s56 offen
    s_add_u32 s56, s56, 21504
    buffer_load_dwordx2 v[22:23], v7, s[32:35], s56 offen
    s_add_u32 s56, s56, 21504
    buffer_load_dwordx2 v[24:25], v7, s[32:35], s56 offen
    s_add_u32 s56, s56, 21504
    buffer_load_dwordx2 v[26:27], v7, s[32:35], s56 offen
    s_add_u32 s56, s56, 21504
    buffer_load_dwordx2 v[28:29], v7, s[32:35], s56 offen
    s_add_u32 s56, s56, 21504
    buffer_load_dwordx2 v[30:31], v7, s[32:35], s56 offen
    buffer_load_ushort v16, v6, s[28:31], 0 offen
L_nomod1:
    s_lshl_b32 s95, s49, 3
    s_add_u32 s95, s95, s48
    s_lshl_b32 s95, s95, 2
    s_add_u32 s95, s95, s50
    s_lshl_b32 s56, s49, 2
    s_add_u32 s56, s56, s50
    s_mul_i32 s56, s56, 16
    v_add_u32 v6, s56, v0
    v_min_u32 v6, 1791, v6
    v_lshlrev_b32 v6, 7, v6
    s_mul_i32 s56, s48, 229376
    s_add_u32 s56, s56, 0
    s_mov_b64 exec, 0xffff
    buffer_load_dword v127, v6, s[4:7], s56 offen
    s_mov_b64 exec, -1
    s_lshl_b32 s56, s49, 2
    s_add_u32 s56, s56, s50
    s_mul_i32 s56, s56, 16
    v_add_u32 v6, s56, v0
    v_min_u32 v6, 1791, v6
    v_lshlrev_b32 v6, 7, v6
    s_mul_i32 s56, s48, 229376
    s_add_u32 s56, s56, 1114112
    s_mov_b64 exec, 0xffff
    buffer_load_dword v127, v6, s[44:47], s56 offen sc1
    s_mov_b64 exec, -1
    v_lshrrev_b32 v10, 2, v0
    v_mul_u32_u24 v10, 2688, v10
    v_and_b32 v6, 3, v0
    v_lshl_add_u32 v10, v6, 4, v10
    v_lshrrev_b32 v6, 3, v0
    v_and_b32 v7, 7, v0
    v_and_b32 v8, 2, v6
    v_lshlrev_b32 v8, 1, v8
    v_xor_b32 v8, v8, v7
    v_lshlrev_b32 v8, 4, v8
    v_mul_u32_u24 v11, 2688, v6
    v_add_u32 v11, v11, v8
    v_mul_u32_u24 v12, 3584, v6
    v_add_u32 v12, v12, v8
    v_mul_u32_u24 v13, 896, v6
    v_add_u32 v14, v13, v8
    v_and_b32 v8, 6, v6
    v_xor_b32 v8, v8, v7
    v_lshl_add_u32 v13, v8, 4, v13
    s_lshl_b32 s99, s98, 7
    s_mul_i32 s56, s50, 28672
    s_add_u32 s99, s99, s56
    s_lshl_b32 s101, s50, 10
    s_mul_i32 s92, s51, 56
    s_sub_u32 s92, s92, s3
    s_mul_i32 s56, s50, 43008
    s_add_u32 s92, s92, s56
    s_mul_i32 s56, s49, 37
    s_lshr_b32 s56, s56, 8
    s_mul_i32 s56, s56, 7
    s_sub_u32 s94, s49, s56
    s_lshl_b32 s90, s51, 7
    s_add_u32 s90, s90, 896
    s_mul_i32 s56, s50, 21504
    s_add_u32 s90, s90, s56
    s_mul_i32 s91, s52, 7
    s_cmp_ge_u32 s93, 21
    s_cbranch_scc1 L_plainw
    s_mul_i32 s56, s91, 86016
    s_add_u32 s56, s56, s90
    s_lshl_b32 s57, s91, 12
    s_add_u32 s57, s57, s101
    s_add_u32 m0, s57, 3584
    s_add_u32 s91, s91, 1
    buffer_load_dwordx4 v11, s[8:11], s56 offen lds
    s_cmp_eq_u32 s91, 14
    s_cselect_b32 s91, 0, s91
    s_mul_i32 s56, s91, 86016
    s_add_u32 s56, s56, s90
    s_lshl_b32 s57, s91, 12
    s_add_u32 s57, s57, s101
    s_add_u32 m0, s57, 3584
    s_add_u32 s91, s91, 1
    buffer_load_dwordx4 v11, s[8:11], s56 offen lds
    s_cmp_eq_u32 s91, 14
    s_cselect_b32 s91, 0, s91
    s_mul_i32 s56, s91, 86016
    s_add_u32 s56, s56, s90
    s_lshl_b32 s57, s91, 12
    s_add_u32 s57, s57, s101
    s_add_u32 m0, s57, 3584
    s_add_u32 s91, s91, 1
    buffer_load_dwordx4 v11, s[8:11], s56 offen lds
    s_cmp_eq_u32 s91, 14
    s_cselect_b32 s91, 0, s91
    s_mul_i32 s56, s91, 86016
    s_add_u32 s56, s56, s90
    s_lshl_b32 s57, s91, 12
    s_add_u32 s57, s57, s101
    s_add_u32 m0, s57, 3584
    s_add_u32 s91, s91, 1
    buffer_load_dwordx4 v11, s[8:11], s56 offen lds
    s_cmp_eq_u32 s91, 14
    s_cselect_b32 s91, 0, s91
    s_waitcnt vmcnt(6)
    v_readfirstlane_b32 s54, v3
    s_nop 0
    s_mul_i32 s54, s54, 1664525
    s_add_u32 s54, s54, 1013904223
    s_cmp_lg_u32 s50, 3
    s_cbranch_scc1 L_noxcc_1
    s_getreg_b32 s56, hwreg(HW_REG_XCC_ID, 0, 4)
    v_mov_b32 v60, s54
    v_mov_b32 v61, s56
    s_lshl_b32 s56, s48, 5
    s_add_u32 s56, s56, s49
    s_lshl_b32 s56, s56, 7
    s_add_u32 s56, s56, 655360
    s_mov_b64 exec, 1
    buffer_store_dwordx2 v[60:61], off, s[44:47], s56 sc1
    s_mov_b64 exec, -1
L_noxcc_1:
    v_lshlrev_b32 v16, 16, v16
    v_mul_f32 v17, 0xbfb8aa3b, v16
    v_exp_f32 v17, v17
    s_nop 0
    v_add_f32 v17, 1.0, v17
    v_rcp_f32 v17, v17
    s_nop 0
    v_mul_f32 v16, v16, v17
    v_cvt_pk_bf16_f32 v16, v16, v16
    v_lshlrev_b32 v16, 16, v16
    v_mov_b32 v80, 0
    v_mov_b32 v81, 0
    v_mov_b32 v82, 0
    v_mov_b32 v83, 0
    v_lshlrev_b32 v84, 16, v18
    v_and_b32 v85, 0xffff0000, v18
    v_lshlrev_b32 v86, 16, v19
    v_and_b32 v87, 0xffff0000, v19
    v_fmac_f32_dpp v80, v16, v84 row_newbcast:0 row_mask:0xf bank_mask:0xf
    v_fmac_f32_dpp v81, v16, v85 row_newbcast:0 row_mask:0xf bank_mask:0xf
    v_fmac_f32_dpp v82, v16, v86 row_newbcast:0 row_mask:0xf bank_mask:0xf
    v_fmac_f32_dpp v83, v16, v87 row_newbcast:0 row_mask:0xf bank_mask:0xf
    v_lshlrev_b32 v84, 16, v20
    v_and_b32 v85, 0xffff0000, v20
    v_lshlrev_b32 v86, 16, v21
    v_and_b32 v87, 0xffff0000, v21
    v_fmac_f32_dpp v80, v16, v84 row_newbcast:1 row_mask:0xf bank_mask:0xf
    v_fmac_f32_dpp v81, v16, v85 row_newbcast:1 row_mask:0xf bank_mask:0xf
    v_fmac_f32_dpp v82, v16, v86 row_newbcast:1 row_mask:0xf bank_mask:0xf
    v_fmac_f32_dpp v83, v16, v87 row_newbcast:1 row_mask:0xf bank_mask:0xf
    v_lshlrev_b32 v84, 16, v22
    v_and_b32 v85, 0xffff0000, v22
    v_lshlrev_b32 v86, 16, v23
    v_and_b32 v87, 0xffff0000, v23
    v_fmac_f32_dpp v80, v16, v84 row_newbcast:2 row_mask:0xf bank_mask:0xf
    v_fmac_f32_dpp v81, v16, v85 row_newbcast:2 row_mask:0xf bank_mask:0xf
    v_fmac_f32_dpp v82, v16, v86 row_newbcast:2 row_mask:0xf bank_mask:0xf
    v_fmac_f32_dpp v83, v16, v87 row_newbcast:2 row_mask:0xf bank_mask:0xf
    v_lshlrev_b32 v84, 16, v24
    v_and_b32 v85, 0xffff0000, v24
    v_lshlrev_b32 v86, 16, v25
    v_and_b32 v87, 0xffff0000, v25
    v_fmac_f32_dpp v80, v16, v84 row_newbcast:3 row_mask:0xf bank_mask:0xf
    v_fmac_f32_dpp v81, v16, v85 row_newbcast:3 row_mask:0xf bank_mask:0xf
    v_fmac_f32_dpp v82, v16, v86 row_newbcast:3 row_mask:0xf bank_mask:0xf
    v_fmac_f32_dpp v83, v16, v87 row_newbcast:3 row_mask:0xf bank_mask:0xf
    v_lshlrev_b32 v84, 16, v26
    v_and_b32 v85, 0xffff0000, v26
    v_lshlrev_b32 v86, 16, v27
    v_and_b32 v87, 0xffff0000, v27
    v_fmac_f32_dpp v80, v16, v84 row_newbcast:4 row_mask:0xf bank_mask:0xf
    v_fmac_f32_dpp v81, v16, v85 row_newbcast:4 row_mask:0xf bank_mask:0xf
    v_fmac_f32_dpp v82, v16, v86 row_newbcast:4 row_mask:0xf bank_mask:0xf
    v_fmac_f32_dpp v83, v16, v87 row_newbcast:4 row_mask:0xf bank_mask:0xf
    v_lshlrev_b32 v84, 16, v28
    v_and_b32 v85, 0xffff0000, v28
    v_lshlrev_b32 v86, 16, v29
    v_and_b32 v87, 0xffff0000, v29
    v_fmac_f32_dpp v80, v16, v84 row_newbcast:5 row_mask:0xf bank_mask:0xf
    v_fmac_f32_dpp v81, v16, v85 row_newbcast:5 row_mask:0xf bank_mask:0xf
    v_fmac_f32_dpp v82, v16, v86 row_newbcast:5 row_mask:0xf bank_mask:0xf
    v_fmac_f32_dpp v83, v16, v87 row_newbcast:5 row_mask:0xf bank_mask:0xf
    v_lshlrev_b32 v84, 16, v30
    v_and_b32 v85, 0xffff0000, v30
    v_lshlrev_b32 v86, 16, v31
    v_and_b32 v87, 0xffff0000, v31
    v_fmac_f32_dpp v80, v16, v84 row_newbcast:6 row_mask:0xf bank_mask:0xf
    v_fmac_f32_dpp v81, v16, v85 row_newbcast:6 row_mask:0xf bank_mask:0xf
    v_fmac_f32_dpp v82, v16, v86 row_newbcast:6 row_mask:0xf bank_mask:0xf
    v_fmac_f32_dpp v83, v16, v87 row_newbcast:6 row_mask:0xf bank_mask:0xf
    v_permlane16_swap_b32 v80, v81
    s_nop 0
    v_permlane16_swap_b32 v82, v83
    v_add_f32 v80, v80, v81
    v_add_f32 v82, v82, v83
    s_nop 1
    v_permlane32_swap_b32 v80, v82
    v_add_f32 v80, v80, v82
    v_lshrrev_b32 v4, 4, v0
    v_and_b32 v5, 15, v0
    v_lshl_add_u32 v6, v5, 2, v4
    s_lshl_b32 s56, s50, 8
    v_lshl_add_u32 v6, v6, 2, s56
    ds_write_b32 v6, v80 offset:2560
    s_waitcnt lgkmcnt(0)
    s_barrier
    s_cmp_lg_u32 s50, 0
    s_cbranch_scc1 L_nomod2
    s_mov_b64 exec, 0xffff
    ds_read_b128 v[80:83], v1 offset:2560
    ds_read_b128 v[84:87], v1 offset:2816
    ds_read_b128 v[88:91], v1 offset:3072
    ds_read_b128 v[92:95], v1 offset:3328
    s_and_b32 s56, s48, 3
    s_mul_i32 s56, s56, 10752
    s_lshr_b32 s57, s48, 2
    s_lshl_b32 s60, s93, 1
    s_add_u32 s57, s57, s60
    s_lshl_b32 s57, s57, 8
    s_add_u32 s56, s56, s57
    s_add_u32 s56, s56, 65536
    v_mov_b32 v6, 0xff
    s_waitcnt lgkmcnt(0)
    v_add_f32 v80, v80, v84
    v_add_f32 v88, v88, v92
    v_add_f32 v81, v81, v85
    v_add_f32 v89, v89, v93
    v_add_f32 v82, v82, v86
    v_add_f32 v90, v90, v94
    v_add_f32 v83, v83, v87
    v_add_f32 v91, v91, v95
    v_add_f32 v80, v80, v88
    s_lshr_b32 s57, s54, 0
    v_bfi_b32 v80, v6, s57, v80
    v_add_f32 v81, v81, v89
    s_lshr_b32 s57, s54, 8
    v_bfi_b32 v81, v6, s57, v81
    v_add_f32 v82, v82, v90
    s_lshr_b32 s57, s54, 16
    v_bfi_b32 v82, v6, s57, v82
    v_add_f32 v83, v83, v91
    s_lshr_b32 s57, s54, 24
    v_bfi_b32 v83, v6, s57, v83
    buffer_store_dwordx4 v[80:83], v1, s[44:47], s56 offen sc1
    s_mov_b64 exec, -1
L_nomod2:
    s_mul_i32 s56, s91, 86016
    s_add_u32 s56, s56, s90
    s_lshl_b32 s57, s91, 12
    s_add_u32 s57, s57, s101
    s_add_u32 m0, s57, 3584
    s_add_u32 s91, s91, 1
    buffer_load_dwordx4 v11, s[8:11], s56 offen lds
    s_cmp_eq_u32 s91, 14
    s_cselect_b32 s91, 0, s91
    s_mul_i32 s56, s91, 86016
    s_add_u32 s56, s56, s90
    s_lshl_b32 s57, s91, 12
    s_add_u32 s57, s57, s101
    s_add_u32 m0, s57, 3584
    s_add_u32 s91, s91, 1
    buffer_load_dwordx4 v11, s[8:11], s56 offen lds
    s_cmp_eq_u32 s91, 14
    s_cselect_b32 s91, 0, s91
    s_mul_i32 s56, s91, 86016
    s_add_u32 s56, s56, s90
    s_lshl_b32 s57, s91, 12
    s_add_u32 s57, s57, s101
    s_add_u32 m0, s57, 3584
    s_add_u32 s91, s91, 1
    buffer_load_dwordx4 v11, s[8:11], s56 offen lds
    s_cmp_eq_u32 s91, 14
    s_cselect_b32 s91, 0, s91
    s_mul_i32 s56, s91, 86016
    s_add_u32 s56, s56, s90
    s_lshl_b32 s57, s91, 12
    s_add_u32 s57, s57, s101
    s_add_u32 m0, s57, 3584
    s_add_u32 s91, s91, 1
    buffer_load_dwordx4 v11, s[8:11], s56 offen lds
    s_cmp_eq_u32 s91, 14
    s_cselect_b32 s91, 0, s91
    s_mul_i32 s56, s91, 86016
    s_add_u32 s56, s56, s90
    s_lshl_b32 s57, s91, 12
    s_add_u32 s57, s57, s101
    s_add_u32 m0, s57, 3584
    s_add_u32 s91, s91, 1
    buffer_load_dwordx4 v11, s[8:11], s56 offen lds
    s_cmp_eq_u32 s91, 14
    s_cselect_b32 s91, 0, s91
    s_mul_i32 s56, s91, 86016
    s_add_u32 s56, s56, s90
    s_lshl_b32 s57, s91, 12
    s_add_u32 s57, s57, s101
    s_add_u32 m0, s57, 3584
    s_add_u32 s91, s91, 1
    buffer_load_dwordx4 v11, s[8:11], s56 offen lds
    s_cmp_eq_u32 s91, 14
    s_cselect_b32 s91, 0, s91
    s_mul_i32 s56, s91, 86016
    s_add_u32 s56, s56, s90
    s_lshl_b32 s57, s91, 12
    s_add_u32 s57, s57, s101
    s_add_u32 m0, s57, 3584
    s_add_u32 s91, s91, 1
    buffer_load_dwordx4 v11, s[8:11], s56 offen lds
    s_cmp_eq_u32 s91, 14
    s_cselect_b32 s91, 0, s91
    s_mul_i32 s56, s91, 86016
    s_add_u32 s56, s56, s90
    s_lshl_b32 s57, s91, 12
    s_add_u32 s57, s57, s101
    s_add_u32 m0, s57, 3584
    s_add_u32 s91, s91, 1
    buffer_load_dwordx4 v11, s[8:11], s56 offen lds
    s_cmp_eq_u32 s91, 14
    s_cselect_b32 s91, 0, s91
    s_mul_i32 s56, s91, 86016
    s_add_u32 s56, s56, s90
    s_lshl_b32 s57, s91, 12
    s_add_u32 s57, s57, s101
    s_add_u32 m0, s57, 3584
    s_add_u32 s91, s91, 1
    buffer_load_dwordx4 v11, s[8:11], s56 offen lds
    s_cmp_eq_u32 s91, 14
    s_cselect_b32 s91, 0, s91
    s_mul_i32 s56, s91, 86016
    s_add_u32 s56, s56, s90
    s_lshl_b32 s57, s91, 12
    s_add_u32 s57, s57, s101
    s_add_u32 m0, s57, 3584
    s_add_u32 s91, s91, 1
    buffer_load_dwordx4 v11, s[8:11], s56 offen lds
    s_cmp_eq_u32 s91, 14
    s_cselect_b32 s91, 0, s91
    s_mul_i32 s56, s94, 172032
    s_add_u32 s56, s56, s92
    s_lshl_b32 s57, s94, 12
    s_add_u32 s57, s57, s101
    s_add_u32 m0, s57, 60928
    s_add_u32 s94, s94, 1
    buffer_load_dwordx4 v10, s[8:11], s56 offen lds
    s_cmp_eq_u32 s94, 7
    s_cselect_b32 s94, 0, s94
    s_mul_i32 s56, s94, 172032
    s_add_u32 s56, s56, s92
    s_lshl_b32 s57, s94, 12
    s_add_u32 s57, s57, s101
    s_add_u32 m0, s57, 60928
    s_add_u32 s94, s94, 1
    buffer_load_dwordx4 v10, s[8:11], s56 offen lds
    s_cmp_eq_u32 s94, 7
    s_cselect_b32 s94, 0, s94
    s_mul_i32 s56, s94, 172032
    s_add_u32 s56, s56, s92
    s_lshl_b32 s57, s94, 12
    s_add_u32 s57, s57, s101
    s_add_u32 m0, s57, 60928
    s_add_u32 s94, s94, 1
    buffer_load_dwordx4 v10, s[8:11], s56 offen lds
    s_cmp_eq_u32 s94, 7
    s_cselect_b32 s94, 0, s94
    s_mul_i32 s56, s94, 172032
    s_add_u32 s56, s56, s92
    s_lshl_b32 s57, s94, 12
    s_add_u32 s57, s57, s101
    s_add_u32 m0, s57, 60928
    s_add_u32 s94, s94, 1
    buffer_load_dwordx4 v10, s[8:11], s56 offen lds
    s_cmp_eq_u32 s94, 7
    s_cselect_b32 s94, 0, s94
    s_mul_i32 s56, s94, 172032
    s_add_u32 s56, s56, s92
    s_lshl_b32 s57, s94, 12
    s_add_u32 s57, s57, s101
    s_add_u32 m0, s57, 60928
    s_add_u32 s94, s94, 1
    buffer_load_dwordx4 v10, s[8:11], s56 offen lds
    s_cmp_eq_u32 s94, 7
    s_cselect_b32 s94, 0, s94
    s_mul_i32 s56, s94, 172032
    s_add_u32 s56, s56, s92
    s_lshl_b32 s57, s94, 12
    s_add_u32 s57, s57, s101
    s_add_u32 m0, s57, 60928
    s_add_u32 s94, s94, 1
    buffer_load_dwordx4 v10, s[8:11], s56 offen lds
    s_cmp_eq_u32 s94, 7
    s_cselect_b32 s94, 0, s94
    s_mul_i32 s56, s94, 172032
    s_add_u32 s56, s56, s92
    s_lshl_b32 s57, s94, 12
    s_add_u32 s57, s57, s101
    s_add_u32 m0, s57, 60928
    s_add_u32 s94, s94, 1
    buffer_load_dwordx4 v10, s[8:11], s56 offen lds
    s_cmp_eq_u32 s94, 7
    s_cselect_b32 s94, 0, s94
    s_branch L_wissued
L_plainw:
    s_mul_i32 s56, s91, 86016
    s_add_u32 s56, s56, s90
    s_lshl_b32 s57, s91, 12
    s_add_u32 s57, s57, s101
    s_add_u32 m0, s57, 3584
    s_add_u32 s91, s91, 1
    buffer_load_dwordx4 v11, s[8:11], s56 offen lds
    s_cmp_eq_u32 s91, 14
    s_cselect_b32 s91, 0, s91
    s_mul_i32 s56, s91, 86016
    s_add_u32 s56, s56, s90
    s_lshl_b32 s57, s91, 12
    s_add_u32 s57, s57, s101
    s_add_u32 m0, s57, 3584
    s_add_u32 s91, s91, 1
    buffer_load_dwordx4 v11, s[8:11], s56 offen lds
    s_cmp_eq_u32 s91, 14
    s_cselect_b32 s91, 0, s91
    s_mul_i32 s56, s91, 86016
    s_add_u32 s56, s56, s90
    s_lshl_b32 s57, s91, 12
    s_add_u32 s57, s57, s101
    s_add_u32 m0, s57, 3584
    s_add_u32 s91, s91, 1
    buffer_load_dwordx4 v11, s[8:11], s56 offen lds
    s_cmp_eq_u32 s91, 14
    s_cselect_b32 s91, 0, s91
    s_mul_i32 s56, s91, 86016
    s_add_u32 s56, s56, s90
    s_lshl_b32 s57, s91, 12
    s_add_u32 s57, s57, s101
    s_add_u32 m0, s57, 3584
    s_add_u32 s91, s91, 1
    buffer_load_dwordx4 v11, s[8:11], s56 offen lds
    s_cmp_eq_u32 s91, 14
    s_cselect_b32 s91, 0, s91
    s_waitcnt vmcnt(6)
    v_readfirstlane_b32 s54, v3
    s_nop 0
    s_mul_i32 s54, s54, 1664525
    s_add_u32 s54, s54, 1013904223
    s_cmp_lg_u32 s50, 3
    s_cbranch_scc1 L_noxcc_2
    s_getreg_b32 s56, hwreg(HW_REG_XCC_ID, 0, 4)
    v_mov_b32 v60, s54
    v_mov_b32 v61, s56
    s_lshl_b32 s56, s48, 5
    s_add_u32 s56, s56, s49
    s_lshl_b32 s56, s56, 7
    s_add_u32 s56, s56, 655360
    s_mov_b64 exec, 1
    buffer_store_dwordx2 v[60:61], off, s[44:47], s56 sc1
    s_mov_b64 exec, -1
L_noxcc_2:
    s_mul_i32 s56, s91, 86016
    s_add_u32 s56, s56, s90
    s_lshl_b32 s57, s91, 12
    s_add_u32 s57, s57, s101
    s_add_u32 m0, s57, 3584
    s_add_u32 s91, s91, 1
    buffer_load_dwordx4 v11, s[8:11], s56 offen lds
    s_cmp_eq_u32 s91, 14
    s_cselect_b32 s91, 0, s91
    s_mul_i32 s56, s91, 86016
    s_add_u32 s56, s56, s90
    s_lshl_b32 s57, s91, 12
    s_add_u32 s57, s57, s101
    s_add_u32 m0, s57, 3584
    s_add_u32 s91, s91, 1
    buffer_load_dwordx4 v11, s[8:11], s56 offen lds
    s_cmp_eq_u32 s91, 14
    s_cselect_b32 s91, 0, s91
    s_mul_i32 s56, s91, 86016
    s_add_u32 s56, s56, s90
    s_lshl_b32 s57, s91, 12
    s_add_u32 s57, s57, s101
    s_add_u32 m0, s57, 3584
    s_add_u32 s91, s91, 1
    buffer_load_dwordx4 v11, s[8:11], s56 offen lds
    s_cmp_eq_u32 s91, 14
    s_cselect_b32 s91, 0, s91
    s_mul_i32 s56, s91, 86016
    s_add_u32 s56, s56, s90
    s_lshl_b32 s57, s91, 12
    s_add_u32 s57, s57, s101
    s_add_u32 m0, s57, 3584
    s_add_u32 s91, s91, 1
    buffer_load_dwordx4 v11, s[8:11], s56 offen lds
    s_cmp_eq_u32 s91, 14
    s_cselect_b32 s91, 0, s91
    s_mul_i32 s56, s91, 86016
    s_add_u32 s56, s56, s90
    s_lshl_b32 s57, s91, 12
    s_add_u32 s57, s57, s101
    s_add_u32 m0, s57, 3584
    s_add_u32 s91, s91, 1
    buffer_load_dwordx4 v11, s[8:11], s56 offen lds
    s_cmp_eq_u32 s91, 14
    s_cselect_b32 s91, 0, s91
    s_mul_i32 s56, s91, 86016
    s_add_u32 s56, s56, s90
    s_lshl_b32 s57, s91, 12
    s_add_u32 s57, s57, s101
    s_add_u32 m0, s57, 3584
    s_add_u32 s91, s91, 1
    buffer_load_dwordx4 v11, s[8:11], s56 offen lds
    s_cmp_eq_u32 s91, 14
    s_cselect_b32 s91, 0, s91
    s_mul_i32 s56, s91, 86016
    s_add_u32 s56, s56, s90
    s_lshl_b32 s57, s91, 12
    s_add_u32 s57, s57, s101
    s_add_u32 m0, s57, 3584
    s_add_u32 s91, s91, 1
    buffer_load_dwordx4 v11, s[8:11], s56 offen lds
    s_cmp_eq_u32 s91, 14
    s_cselect_b32 s91, 0, s91
    s_mul_i32 s56, s91, 86016
    s_add_u32 s56, s56, s90
    s_lshl_b32 s57, s91, 12
    s_add_u32 s57, s57, s101
    s_add_u32 m0, s57, 3584
    s_add_u32 s91, s91, 1
    buffer_load_dwordx4 v11, s[8:11], s56 offen lds
    s_cmp_eq_u32 s91, 14
    s_cselect_b32 s91, 0, s91
    s_mul_i32 s56, s91, 86016
    s_add_u32 s56, s56, s90
    s_lshl_b32 s57, s91, 12
    s_add_u32 s57, s57, s101
    s_add_u32 m0, s57, 3584
    s_add_u32 s91, s91, 1
    buffer_load_dwordx4 v11, s[8:11], s56 offen lds
    s_cmp_eq_u32 s91, 14
    s_cselect_b32 s91, 0, s91
    s_mul_i32 s56, s91, 86016
    s_add_u32 s56, s56, s90
    s_lshl_b32 s57, s91, 12
    s_add_u32 s57, s57, s101
    s_add_u32 m0, s57, 3584
    s_add_u32 s91, s91, 1
    buffer_load_dwordx4 v11, s[8:11], s56 offen lds
    s_cmp_eq_u32 s91, 14
    s_cselect_b32 s91, 0, s91
    s_mul_i32 s56, s94, 172032
    s_add_u32 s56, s56, s92
    s_lshl_b32 s57, s94, 12
    s_add_u32 s57, s57, s101
    s_add_u32 m0, s57, 60928
    s_add_u32 s94, s94, 1
    buffer_load_dwordx4 v10, s[8:11], s56 offen lds
    s_cmp_eq_u32 s94, 7
    s_cselect_b32 s94, 0, s94
    s_mul_i32 s56, s94, 172032
    s_add_u32 s56, s56, s92
    s_lshl_b32 s57, s94, 12
    s_add_u32 s57, s57, s101
    s_add_u32 m0, s57, 60928
    s_add_u32 s94, s94, 1
    buffer_load_dwordx4 v10, s[8:11], s56 offen lds
    s_cmp_eq_u32 s94, 7
    s_cselect_b32 s94, 0, s94
    s_mul_i32 s56, s94, 172032
    s_add_u32 s56, s56, s92
    s_lshl_b32 s57, s94, 12
    s_add_u32 s57, s57, s101
    s_add_u32 m0, s57, 60928
    s_add_u32 s94, s94, 1
    buffer_load_dwordx4 v10, s[8:11], s56 offen lds
    s_cmp_eq_u32 s94, 7
    s_cselect_b32 s94, 0, s94
    s_mul_i32 s56, s94, 172032
    s_add_u32 s56, s56, s92
    s_lshl_b32 s57, s94, 12
    s_add_u32 s57, s57, s101
    s_add_u32 m0, s57, 60928
    s_add_u32 s94, s94, 1
    buffer_load_dwordx4 v10, s[8:11], s56 offen lds
    s_cmp_eq_u32 s94, 7
    s_cselect_b32 s94, 0, s94
    s_mul_i32 s56, s94, 172032
    s_add_u32 s56, s56, s92
    s_lshl_b32 s57, s94, 12
    s_add_u32 s57, s57, s101
    s_add_u32 m0, s57, 60928
    s_add_u32 s94, s94, 1
    buffer_load_dwordx4 v10, s[8:11], s56 offen lds
    s_cmp_eq_u32 s94, 7
    s_cselect_b32 s94, 0, s94
    s_mul_i32 s56, s94, 172032
    s_add_u32 s56, s56, s92
    s_lshl_b32 s57, s94, 12
    s_add_u32 s57, s57, s101
    s_add_u32 m0, s57, 60928
    s_add_u32 s94, s94, 1
    buffer_load_dwordx4 v10, s[8:11], s56 offen lds
    s_cmp_eq_u32 s94, 7
    s_cselect_b32 s94, 0, s94
    s_mul_i32 s56, s94, 172032
    s_add_u32 s56, s56, s92
    s_lshl_b32 s57, s94, 12
    s_add_u32 s57, s57, s101
    s_add_u32 m0, s57, 60928
    s_add_u32 s94, s94, 1
    buffer_load_dwordx4 v10, s[8:11], s56 offen lds
    s_cmp_eq_u32 s94, 7
    s_cselect_b32 s94, 0, s94
L_wissued:
    v_lshrrev_b32 v4, 5, v0
    v_and_b32 v5, 31, v0
    s_cmp_ge_u32 s51, 7
    s_cbranch_scc1 L_vaddr
    s_lshl_b32 s56, s51, 4
    v_add_u32 v4, s56, v4
    v_lshlrev_b32 v5, 3, v5
    v_add_u32 v6, 0, v4
    v_mul_u32_u24 v7, 147, v6
    v_lshrrev_b32 v7, 10, v7
    v_mul_u32_u24 v8, 7, v7
    v_sub_u32 v6, v6, v8
    v_lshl_add_u32 v6, v6, 8, v5
    v_lshl_add_u32 v96, v7, 18, v6
    v_add_u32 v6, 2, v4
    v_mul_u32_u24 v7, 147, v6
    v_lshrrev_b32 v7, 10, v7
    v_mul_u32_u24 v8, 7, v7
    v_sub_u32 v6, v6, v8
    v_lshl_add_u32 v6, v6, 8, v5
    v_lshl_add_u32 v97, v7, 18, v6
    v_add_u32 v6, 4, v4
    v_mul_u32_u24 v7, 147, v6
    v_lshrrev_b32 v7, 10, v7
    v_mul_u32_u24 v8, 7, v7
    v_sub_u32 v6, v6, v8
    v_lshl_add_u32 v6, v6, 8, v5
    v_lshl_add_u32 v98, v7, 18, v6
    v_add_u32 v6, 6, v4
    v_mul_u32_u24 v7, 147, v6
    v_lshrrev_b32 v7, 10, v7
    v_mul_u32_u24 v8, 7, v7
    v_sub_u32 v6, v6, v8
    v_lshl_add_u32 v6, v6, 8, v5
    v_lshl_add_u32 v99, v7, 18, v6
    v_add_u32 v6, 8, v4
    v_mul_u32_u24 v7, 147, v6
    v_lshrrev_b32 v7, 10, v7
    v_mul_u32_u24 v8, 7, v7
    v_sub_u32 v6, v6, v8
    v_lshl_add_u32 v6, v6, 8, v5
    v_lshl_add_u32 v100, v7, 18, v6
    v_add_u32 v6, 10, v4
    v_mul_u32_u24 v7, 147, v6
    v_lshrrev_b32 v7, 10, v7
    v_mul_u32_u24 v8, 7, v7
    v_sub_u32 v6, v6, v8
    v_lshl_add_u32 v6, v6, 8, v5
    v_lshl_add_u32 v101, v7, 18, v6
    v_add_u32 v6, 12, v4
    v_mul_u32_u24 v7, 147, v6
    v_lshrrev_b32 v7, 10, v7
    v_mul_u32_u24 v8, 7, v7
    v_sub_u32 v6, v6, v8
    v_lshl_add_u32 v6, v6, 8, v5
    v_lshl_add_u32 v102, v7, 18, v6
    v_add_u32 v6, 14, v4
    v_mul_u32_u24 v7, 147, v6
    v_lshrrev_b32 v7, 10, v7
    v_mul_u32_u24 v8, 7, v7
    v_sub_u32 v6, v6, v8
    v_lshl_add_u32 v6, v6, 8, v5
    v_lshl_add_u32 v103, v7, 18, v6
    s_branch L_addrdone
L_vaddr:
    s_sub_u32 s56, s51, 7
    s_lshl_b32 s56, s56, 6
    v_add_u32 v5, s56, v5
    v_lshlrev_b32 v4, 9, v4
    v_add_u32 v4, 2048, v4
    v_add_u32 v6, 0, v5
    v_mul_u32_u24 v7, 2341, v6
    v_lshrrev_b32 v7, 16, v7
    v_mul_u32_u24 v8, 28, v7
    v_sub_u32 v6, v6, v8
    v_lshl_add_u32 v6, v6, 4, v4
    v_lshl_add_u32 v96, v7, 18, v6
    v_add_u32 v6, 32, v5
    v_mul_u32_u24 v7, 2341, v6
    v_lshrrev_b32 v7, 16, v7
    v_mul_u32_u24 v8, 28, v7
    v_sub_u32 v6, v6, v8
    v_lshl_add_u32 v6, v6, 4, v4
    v_lshl_add_u32 v97, v7, 18, v6
    v_mov_b32 v98, v96
    v_mov_b32 v99, v96
    v_mov_b32 v100, v96
    v_mov_b32 v101, v96
    v_mov_b32 v102, v96
    v_mov_b32 v103, v96
L_addrdone:
    s_lshl_b32 s58, s62, 7
    s_mul_i32 s60, s50, 7168
    s_add_u32 s58, s58, s60
    s_mul_i32 s60, s61, 7
    s_lshr_b32 s60, s60, 1
    s_mul_i32 s59, s60, 28672
    s_add_u32 s59, s59, s58
    s_lshl_b32 s57, s60, 12
    s_add_u32 s57, s57, s101
    s_add_u32 m0, s57, 105984
    s_add_u32 s60, s60, 1
    buffer_load_dwordx4 v13, s[12:15], s59 offen lds
    s_cmp_eq_u32 s60, 14
    s_cselect_b32 s60, 0, s60
    s_mul_i32 s59, s60, 28672
    s_add_u32 s59, s59, s58
    s_lshl_b32 s57, s60, 12
    s_add_u32 s57, s57, s101
    s_add_u32 m0, s57, 105984
    s_add_u32 s60, s60, 1
    buffer_load_dwordx4 v13, s[12:15], s59 offen lds
    s_cmp_eq_u32 s60, 14
    s_cselect_b32 s60, 0, s60
    s_mul_i32 s59, s60, 28672
    s_add_u32 s59, s59, s58
    s_lshl_b32 s57, s60, 12
    s_add_u32 s57, s57, s101
    s_add_u32 m0, s57, 105984
    s_add_u32 s60, s60, 1
    buffer_load_dwordx4 v13, s[12:15], s59 offen lds
    s_cmp_eq_u32 s60, 14
    s_cselect_b32 s60, 0, s60
    s_mul_i32 s59, s60, 28672
    s_add_u32 s59, s59, s58
    s_lshl_b32 s57, s60, 12
    s_add_u32 s57, s57, s101
    s_add_u32 m0, s57, 105984
    s_add_u32 s60, s60, 1
    buffer_load_dwordx4 v13, s[12:15], s59 offen lds
    s_cmp_eq_u32 s60, 14
    s_cselect_b32 s60, 0, s60
    s_mul_i32 s59, s60, 28672
    s_add_u32 s59, s59, s58
    s_lshl_b32 s57, s60, 12
    s_add_u32 s57, s57, s101
    s_add_u32 m0, s57, 105984
    s_add_u32 s60, s60, 1
    buffer_load_dwordx4 v13, s[12:15], s59 offen lds
    s_cmp_eq_u32 s60, 14
    s_cselect_b32 s60, 0, s60
    s_mul_i32 s59, s60, 28672
    s_add_u32 s59, s59, s58
    s_lshl_b32 s57, s60, 12
    s_add_u32 s57, s57, s101
    s_add_u32 m0, s57, 105984
    s_add_u32 s60, s60, 1
    buffer_load_dwordx4 v13, s[12:15], s59 offen lds
    s_cmp_eq_u32 s60, 14
    s_cselect_b32 s60, 0, s60
    s_mul_i32 s59, s60, 28672
    s_add_u32 s59, s59, s58
    s_lshl_b32 s57, s60, 12
    s_add_u32 s57, s57, s101
    s_add_u32 m0, s57, 105984
    s_add_u32 s60, s60, 1
    buffer_load_dwordx4 v13, s[12:15], s59 offen lds
    s_cmp_eq_u32 s60, 14
    s_cselect_b32 s60, 0, s60
    s_mul_i32 s59, s60, 28672
    s_add_u32 s59, s59, s58
    s_lshl_b32 s57, s60, 12
    s_add_u32 s57, s57, s101
    s_add_u32 m0, s57, 105984
    s_add_u32 s60, s60, 1
    buffer_load_dwordx4 v13, s[12:15], s59 offen lds
    s_cmp_eq_u32 s60, 14
    s_cselect_b32 s60, 0, s60
    s_mul_i32 s59, s60, 28672
    s_add_u32 s59, s59, s58
    s_lshl_b32 s57, s60, 12
    s_add_u32 s57, s57, s101
    s_add_u32 m0, s57, 105984
    s_add_u32 s60, s60, 1
    buffer_load_dwordx4 v13, s[12:15], s59 offen lds
    s_cmp_eq_u32 s60, 14
    s_cselect_b32 s60, 0, s60
    s_mul_i32 s59, s60, 28672
    s_add_u32 s59, s59, s58
    s_lshl_b32 s57, s60, 12
    s_add_u32 s57, s57, s101
    s_add_u32 m0, s57, 105984
    s_add_u32 s60, s60, 1
    buffer_load_dwordx4 v13, s[12:15], s59 offen lds
    s_cmp_eq_u32 s60, 14
    s_cselect_b32 s60, 0, s60
    s_mul_i32 s59, s60, 28672
    s_add_u32 s59, s59, s58
    s_lshl_b32 s57, s60, 12
    s_add_u32 s57, s57, s101
    s_add_u32 m0, s57, 105984
    s_add_u32 s60, s60, 1
    buffer_load_dwordx4 v13, s[12:15], s59 offen lds
    s_cmp_eq_u32 s60, 14
    s_cselect_b32 s60, 0, s60
    s_mul_i32 s59, s60, 28672
    s_add_u32 s59, s59, s58
    s_lshl_b32 s57, s60, 12
    s_add_u32 s57, s57, s101
    s_add_u32 m0, s57, 105984
    s_add_u32 s60, s60, 1
    buffer_load_dwordx4 v13, s[12:15], s59 offen lds
    s_cmp_eq_u32 s60, 14
    s_cselect_b32 s60, 0, s60
    s_mul_i32 s59, s60, 28672
    s_add_u32 s59, s59, s58
    s_lshl_b32 s57, s60, 12
    s_add_u32 s57, s57, s101
    s_add_u32 m0, s57, 105984
    s_add_u32 s60, s60, 1
    buffer_load_dwordx4 v13, s[12:15], s59 offen lds
    s_cmp_eq_u32 s60, 14
    s_cselect_b32 s60, 0, s60
    s_mul_i32 s59, s60, 28672
    s_add_u32 s59, s59, s58
    s_lshl_b32 s57, s60, 12
    s_add_u32 s57, s57, s101
    s_add_u32 m0, s57, 105984
    s_add_u32 s60, s60, 1
    buffer_load_dwordx4 v13, s[12:15], s59 offen lds
    s_cmp_eq_u32 s60, 14
    s_cselect_b32 s60, 0, s60
    v_and_b32 v62, 31, v0
    v_lshlrev_b32 v62, 7, v62
    s_lshl_b32 s95, s48, 12
    s_add_u32 s95, s95, 655360
    buffer_load_dwordx2 v[60:61], v62, s[44:47], s95 offen sc1
    s_mov_b32 s8, s95
    s_mul_i32 s10, s53, 14
    s_add_u32 s10, s10, s51
    s_lshl_b32 s10, s10, 7
    s_add_u32 s10, s10, 131072
    v_lshrrev_b32 v4, 4, v0
    v_min_u32 v4, 2, v4
    v_cmp_eq_u32 vcc, 1, v4
    v_mul_u32_u24 v5, 168, v4
    s_nop 0
    v_cndmask_b32 v210, 0, 1.0, vcc
    v_cndmask_b32 v6, 0, 56, vcc
    v_add_u32 v5, v5, v6
    v_and_b32 v6, 15, v0
    s_lshl_b32 s56, s62, 4
    s_add_u32 s56, s56, 224
    v_add3_u32 v5, v5, v6, s56
    v_lshlrev_b32 v208, 4, v5
    v_lshl_add_u32 v209, v4, 4, v6
    v_lshlrev_b32 v209, 4, v209
    v_lshrrev_b32 v4, 2, v0
    v_mul_u32_u24 v4, 896, v4
    v_and_b32 v5, 3, v0
    v_lshl_add_u32 v214, v5, 4, v4
    s_lshl_b32 s56, s48, 2
    s_add_u32 s56, s56, s61
    s_lshl_b32 s56, s56, 2
    s_add_u32 s56, s56, s50
    s_mul_i32 s56, s56, 14336
    s_lshl_b32 s57, s62, 7
    s_add_u32 s100, s56, s57
    v_and_b32 v4, 31, v0
    v_lshrrev_b32 v7, 5, v0
    v_lshlrev_b32 v7, 2, v7
    v_sub_u32 v4, v4, v7
    v_mov_b32 v6, 0xffff
    v_mov_b32 v7, 0xffff0000
    v_cmp_le_i32 s[64:65], 0, v4
    v_cmp_le_i32 s[66:67], 1, v4
    v_cmp_le_i32 s[68:69], 2, v4
    v_cmp_le_i32 s[70:71], 3, v4
    v_cmp_le_i32 s[72:73], 8, v4
    v_cmp_le_i32 s[74:75], 9, v4
    v_cmp_le_i32 s[76:77], 10, v4
    v_cmp_le_i32 s[78:79], 11, v4
    v_cmp_le_i32 s[80:81], 16, v4
    v_cmp_le_i32 s[82:83], 17, v4
    v_cmp_le_i32 s[84:85], 18, v4
    v_cmp_le_i32 s[86:87], 19, v4
    v_cmp_le_i32 s[88:89], 24, v4
    v_cmp_le_i32 s[90:91], 25, v4
    v_cmp_le_i32 s[92:93], 26, v4
    v_cmp_le_i32 s[94:95], 27, v4
    v_cndmask_b32 v4, 0, v6, s[64:65]
    v_cndmask_b32 v5, 0, v7, s[66:67]
    v_or_b32 v72, v4, v5
    v_cndmask_b32 v4, 0, v6, s[68:69]
    v_cndmask_b32 v5, 0, v7, s[70:71]
    v_or_b32 v73, v4, v5
    v_cndmask_b32 v4, 0, v6, s[72:73]
    v_cndmask_b32 v5, 0, v7, s[74:75]
    v_or_b32 v74, v4, v5
    v_cndmask_b32 v4, 0, v6, s[76:77]
    v_cndmask_b32 v5, 0, v7, s[78:79]
    v_or_b32 v75, v4, v5
    v_cndmask_b32 v4, 0, v6, s[80:81]
    v_cndmask_b32 v5, 0, v7, s[82:83]
    v_or_b32 v76, v4, v5
    v_cndmask_b32 v4, 0, v6, s[84:85]
    v_cndmask_b32 v5, 0, v7, s[86:87]
    v_or_b32 v77, v4, v5
    v_cndmask_b32 v4, 0, v6, s[88:89]
    v_cndmask_b32 v5, 0, v7, s[90:91]
    v_or_b32 v78, v4, v5
    v_cndmask_b32 v4, 0, v6, s[92:93]
    v_cndmask_b32 v5, 0, v7, s[94:95]
    v_or_b32 v79, v4, v5
    s_mul_i32 s42, s50, 12288
    s_add_u32 s42, s42, 3584
    v_add_u32 v4, 1792, v1
    v_subrev_u32 v5, 16, v0
    v_lshlrev_b32 v5, 9, v5
    v_add_u32 v5, 2496, v5
    v_cmp_gt_u32 vcc, 16, v0
    v_mov_b32 v6, 0x3f803f80
    s_nop 0
    v_cndmask_b32 v4, v5, v4, vcc
    v_cndmask_b32 v196, v6, 0, vcc
    v_add_u32 v201, s42, v4
    v_mov_b32 v197, v196
    v_mov_b32 v198, v196
    v_mov_b32 v199, v196
    s_and_b32 s43, s53, 0xfc
    s_mul_i32 s57, s50, 3
    s_add_u32 s43, s43, s57
    s_sub_u32 s43, s43, 8
    v_bfe_u32 v4, v0, 2, 2
    v_min_u32 v4, 2, v4
    v_add_u32 v4, s43, v4
    v_max_i32 v4, 0, v4
    v_mul_u32_u24 v4, 14, v4
    s_mul_i32 s56, s51, 28
    v_and_b32 v5, 1, v0
    v_mul_u32_u24 v5, 27, v5
    v_add_u32 v5, s56, v5
    v_lshrrev_b32 v5, 6, v5
    v_add_u32 v4, v4, v5
    v_bfe_u32 v5, v0, 1, 1
    v_mul_u32_u24 v5, 7, v5
    v_add_u32 v4, v4, v5
    v_lshlrev_b32 v4, 7, v4
    v_add_u32 v200, 131072, v4
    v_mov_b32 v184, 0
    v_mov_b32 v185, 0
    v_mov_b32 v186, 0
    v_mov_b32 v187, 0
    v_mov_b32 v188, 0
    v_mov_b32 v189, 0
    v_mov_b32 v190, 0
    v_mov_b32 v191, 0
    v_mov_b32 v5, 0x0000f149
    v_cmp_le_u32 vcc, 48, v0
    v_add_u32 v202, s42, v1
    s_nop 0
    v_cndmask_b32 v188, 0, v5, vcc
    v_cndmask_b32 v190, 0, v5, vcc
    s_lshl_b32 s56, s49, 3
    s_add_u32 s56, s56, s48
    s_lshl_b32 s56, s56, 2
    s_add_u32 s56, s56, s50
    s_min_u32 s56, s56, 784
    s_mul_i32 s57, s56, 9363
    s_lshr_b32 s57, s57, 16
    s_mul_i32 s58, s57, 7
    s_sub_u32 s58, s56, s58
    s_mul_i32 s41, s58, 112
    s_add_u32 s41, s41, s57
    s_cmp_ge_u32 s56, 784
    s_cselect_b32 s41, 784, s41
    s_mul_i32 s40, s57, 14336
    s_lshl_b32 s58, s58, 7
    s_add_u32 s40, s40, s58
    v_add_u32 v211, 6144, v14
    v_lshrrev_b32 v212, 5, v0
    v_mul_u32_u24 v212, 4, v212
    v_bfe_u32 v5, v0, 2, 2
    v_add_u32 v212, v212, v5
    v_lshlrev_b32 v212, 7, v212
    v_bfe_u32 v4, v0, 4, 1
    v_lshl_add_u32 v212, v4, 5, v212
    v_and_b32 v4, 3, v0
    v_lshl_add_u32 v212, v4, 3, v212
    v_lshrrev_b32 v5, 1, v5
    v_lshl_add_u32 v212, v5, 6, v212
    s_lshl_b32 s56, s50, 11
    s_add_u32 s56, s56, 52736
    v_add_u32 v212, s56, v212
    v_xor_b32 v213, 64, v212
    s_waitcnt vmcnt(0)
    s_mov_b32 s63, 0
L_xcc_3:
    v_cmp_ne_u32 vcc, s54, v60
    s_cbranch_vccz L_xccd_4
    buffer_load_dwordx2 v[60:61], v62, s[44:47], s8 offen sc1
    s_add_u32 s63, s63, 1
    s_cmp_ge_u32 s63, 131072
    s_waitcnt vmcnt(0)
    s_cbranch_scc0 L_xcc_3
L_xccd_4:
    s_getreg_b32 s56, hwreg(HW_REG_XCC_ID, 0, 4)
    v_cmp_ne_u32 vcc, s56, v61
    s_nop 0
    s_cmp_eq_u64 vcc, 0
    s_cselect_b32 s55, 1, 0
L_p1:
    s_waitcnt lgkmcnt(0)
    s_barrier
    v_lshrrev_b32 v4, 5, v0
    v_lshlrev_b32 v4, 9, v4
    v_bfe_u32 v5, v0, 2, 2
    v_lshl_add_u32 v4, v5, 6, v4
    v_bfe_u32 v5, v0, 4, 1
    v_lshl_add_u32 v4, v5, 5, v4
    v_and_b32 v5, 3, v0
    v_lshl_add_u32 v4, v5, 3, v4
    v_add_u32 v4, s3, v4
    v_add_u32 v10, 60928, v4
    v_lshrrev_b32 v8, 5, v0
    v_mul_u32_u24 v8, 8, v8
    v_bfe_u32 v5, v0, 2, 2
    v_add_u32 v8, v8, v5
    v_lshlrev_b32 v8, 7, v8
    v_bfe_u32 v4, v0, 4, 1
    v_lshl_add_u32 v8, v4, 5, v8
    v_and_b32 v4, 3, v0
    v_lshl_add_u32 v8, v4, 3, v8
    v_lshrrev_b32 v5, 1, v5
    v_lshl_add_u32 v8, v5, 6, v8
    v_add_u32 v8, 3584, v8
    v_xor_b32 v9, 64, v8
    v_and_b32 v11, 3, v0
    v_lshlrev_b32 v11, 2, v11
    s_lshl_b32 s8, s53, 6
    s_add_u32 s8, s8, 4096
    s_mul_i32 s11, s53, 28672
    s_add_u32 s11, s11, 1114112
    s_lshl_b32 s9, s53, 12
    s_add_u32 s9, s9, 5242880
    s_cmp_ge_u32 s49, 28
    s_cbranch_scc1 L_p1_h
    s_cmp_ge_u32 s51, 7
    s_cbranch_scc1 L_p1_v
L_p1_k:
    buffer_load_dword v120, v11, s[44:47], s8 offen offset:0 sc1
    ds_read_b64_tr_b16 a[112:113], v10 offset:0
    ds_read_b64_tr_b16 a[114:115], v10 offset:256
    ds_read_b64_tr_b16 a[116:117], v10 offset:1024
    ds_read_b64_tr_b16 a[118:119], v10 offset:1280
    ds_read_b64_tr_b16 a[120:121], v10 offset:2048
    ds_read_b64_tr_b16 a[122:123], v10 offset:2304
    ds_read_b64_tr_b16 a[124:125], v10 offset:3072
    ds_read_b64_tr_b16 a[126:127], v10 offset:3328
    ds_read_b64_tr_b16 a[128:129], v10 offset:4096
    ds_read_b64_tr_b16 a[130:131], v10 offset:4352
    ds_read_b64_tr_b16 a[132:133], v10 offset:5120
    ds_read_b64_tr_b16 a[134:135], v10 offset:5376
    ds_read_b64_tr_b16 a[136:137], v10 offset:6144
    ds_read_b64_tr_b16 a[138:139], v10 offset:6400
    ds_read_b64_tr_b16 a[140:141], v10 offset:7168
    ds_read_b64_tr_b16 a[142:143], v10 offset:7424
    ds_read_b64_tr_b16 a[144:145], v10 offset:8192
    ds_read_b64_tr_b16 a[146:147], v10 offset:8448
    ds_read_b64_tr_b16 a[148:149], v10 offset:9216
    ds_read_b64_tr_b16 a[150:151], v10 offset:9472
    ds_read_b64_tr_b16 a[152:153], v10 offset:10240
    ds_read_b64_tr_b16 a[154:155], v10 offset:10496
    ds_read_b64_tr_b16 a[156:157], v10 offset:11264
    ds_read_b64_tr_b16 a[158:159], v10 offset:11520
    ds_read_b64_tr_b16 a[160:161], v10 offset:12288
    ds_read_b64_tr_b16 a[162:163], v10 offset:12544
    ds_read_b64_tr_b16 a[164:165], v10 offset:13312
    ds_read_b64_tr_b16 a[166:167], v10 offset:13568
    ds_read_b64_tr_b16 a[168:169], v10 offset:14336
    ds_read_b64_tr_b16 a[170:171], v10 offset:14592
    ds_read_b64_tr_b16 a[172:173], v10 offset:15360
    ds_read_b64_tr_b16 a[174:175], v10 offset:15616
    ds_read_b64_tr_b16 a[176:177], v10 offset:16384
    ds_read_b64_tr_b16 a[178:179], v10 offset:16640
    ds_read_b64_tr_b16 a[180:181], v10 offset:17408
    ds_read_b64_tr_b16 a[182:183], v10 offset:17664
    ds_read_b64_tr_b16 a[184:185], v10 offset:18432
    ds_read_b64_tr_b16 a[186:187], v10 offset:18688
    ds_read_b64_tr_b16 a[188:189], v10 offset:19456
    ds_read_b64_tr_b16 a[190:191], v10 offset:19712
    ds_read_b64_tr_b16 a[192:193], v10 offset:20480
    ds_read_b64_tr_b16 a[194:195], v10 offset:20736
    ds_read_b64_tr_b16 a[196:197], v10 offset:21504
    ds_read_b64_tr_b16 a[198:199], v10 offset:21760
    ds_read_b64_tr_b16 a[200:201], v10 offset:22528
    ds_read_b64_tr_b16 a[202:203], v10 offset:22784
    ds_read_b64_tr_b16 a[204:205], v10 offset:23552
    ds_read_b64_tr_b16 a[206:207], v10 offset:23808
    ds_read_b64_tr_b16 a[208:209], v10 offset:24576
    ds_read_b64_tr_b16 a[210:211], v10 offset:24832
    ds_read_b64_tr_b16 a[212:213], v10 offset:25600
    ds_read_b64_tr_b16 a[214:215], v10 offset:25856
    ds_read_b64_tr_b16 a[216:217], v10 offset:26624
    ds_read_b64_tr_b16 a[218:219], v10 offset:26880
    ds_read_b64_tr_b16 a[220:221], v10 offset:27648
    ds_read_b64_tr_b16 a[222:223], v10 offset:27904
    ds_read_b64_tr_b16 a[224:225], v8 offset:0
    ds_read_b64_tr_b16 a[226:227], v8 offset:512
    ds_read_b64_tr_b16 a[228:229], v9 offset:0
    ds_read_b64_tr_b16 a[230:231], v9 offset:512
    ds_read_b64_tr_b16 a[232:233], v8 offset:2048
    ds_read_b64_tr_b16 a[234:235], v8 offset:2560
    ds_read_b64_tr_b16 a[236:237], v9 offset:2048
    ds_read_b64_tr_b16 a[238:239], v9 offset:2560
    ds_read_b64_tr_b16 a[240:241], v8 offset:4096
    ds_read_b64_tr_b16 a[242:243], v8 offset:4608
    ds_read_b64_tr_b16 a[244:245], v9 offset:4096
    ds_read_b64_tr_b16 a[246:247], v9 offset:4608
    s_waitcnt vmcnt(0)
    v_cmp_ne_u32 vcc, s54, v120
    s_cbranch_vccz L_chkd_6
    s_mov_b32 s63, 0
L_chk_5:
    buffer_load_dword v120, v11, s[44:47], s8 offen offset:0 sc1
    s_add_u32 s63, s63, 1
    s_cmp_ge_u32 s63, 131072
    s_waitcnt vmcnt(0)
    s_cbranch_scc1 L_chkd_6
    v_cmp_ne_u32 vcc, s54, v120
    s_cbranch_vccnz L_chk_5
L_chkd_6:
    s_cmp_lg_u32 s55, 0
    s_cbranch_scc1 L_acq_7
    buffer_inv sc1
    s_waitcnt vmcnt(0)
L_acq_7:
    buffer_load_dwordx4 a[0:3], v1, s[44:47], s11 offen offset:0 sc1
    buffer_load_dwordx4 a[4:7], v1, s[44:47], s11 offen offset:1024 sc1
    buffer_load_dwordx4 a[8:11], v1, s[44:47], s11 offen offset:2048 sc1
    buffer_load_dwordx4 a[12:15], v1, s[44:47], s11 offen offset:3072 sc1
    s_add_u32 s11, s11, 4096
    buffer_load_dwordx4 a[16:19], v1, s[44:47], s11 offen offset:0 sc1
    buffer_load_dwordx4 a[20:23], v1, s[44:47], s11 offen offset:1024 sc1
    buffer_load_dwordx4 a[24:27], v1, s[44:47], s11 offen offset:2048 sc1
    buffer_load_dwordx4 a[28:31], v1, s[44:47], s11 offen offset:3072 sc1
    s_waitcnt vmcnt(7) lgkmcnt(8)
    v_mfma_f32_32x32x16_bf16 v[16:31], a[224:227], a[0:3], 0
    s_add_u32 s11, s11, 4096
    buffer_load_dwordx4 a[32:35], v1, s[44:47], s11 offen offset:0 sc1
    ds_read_b64_tr_b16 a[248:249], v8 offset:6144
    ds_read_b64_tr_b16 a[250:251], v8 offset:6656
    v_mfma_f32_32x32x16_bf16 v[32:47], a[228:231], a[0:3], 0
    ds_read_b64_tr_b16 a[252:253], v9 offset:6144
    ds_read_b64_tr_b16 a[254:255], v9 offset:6656
    s_waitcnt vmcnt(7) lgkmcnt(8)
    v_mfma_f32_32x32x16_bf16 v[16:31], a[232:235], a[4:7], v[16:31]
    buffer_load_dwordx4 a[36:39], v1, s[44:47], s11 offen offset:1024 sc1
    ds_read_b64_tr_b16 a[224:225], v8 offset:8192
    ds_read_b64_tr_b16 a[226:227], v8 offset:8704
    v_mfma_f32_32x32x16_bf16 v[32:47], a[236:239], a[4:7], v[32:47]
    ds_read_b64_tr_b16 a[228:229], v9 offset:8192
    ds_read_b64_tr_b16 a[230:231], v9 offset:8704
    s_waitcnt vmcnt(7) lgkmcnt(8)
    v_mfma_f32_32x32x16_bf16 v[16:31], a[240:243], a[8:11], v[16:31]
    buffer_load_dwordx4 a[40:43], v1, s[44:47], s11 offen offset:2048 sc1
    ds_read_b64_tr_b16 a[232:233], v8 offset:10240
    ds_read_b64_tr_b16 a[234:235], v8 offset:10752
    v_mfma_f32_32x32x16_bf16 v[32:47], a[244:247], a[8:11], v[32:47]
    ds_read_b64_tr_b16 a[236:237], v9 offset:10240
    ds_read_b64_tr_b16 a[238:239], v9 offset:10752
    s_waitcnt vmcnt(7) lgkmcnt(8)
    v_mfma_f32_32x32x16_bf16 v[16:31], a[248:251], a[12:15], v[16:31]
    buffer_load_dwordx4 a[44:47], v1, s[44:47], s11 offen offset:3072 sc1
    ds_read_b64_tr_b16 a[240:241], v8 offset:12288
    ds_read_b64_tr_b16 a[242:243], v8 offset:12800
    v_mfma_f32_32x32x16_bf16 v[32:47], a[252:255], a[12:15], v[32:47]
    ds_read_b64_tr_b16 a[244:245], v9 offset:12288
    ds_read_b64_tr_b16 a[246:247], v9 offset:12800
    s_waitcnt vmcnt(7) lgkmcnt(8)
    v_mfma_f32_32x32x16_bf16 v[16:31], a[224:227], a[16:19], v[16:31]
    s_add_u32 s11, s11, 4096
    buffer_load_dwordx4 a[48:51], v1, s[44:47], s11 offen offset:0 sc1
    ds_read_b64_tr_b16 a[248:249], v8 offset:14336
    ds_read_b64_tr_b16 a[250:251], v8 offset:14848
    v_mfma_f32_32x32x16_bf16 v[32:47], a[228:231], a[16:19], v[32:47]
    ds_read_b64_tr_b16 a[252:253], v9 offset:14336
    ds_read_b64_tr_b16 a[254:255], v9 offset:14848
    s_waitcnt vmcnt(7) lgkmcnt(8)
    v_mfma_f32_32x32x16_bf16 v[16:31], a[232:235], a[20:23], v[16:31]
    buffer_load_dwordx4 a[52:55], v1, s[44:47], s11 offen offset:1024 sc1
    ds_read_b64_tr_b16 a[224:225], v8 offset:16384
    ds_read_b64_tr_b16 a[226:227], v8 offset:16896
    v_mfma_f32_32x32x16_bf16 v[32:47], a[236:239], a[20:23], v[32:47]
    ds_read_b64_tr_b16 a[228:229], v9 offset:16384
    ds_read_b64_tr_b16 a[230:231], v9 offset:16896
    s_waitcnt vmcnt(7) lgkmcnt(8)
    v_mfma_f32_32x32x16_bf16 v[16:31], a[240:243], a[24:27], v[16:31]
    buffer_load_dwordx4 a[56:59], v1, s[44:47], s11 offen offset:2048 sc1
    ds_read_b64_tr_b16 a[232:233], v8 offset:18432
    ds_read_b64_tr_b16 a[234:235], v8 offset:18944
    v_mfma_f32_32x32x16_bf16 v[32:47], a[244:247], a[24:27], v[32:47]
    ds_read_b64_tr_b16 a[236:237], v9 offset:18432
    ds_read_b64_tr_b16 a[238:239], v9 offset:18944
    s_waitcnt vmcnt(7) lgkmcnt(8)
    v_mfma_f32_32x32x16_bf16 v[16:31], a[248:251], a[28:31], v[16:31]
    buffer_load_dwordx4 a[60:63], v1, s[44:47], s11 offen offset:3072 sc1
    ds_read_b64_tr_b16 a[240:241], v8 offset:20480
    ds_read_b64_tr_b16 a[242:243], v8 offset:20992
    v_mfma_f32_32x32x16_bf16 v[32:47], a[252:255], a[28:31], v[32:47]
    ds_read_b64_tr_b16 a[244:245], v9 offset:20480
    ds_read_b64_tr_b16 a[246:247], v9 offset:20992
    s_waitcnt vmcnt(7) lgkmcnt(8)
    v_mfma_f32_32x32x16_bf16 v[16:31], a[224:227], a[32:35], v[16:31]
    s_add_u32 s11, s11, 4096
    buffer_load_dwordx4 a[64:67], v1, s[44:47], s11 offen offset:0 sc1
    ds_read_b64_tr_b16 a[248:249], v8 offset:22528
    ds_read_b64_tr_b16 a[250:251], v8 offset:23040
    v_mfma_f32_32x32x16_bf16 v[32:47], a[228:231], a[32:35], v[32:47]
    ds_read_b64_tr_b16 a[252:253], v9 offset:22528
    ds_read_b64_tr_b16 a[254:255], v9 offset:23040
    s_waitcnt vmcnt(7) lgkmcnt(8)
    v_mfma_f32_32x32x16_bf16 v[16:31], a[232:235], a[36:39], v[16:31]
    buffer_load_dwordx4 a[68:71], v1, s[44:47], s11 offen offset:1024 sc1
    ds_read_b64_tr_b16 a[224:225], v8 offset:24576
    ds_read_b64_tr_b16 a[226:227], v8 offset:25088
    v_mfma_f32_32x32x16_bf16 v[32:47], a[236:239], a[36:39], v[32:47]
    ds_read_b64_tr_b16 a[228:229], v9 offset:24576
    ds_read_b64_tr_b16 a[230:231], v9 offset:25088
    s_waitcnt vmcnt(7) lgkmcnt(8)
    v_mfma_f32_32x32x16_bf16 v[16:31], a[240:243], a[40:43], v[16:31]
    buffer_load_dwordx4 a[72:75], v1, s[44:47], s11 offen offset:2048 sc1
    ds_read_b64_tr_b16 a[232:233], v8 offset:26624
    ds_read_b64_tr_b16 a[234:235], v8 offset:27136
    v_mfma_f32_32x32x16_bf16 v[32:47], a[244:247], a[40:43], v[32:47]
    ds_read_b64_tr_b16 a[236:237], v9 offset:26624
    ds_read_b64_tr_b16 a[238:239], v9 offset:27136
    s_waitcnt vmcnt(7) lgkmcnt(8)
    v_mfma_f32_32x32x16_bf16 v[16:31], a[248:251], a[44:47], v[16:31]
    buffer_load_dwordx4 a[76:79], v1, s[44:47], s11 offen offset:3072 sc1
    ds_read_b64_tr_b16 a[240:241], v8 offset:28672
    ds_read_b64_tr_b16 a[242:243], v8 offset:29184
    v_mfma_f32_32x32x16_bf16 v[32:47], a[252:255], a[44:47], v[32:47]
    ds_read_b64_tr_b16 a[244:245], v9 offset:28672
    ds_read_b64_tr_b16 a[246:247], v9 offset:29184
    s_waitcnt vmcnt(7) lgkmcnt(8)
    v_mfma_f32_32x32x16_bf16 v[16:31], a[224:227], a[48:51], v[16:31]
    s_add_u32 s11, s11, 4096
    buffer_load_dwordx4 a[80:83], v1, s[44:47], s11 offen offset:0 sc1
    ds_read_b64_tr_b16 a[248:249], v8 offset:30720
    ds_read_b64_tr_b16 a[250:251], v8 offset:31232
    v_mfma_f32_32x32x16_bf16 v[32:47], a[228:231], a[48:51], v[32:47]
    ds_read_b64_tr_b16 a[252:253], v9 offset:30720
    ds_read_b64_tr_b16 a[254:255], v9 offset:31232
    s_waitcnt vmcnt(7) lgkmcnt(8)
    v_mfma_f32_32x32x16_bf16 v[16:31], a[232:235], a[52:55], v[16:31]
    buffer_load_dwordx4 a[84:87], v1, s[44:47], s11 offen offset:1024 sc1
    ds_read_b64_tr_b16 a[224:225], v8 offset:32768
    ds_read_b64_tr_b16 a[226:227], v8 offset:33280
    v_mfma_f32_32x32x16_bf16 v[32:47], a[236:239], a[52:55], v[32:47]
    ds_read_b64_tr_b16 a[228:229], v9 offset:32768
    ds_read_b64_tr_b16 a[230:231], v9 offset:33280
    s_waitcnt vmcnt(7) lgkmcnt(8)
    v_mfma_f32_32x32x16_bf16 v[16:31], a[240:243], a[56:59], v[16:31]
    buffer_load_dwordx4 a[88:91], v1, s[44:47], s11 offen offset:2048 sc1
    ds_read_b64_tr_b16 a[232:233], v8 offset:34816
    ds_read_b64_tr_b16 a[234:235], v8 offset:35328
    v_mfma_f32_32x32x16_bf16 v[32:47], a[244:247], a[56:59], v[32:47]
    ds_read_b64_tr_b16 a[236:237], v9 offset:34816
    ds_read_b64_tr_b16 a[238:239], v9 offset:35328
    s_waitcnt vmcnt(7) lgkmcnt(8)
    v_mfma_f32_32x32x16_bf16 v[16:31], a[248:251], a[60:63], v[16:31]
    buffer_load_dwordx4 a[92:95], v1, s[44:47], s11 offen offset:3072 sc1
    ds_read_b64_tr_b16 a[240:241], v8 offset:36864
    ds_read_b64_tr_b16 a[242:243], v8 offset:37376
    v_mfma_f32_32x32x16_bf16 v[32:47], a[252:255], a[60:63], v[32:47]
    ds_read_b64_tr_b16 a[244:245], v9 offset:36864
    ds_read_b64_tr_b16 a[246:247], v9 offset:37376
    s_waitcnt vmcnt(7) lgkmcnt(8)
    v_mfma_f32_32x32x16_bf16 v[16:31], a[224:227], a[64:67], v[16:31]
    s_add_u32 s11, s11, 4096
    buffer_load_dwordx4 a[96:99], v1, s[44:47], s11 offen offset:0 sc1
    ds_read_b64_tr_b16 a[248:249], v8 offset:38912
    ds_read_b64_tr_b16 a[250:251], v8 offset:39424
    v_mfma_f32_32x32x16_bf16 v[32:47], a[228:231], a[64:67], v[32:47]
    ds_read_b64_tr_b16 a[252:253], v9 offset:38912
    ds_read_b64_tr_b16 a[254:255], v9 offset:39424
    s_waitcnt vmcnt(7) lgkmcnt(8)
    v_mfma_f32_32x32x16_bf16 v[16:31], a[232:235], a[68:71], v[16:31]
    buffer_load_dwordx4 a[100:103], v1, s[44:47], s11 offen offset:1024 sc1
    ds_read_b64_tr_b16 a[224:225], v8 offset:40960
    ds_read_b64_tr_b16 a[226:227], v8 offset:41472
    v_mfma_f32_32x32x16_bf16 v[32:47], a[236:239], a[68:71], v[32:47]
    ds_read_b64_tr_b16 a[228:229], v9 offset:40960
    ds_read_b64_tr_b16 a[230:231], v9 offset:41472
    s_waitcnt vmcnt(7) lgkmcnt(8)
    v_mfma_f32_32x32x16_bf16 v[16:31], a[240:243], a[72:75], v[16:31]
    buffer_load_dwordx4 a[104:107], v1, s[44:47], s11 offen offset:2048 sc1
    ds_read_b64_tr_b16 a[232:233], v8 offset:43008
    ds_read_b64_tr_b16 a[234:235], v8 offset:43520
    v_mfma_f32_32x32x16_bf16 v[32:47], a[244:247], a[72:75], v[32:47]
    ds_read_b64_tr_b16 a[236:237], v9 offset:43008
    ds_read_b64_tr_b16 a[238:239], v9 offset:43520
    s_waitcnt vmcnt(7) lgkmcnt(8)
    v_mfma_f32_32x32x16_bf16 v[16:31], a[248:251], a[76:79], v[16:31]
    buffer_load_dwordx4 a[108:111], v1, s[44:47], s11 offen offset:3072 sc1
    ds_read_b64_tr_b16 a[240:241], v8 offset:45056
    ds_read_b64_tr_b16 a[242:243], v8 offset:45568
    v_mfma_f32_32x32x16_bf16 v[32:47], a[252:255], a[76:79], v[32:47]
    ds_read_b64_tr_b16 a[244:245], v9 offset:45056
    ds_read_b64_tr_b16 a[246:247], v9 offset:45568
    s_waitcnt vmcnt(7) lgkmcnt(8)
    v_mfma_f32_32x32x16_bf16 v[16:31], a[224:227], a[80:83], v[16:31]
    ds_read_b64_tr_b16 a[248:249], v8 offset:47104
    ds_read_b64_tr_b16 a[250:251], v8 offset:47616
    v_mfma_f32_32x32x16_bf16 v[32:47], a[228:231], a[80:83], v[32:47]
    ds_read_b64_tr_b16 a[252:253], v9 offset:47104
    ds_read_b64_tr_b16 a[254:255], v9 offset:47616
    s_waitcnt vmcnt(6) lgkmcnt(8)
    v_mfma_f32_32x32x16_bf16 v[16:31], a[232:235], a[84:87], v[16:31]
    ds_read_b64_tr_b16 a[224:225], v8 offset:49152
    ds_read_b64_tr_b16 a[226:227], v8 offset:49664
    v_mfma_f32_32x32x16_bf16 v[32:47], a[236:239], a[84:87], v[32:47]
    ds_read_b64_tr_b16 a[228:229], v9 offset:49152
    ds_read_b64_tr_b16 a[230:231], v9 offset:49664
    s_waitcnt vmcnt(5) lgkmcnt(8)
    v_mfma_f32_32x32x16_bf16 v[16:31], a[240:243], a[88:91], v[16:31]
    ds_read_b64_tr_b16 a[232:233], v8 offset:51200
    ds_read_b64_tr_b16 a[234:235], v8 offset:51712
    v_mfma_f32_32x32x16_bf16 v[32:47], a[244:247], a[88:91], v[32:47]
    ds_read_b64_tr_b16 a[236:237], v9 offset:51200
    ds_read_b64_tr_b16 a[238:239], v9 offset:51712
    s_waitcnt vmcnt(4) lgkmcnt(8)
    v_mfma_f32_32x32x16_bf16 v[16:31], a[248:251], a[92:95], v[16:31]
    ds_read_b64_tr_b16 a[240:241], v8 offset:53248
    ds_read_b64_tr_b16 a[242:243], v8 offset:53760
    v_mfma_f32_32x32x16_bf16 v[32:47], a[252:255], a[92:95], v[32:47]
    ds_read_b64_tr_b16 a[244:245], v9 offset:53248
    ds_read_b64_tr_b16 a[246:247], v9 offset:53760
    s_waitcnt vmcnt(3) lgkmcnt(8)
    v_mfma_f32_32x32x16_bf16 v[16:31], a[224:227], a[96:99], v[16:31]
    ds_read_b64_tr_b16 a[248:249], v8 offset:55296
    ds_read_b64_tr_b16 a[250:251], v8 offset:55808
    v_mfma_f32_32x32x16_bf16 v[32:47], a[228:231], a[96:99], v[32:47]
    ds_read_b64_tr_b16 a[252:253], v9 offset:55296
    ds_read_b64_tr_b16 a[254:255], v9 offset:55808
    s_waitcnt vmcnt(2) lgkmcnt(8)
    v_mfma_f32_32x32x16_bf16 v[16:31], a[232:235], a[100:103], v[16:31]
    v_mfma_f32_32x32x16_bf16 v[32:47], a[236:239], a[100:103], v[32:47]
    s_waitcnt vmcnt(1) lgkmcnt(4)
    v_mfma_f32_32x32x16_bf16 v[16:31], a[240:243], a[104:107], v[16:31]
    v_mfma_f32_32x32x16_bf16 v[32:47], a[244:247], a[104:107], v[32:47]
    s_waitcnt vmcnt(0) lgkmcnt(0)
    v_mfma_f32_32x32x16_bf16 v[16:31], a[248:251], a[108:111], v[16:31]
    v_mfma_f32_32x32x16_bf16 v[32:47], a[252:255], a[108:111], v[32:47]
    v_mfma_f32_32x32x16_bf16 v[48:63], a[112:115], a[0:3], 0
    v_mfma_f32_32x32x16_bf16 v[48:63], a[116:119], a[4:7], v[48:63]
    s_nop 8
    v_cvt_pk_bf16_f32 v104, v16, v17
    v_cvt_pk_bf16_f32 v105, v18, v19
    buffer_store_dwordx2 v[104:105], v96, s[44:47], s9 offen sc1
    v_cvt_pk_bf16_f32 v106, v20, v21
    v_mfma_f32_32x32x16_bf16 v[48:63], a[120:123], a[8:11], v[48:63]
    v_cvt_pk_bf16_f32 v107, v22, v23
    buffer_store_dwordx2 v[106:107], v97, s[44:47], s9 offen sc1
    v_cvt_pk_bf16_f32 v108, v24, v25
    v_mfma_f32_32x32x16_bf16 v[48:63], a[124:127], a[12:15], v[48:63]
    v_cvt_pk_bf16_f32 v109, v26, v27
    buffer_store_dwordx2 v[108:109], v98, s[44:47], s9 offen sc1
    v_cvt_pk_bf16_f32 v110, v28, v29
    v_cvt_pk_bf16_f32 v111, v30, v31
    v_mfma_f32_32x32x16_bf16 v[48:63], a[128:131], a[16:19], v[48:63]
    buffer_store_dwordx2 v[110:111], v99, s[44:47], s9 offen sc1
    v_cvt_pk_bf16_f32 v112, v32, v33
    v_cvt_pk_bf16_f32 v113, v34, v35
    v_mfma_f32_32x32x16_bf16 v[48:63], a[132:135], a[20:23], v[48:63]
    buffer_store_dwordx2 v[112:113], v100, s[44:47], s9 offen sc1
    v_cvt_pk_bf16_f32 v114, v36, v37
    v_cvt_pk_bf16_f32 v115, v38, v39
    buffer_store_dwordx2 v[114:115], v101, s[44:47], s9 offen sc1
    v_mfma_f32_32x32x16_bf16 v[48:63], a[136:139], a[24:27], v[48:63]
    v_cvt_pk_bf16_f32 v116, v40, v41
    v_cvt_pk_bf16_f32 v117, v42, v43
    buffer_store_dwordx2 v[116:117], v102, s[44:47], s9 offen sc1
    v_mfma_f32_32x32x16_bf16 v[48:63], a[140:143], a[28:31], v[48:63]
    v_cvt_pk_bf16_f32 v118, v44, v45
    v_cvt_pk_bf16_f32 v119, v46, v47
    buffer_store_dwordx2 v[118:119], v103, s[44:47], s9 offen sc1
    v_mfma_f32_32x32x16_bf16 v[48:63], a[144:147], a[32:35], v[48:63]
    v_mfma_f32_32x32x16_bf16 v[48:63], a[148:151], a[36:39], v[48:63]
    v_mfma_f32_32x32x16_bf16 v[48:63], a[152:155], a[40:43], v[48:63]
    v_mfma_f32_32x32x16_bf16 v[48:63], a[156:159], a[44:47], v[48:63]
    v_mfma_f32_32x32x16_bf16 v[48:63], a[160:163], a[48:51], v[48:63]
    v_mfma_f32_32x32x16_bf16 v[48:63], a[164:167], a[52:55], v[48:63]
    v_mfma_f32_32x32x16_bf16 v[48:63], a[168:171], a[56:59], v[48:63]
    v_mfma_f32_32x32x16_bf16 v[48:63], a[172:175], a[60:63], v[48:63]
    v_mfma_f32_32x32x16_bf16 v[48:63], a[176:179], a[64:67], v[48:63]
    v_mfma_f32_32x32x16_bf16 v[48:63], a[180:183], a[68:71], v[48:63]
    v_mfma_f32_32x32x16_bf16 v[48:63], a[184:187], a[72:75], v[48:63]
    v_mfma_f32_32x32x16_bf16 v[48:63], a[188:191], a[76:79], v[48:63]
    v_mfma_f32_32x32x16_bf16 v[48:63], a[192:195], a[80:83], v[48:63]
    v_mfma_f32_32x32x16_bf16 v[48:63], a[196:199], a[84:87], v[48:63]
    v_mfma_f32_32x32x16_bf16 v[48:63], a[200:203], a[88:91], v[48:63]
    v_mfma_f32_32x32x16_bf16 v[48:63], a[204:207], a[92:95], v[48:63]
    v_mfma_f32_32x32x16_bf16 v[48:63], a[208:211], a[96:99], v[48:63]
    s_waitcnt vmcnt(0)
    v_mov_b32 v7, s54
    s_mov_b64 exec, 1
    buffer_store_dword v7, off, s[44:47], s10 sc1
    s_mov_b64 exec, -1
    v_mfma_f32_32x32x16_bf16 v[48:63], a[212:215], a[100:103], v[48:63]
    v_mfma_f32_32x32x16_bf16 v[48:63], a[216:219], a[104:107], v[48:63]
    v_mfma_f32_32x32x16_bf16 v[48:63], a[220:223], a[108:111], v[48:63]
    s_barrier
    s_mov_b32 exec_lo, 0x00010001
    s_mov_b32 exec_hi, 0x00010001
    buffer_load_dword v127, v96, s[44:47], s9 offen sc1
    buffer_load_dword v127, v97, s[44:47], s9 offen sc1
    buffer_load_dword v127, v98, s[44:47], s9 offen sc1
    buffer_load_dword v127, v99, s[44:47], s9 offen sc1
    buffer_load_dword v127, v100, s[44:47], s9 offen sc1
    buffer_load_dword v127, v101, s[44:47], s9 offen sc1
    buffer_load_dword v127, v102, s[44:47], s9 offen sc1
    buffer_load_dword v127, v103, s[44:47], s9 offen sc1
    s_mov_b64 exec, -1
    s_branch L_p1_done
L_p1_v:
    buffer_load_dword v120, v11, s[44:47], s8 offen offset:0 sc1
    ds_read_b64_tr_b16 a[112:113], v10 offset:0
    ds_read_b64_tr_b16 a[114:115], v10 offset:256
    ds_read_b64_tr_b16 a[116:117], v10 offset:1024
    ds_read_b64_tr_b16 a[118:119], v10 offset:1280
    ds_read_b64_tr_b16 a[120:121], v10 offset:2048
    ds_read_b64_tr_b16 a[122:123], v10 offset:2304
    ds_read_b64_tr_b16 a[124:125], v10 offset:3072
    ds_read_b64_tr_b16 a[126:127], v10 offset:3328
    ds_read_b64_tr_b16 a[128:129], v10 offset:4096
    ds_read_b64_tr_b16 a[130:131], v10 offset:4352
    ds_read_b64_tr_b16 a[132:133], v10 offset:5120
    ds_read_b64_tr_b16 a[134:135], v10 offset:5376
    ds_read_b64_tr_b16 a[136:137], v10 offset:6144
    ds_read_b64_tr_b16 a[138:139], v10 offset:6400
    ds_read_b64_tr_b16 a[140:141], v10 offset:7168
    ds_read_b64_tr_b16 a[142:143], v10 offset:7424
    ds_read_b64_tr_b16 a[144:145], v10 offset:8192
    ds_read_b64_tr_b16 a[146:147], v10 offset:8448
    ds_read_b64_tr_b16 a[148:149], v10 offset:9216
    ds_read_b64_tr_b16 a[150:151], v10 offset:9472
    ds_read_b64_tr_b16 a[152:153], v10 offset:10240
    ds_read_b64_tr_b16 a[154:155], v10 offset:10496
    ds_read_b64_tr_b16 a[156:157], v10 offset:11264
    ds_read_b64_tr_b16 a[158:159], v10 offset:11520
    ds_read_b64_tr_b16 a[160:161], v10 offset:12288
    ds_read_b64_tr_b16 a[162:163], v10 offset:12544
    ds_read_b64_tr_b16 a[164:165], v10 offset:13312
    ds_read_b64_tr_b16 a[166:167], v10 offset:13568
    ds_read_b64_tr_b16 a[168:169], v10 offset:14336
    ds_read_b64_tr_b16 a[170:171], v10 offset:14592
    ds_read_b64_tr_b16 a[172:173], v10 offset:15360
    ds_read_b64_tr_b16 a[174:175], v10 offset:15616
    ds_read_b64_tr_b16 a[176:177], v10 offset:16384
    ds_read_b64_tr_b16 a[178:179], v10 offset:16640
    ds_read_b64_tr_b16 a[180:181], v10 offset:17408
    ds_read_b64_tr_b16 a[182:183], v10 offset:17664
    ds_read_b64_tr_b16 a[184:185], v10 offset:18432
    ds_read_b64_tr_b16 a[186:187], v10 offset:18688
    ds_read_b64_tr_b16 a[188:189], v10 offset:19456
    ds_read_b64_tr_b16 a[190:191], v10 offset:19712
    ds_read_b64_tr_b16 a[192:193], v10 offset:20480
    ds_read_b64_tr_b16 a[194:195], v10 offset:20736
    ds_read_b64_tr_b16 a[196:197], v10 offset:21504
    ds_read_b64_tr_b16 a[198:199], v10 offset:21760
    ds_read_b64_tr_b16 a[200:201], v10 offset:22528
    ds_read_b64_tr_b16 a[202:203], v10 offset:22784
    ds_read_b64_tr_b16 a[204:205], v10 offset:23552
    ds_read_b64_tr_b16 a[206:207], v10 offset:23808
    ds_read_b64_tr_b16 a[208:209], v10 offset:24576
    ds_read_b64_tr_b16 a[210:211], v10 offset:24832
    ds_read_b64_tr_b16 a[212:213], v10 offset:25600
    ds_read_b64_tr_b16 a[214:215], v10 offset:25856
    ds_read_b64_tr_b16 a[216:217], v10 offset:26624
    ds_read_b64_tr_b16 a[218:219], v10 offset:26880
    ds_read_b64_tr_b16 a[220:221], v10 offset:27648
    ds_read_b64_tr_b16 a[222:223], v10 offset:27904
    ds_read_b64_tr_b16 a[224:225], v8 offset:0
    ds_read_b64_tr_b16 a[226:227], v8 offset:512
    ds_read_b64_tr_b16 a[228:229], v9 offset:0
    ds_read_b64_tr_b16 a[230:231], v9 offset:512
    ds_read_b64_tr_b16 a[232:233], v8 offset:2048
    ds_read_b64_tr_b16 a[234:235], v8 offset:2560
    ds_read_b64_tr_b16 a[236:237], v9 offset:2048
    ds_read_b64_tr_b16 a[238:239], v9 offset:2560
    ds_read_b64_tr_b16 a[240:241], v8 offset:4096
    ds_read_b64_tr_b16 a[242:243], v8 offset:4608
    ds_read_b64_tr_b16 a[244:245], v9 offset:4096
    ds_read_b64_tr_b16 a[246:247], v9 offset:4608
    s_waitcnt vmcnt(0)
    v_cmp_ne_u32 vcc, s54, v120
    s_cbranch_vccz L_chkd_9
    s_mov_b32 s63, 0
L_chk_8:
    buffer_load_dword v120, v11, s[44:47], s8 offen offset:0 sc1
    s_add_u32 s63, s63, 1
    s_cmp_ge_u32 s63, 131072
    s_waitcnt vmcnt(0)
    s_cbranch_scc1 L_chkd_9
    v_cmp_ne_u32 vcc, s54, v120
    s_cbranch_vccnz L_chk_8
L_chkd_9:
    s_cmp_lg_u32 s55, 0
    s_cbranch_scc1 L_acq_10
    buffer_inv sc1
    s_waitcnt vmcnt(0)
L_acq_10:
    buffer_load_dwordx4 a[0:3], v1, s[44:47], s11 offen offset:0 sc1
    buffer_load_dwordx4 a[4:7], v1, s[44:47], s11 offen offset:1024 sc1
    buffer_load_dwordx4 a[8:11], v1, s[44:47], s11 offen offset:2048 sc1
    buffer_load_dwordx4 a[12:15], v1, s[44:47], s11 offen offset:3072 sc1
    s_add_u32 s11, s11, 4096
    buffer_load_dwordx4 a[16:19], v1, s[44:47], s11 offen offset:0 sc1
    buffer_load_dwordx4 a[20:23], v1, s[44:47], s11 offen offset:1024 sc1
    buffer_load_dwordx4 a[24:27], v1, s[44:47], s11 offen offset:2048 sc1
    buffer_load_dwordx4 a[28:31], v1, s[44:47], s11 offen offset:3072 sc1
    s_waitcnt vmcnt(7) lgkmcnt(8)
    v_mfma_f32_32x32x16_bf16 v[16:31], a[0:3], a[224:227], 0
    s_add_u32 s11, s11, 4096
    buffer_load_dwordx4 a[32:35], v1, s[44:47], s11 offen offset:0 sc1
    ds_read_b64_tr_b16 a[248:249], v8 offset:6144
    ds_read_b64_tr_b16 a[250:251], v8 offset:6656
    v_mfma_f32_32x32x16_bf16 v[32:47], a[0:3], a[228:231], 0
    ds_read_b64_tr_b16 a[252:253], v9 offset:6144
    ds_read_b64_tr_b16 a[254:255], v9 offset:6656
    s_waitcnt vmcnt(7) lgkmcnt(8)
    v_mfma_f32_32x32x16_bf16 v[16:31], a[4:7], a[232:235], v[16:31]
    buffer_load_dwordx4 a[36:39], v1, s[44:47], s11 offen offset:1024 sc1
    ds_read_b64_tr_b16 a[224:225], v8 offset:8192
    ds_read_b64_tr_b16 a[226:227], v8 offset:8704
    v_mfma_f32_32x32x16_bf16 v[32:47], a[4:7], a[236:239], v[32:47]
    ds_read_b64_tr_b16 a[228:229], v9 offset:8192
    ds_read_b64_tr_b16 a[230:231], v9 offset:8704
    s_waitcnt vmcnt(7) lgkmcnt(8)
    v_mfma_f32_32x32x16_bf16 v[16:31], a[8:11], a[240:243], v[16:31]
    buffer_load_dwordx4 a[40:43], v1, s[44:47], s11 offen offset:2048 sc1
    ds_read_b64_tr_b16 a[232:233], v8 offset:10240
    ds_read_b64_tr_b16 a[234:235], v8 offset:10752
    v_mfma_f32_32x32x16_bf16 v[32:47], a[8:11], a[244:247], v[32:47]
    ds_read_b64_tr_b16 a[236:237], v9 offset:10240
    ds_read_b64_tr_b16 a[238:239], v9 offset:10752
    s_waitcnt vmcnt(7) lgkmcnt(8)
    v_mfma_f32_32x32x16_bf16 v[16:31], a[12:15], a[248:251], v[16:31]
    buffer_load_dwordx4 a[44:47], v1, s[44:47], s11 offen offset:3072 sc1
    ds_read_b64_tr_b16 a[240:241], v8 offset:12288
    ds_read_b64_tr_b16 a[242:243], v8 offset:12800
    v_mfma_f32_32x32x16_bf16 v[32:47], a[12:15], a[252:255], v[32:47]
    ds_read_b64_tr_b16 a[244:245], v9 offset:12288
    ds_read_b64_tr_b16 a[246:247], v9 offset:12800
    s_waitcnt vmcnt(7) lgkmcnt(8)
    v_mfma_f32_32x32x16_bf16 v[16:31], a[16:19], a[224:227], v[16:31]
    s_add_u32 s11, s11, 4096
    buffer_load_dwordx4 a[48:51], v1, s[44:47], s11 offen offset:0 sc1
    ds_read_b64_tr_b16 a[248:249], v8 offset:14336
    ds_read_b64_tr_b16 a[250:251], v8 offset:14848
    v_mfma_f32_32x32x16_bf16 v[32:47], a[16:19], a[228:231], v[32:47]
    ds_read_b64_tr_b16 a[252:253], v9 offset:14336
    ds_read_b64_tr_b16 a[254:255], v9 offset:14848
    s_waitcnt vmcnt(7) lgkmcnt(8)
    v_mfma_f32_32x32x16_bf16 v[16:31], a[20:23], a[232:235], v[16:31]
    buffer_load_dwordx4 a[52:55], v1, s[44:47], s11 offen offset:1024 sc1
    ds_read_b64_tr_b16 a[224:225], v8 offset:16384
    ds_read_b64_tr_b16 a[226:227], v8 offset:16896
    v_mfma_f32_32x32x16_bf16 v[32:47], a[20:23], a[236:239], v[32:47]
    ds_read_b64_tr_b16 a[228:229], v9 offset:16384
    ds_read_b64_tr_b16 a[230:231], v9 offset:16896
    s_waitcnt vmcnt(7) lgkmcnt(8)
    v_mfma_f32_32x32x16_bf16 v[16:31], a[24:27], a[240:243], v[16:31]
    buffer_load_dwordx4 a[56:59], v1, s[44:47], s11 offen offset:2048 sc1
    ds_read_b64_tr_b16 a[232:233], v8 offset:18432
    ds_read_b64_tr_b16 a[234:235], v8 offset:18944
    v_mfma_f32_32x32x16_bf16 v[32:47], a[24:27], a[244:247], v[32:47]
    ds_read_b64_tr_b16 a[236:237], v9 offset:18432
    ds_read_b64_tr_b16 a[238:239], v9 offset:18944
    s_waitcnt vmcnt(7) lgkmcnt(8)
    v_mfma_f32_32x32x16_bf16 v[16:31], a[28:31], a[248:251], v[16:31]
    buffer_load_dwordx4 a[60:63], v1, s[44:47], s11 offen offset:3072 sc1
    ds_read_b64_tr_b16 a[240:241], v8 offset:20480
    ds_read_b64_tr_b16 a[242:243], v8 offset:20992
    v_mfma_f32_32x32x16_bf16 v[32:47], a[28:31], a[252:255], v[32:47]
    ds_read_b64_tr_b16 a[244:245], v9 offset:20480
    ds_read_b64_tr_b16 a[246:247], v9 offset:20992
    s_waitcnt vmcnt(7) lgkmcnt(8)
    v_mfma_f32_32x32x16_bf16 v[16:31], a[32:35], a[224:227], v[16:31]
    s_add_u32 s11, s11, 4096
    buffer_load_dwordx4 a[64:67], v1, s[44:47], s11 offen offset:0 sc1
    ds_read_b64_tr_b16 a[248:249], v8 offset:22528
    ds_read_b64_tr_b16 a[250:251], v8 offset:23040
    v_mfma_f32_32x32x16_bf16 v[32:47], a[32:35], a[228:231], v[32:47]
    ds_read_b64_tr_b16 a[252:253], v9 offset:22528
    ds_read_b64_tr_b16 a[254:255], v9 offset:23040
    s_waitcnt vmcnt(7) lgkmcnt(8)
    v_mfma_f32_32x32x16_bf16 v[16:31], a[36:39], a[232:235], v[16:31]
    buffer_load_dwordx4 a[68:71], v1, s[44:47], s11 offen offset:1024 sc1
    ds_read_b64_tr_b16 a[224:225], v8 offset:24576
    ds_read_b64_tr_b16 a[226:227], v8 offset:25088
    v_mfma_f32_32x32x16_bf16 v[32:47], a[36:39], a[236:239], v[32:47]
    ds_read_b64_tr_b16 a[228:229], v9 offset:24576
    ds_read_b64_tr_b16 a[230:231], v9 offset:25088
    s_waitcnt vmcnt(7) lgkmcnt(8)
    v_mfma_f32_32x32x16_bf16 v[16:31], a[40:43], a[240:243], v[16:31]
    buffer_load_dwordx4 a[72:75], v1, s[44:47], s11 offen offset:2048 sc1
    ds_read_b64_tr_b16 a[232:233], v8 offset:26624
    ds_read_b64_tr_b16 a[234:235], v8 offset:27136
    v_mfma_f32_32x32x16_bf16 v[32:47], a[40:43], a[244:247], v[32:47]
    ds_read_b64_tr_b16 a[236:237], v9 offset:26624
    ds_read_b64_tr_b16 a[238:239], v9 offset:27136
    s_waitcnt vmcnt(7) lgkmcnt(8)
    v_mfma_f32_32x32x16_bf16 v[16:31], a[44:47], a[248:251], v[16:31]
    buffer_load_dwordx4 a[76:79], v1, s[44:47], s11 offen offset:3072 sc1
    ds_read_b64_tr_b16 a[240:241], v8 offset:28672
    ds_read_b64_tr_b16 a[242:243], v8 offset:29184
    v_mfma_f32_32x32x16_bf16 v[32:47], a[44:47], a[252:255], v[32:47]
    ds_read_b64_tr_b16 a[244:245], v9 offset:28672
    ds_read_b64_tr_b16 a[246:247], v9 offset:29184
    s_waitcnt vmcnt(7) lgkmcnt(8)
    v_mfma_f32_32x32x16_bf16 v[16:31], a[48:51], a[224:227], v[16:31]
    s_add_u32 s11, s11, 4096
    buffer_load_dwordx4 a[80:83], v1, s[44:47], s11 offen offset:0 sc1
    ds_read_b64_tr_b16 a[248:249], v8 offset:30720
    ds_read_b64_tr_b16 a[250:251], v8 offset:31232
    v_mfma_f32_32x32x16_bf16 v[32:47], a[48:51], a[228:231], v[32:47]
    ds_read_b64_tr_b16 a[252:253], v9 offset:30720
    ds_read_b64_tr_b16 a[254:255], v9 offset:31232
    s_waitcnt vmcnt(7) lgkmcnt(8)
    v_mfma_f32_32x32x16_bf16 v[16:31], a[52:55], a[232:235], v[16:31]
    buffer_load_dwordx4 a[84:87], v1, s[44:47], s11 offen offset:1024 sc1
    ds_read_b64_tr_b16 a[224:225], v8 offset:32768
    ds_read_b64_tr_b16 a[226:227], v8 offset:33280
    v_mfma_f32_32x32x16_bf16 v[32:47], a[52:55], a[236:239], v[32:47]
    ds_read_b64_tr_b16 a[228:229], v9 offset:32768
    ds_read_b64_tr_b16 a[230:231], v9 offset:33280
    s_waitcnt vmcnt(7) lgkmcnt(8)
    v_mfma_f32_32x32x16_bf16 v[16:31], a[56:59], a[240:243], v[16:31]
    buffer_load_dwordx4 a[88:91], v1, s[44:47], s11 offen offset:2048 sc1
    ds_read_b64_tr_b16 a[232:233], v8 offset:34816
    ds_read_b64_tr_b16 a[234:235], v8 offset:35328
    v_mfma_f32_32x32x16_bf16 v[32:47], a[56:59], a[244:247], v[32:47]
    ds_read_b64_tr_b16 a[236:237], v9 offset:34816
    ds_read_b64_tr_b16 a[238:239], v9 offset:35328
    s_waitcnt vmcnt(7) lgkmcnt(8)
    v_mfma_f32_32x32x16_bf16 v[16:31], a[60:63], a[248:251], v[16:31]
    buffer_load_dwordx4 a[92:95], v1, s[44:47], s11 offen offset:3072 sc1
    ds_read_b64_tr_b16 a[240:241], v8 offset:36864
    ds_read_b64_tr_b16 a[242:243], v8 offset:37376
    v_mfma_f32_32x32x16_bf16 v[32:47], a[60:63], a[252:255], v[32:47]
    ds_read_b64_tr_b16 a[244:245], v9 offset:36864
    ds_read_b64_tr_b16 a[246:247], v9 offset:37376
    s_waitcnt vmcnt(7) lgkmcnt(8)
    v_mfma_f32_32x32x16_bf16 v[16:31], a[64:67], a[224:227], v[16:31]
    s_add_u32 s11, s11, 4096
    buffer_load_dwordx4 a[96:99], v1, s[44:47], s11 offen offset:0 sc1
    ds_read_b64_tr_b16 a[248:249], v8 offset:38912
    ds_read_b64_tr_b16 a[250:251], v8 offset:39424
    v_mfma_f32_32x32x16_bf16 v[32:47], a[64:67], a[228:231], v[32:47]
    ds_read_b64_tr_b16 a[252:253], v9 offset:38912
    ds_read_b64_tr_b16 a[254:255], v9 offset:39424
    s_waitcnt vmcnt(7) lgkmcnt(8)
    v_mfma_f32_32x32x16_bf16 v[16:31], a[68:71], a[232:235], v[16:31]
    buffer_load_dwordx4 a[100:103], v1, s[44:47], s11 offen offset:1024 sc1
    ds_read_b64_tr_b16 a[224:225], v8 offset:40960
    ds_read_b64_tr_b16 a[226:227], v8 offset:41472
    v_mfma_f32_32x32x16_bf16 v[32:47], a[68:71], a[236:239], v[32:47]
    ds_read_b64_tr_b16 a[228:229], v9 offset:40960
    ds_read_b64_tr_b16 a[230:231], v9 offset:41472
    s_waitcnt vmcnt(7) lgkmcnt(8)
    v_mfma_f32_32x32x16_bf16 v[16:31], a[72:75], a[240:243], v[16:31]
    buffer_load_dwordx4 a[104:107], v1, s[44:47], s11 offen offset:2048 sc1
    ds_read_b64_tr_b16 a[232:233], v8 offset:43008
    ds_read_b64_tr_b16 a[234:235], v8 offset:43520
    v_mfma_f32_32x32x16_bf16 v[32:47], a[72:75], a[244:247], v[32:47]
    ds_read_b64_tr_b16 a[236:237], v9 offset:43008
    ds_read_b64_tr_b16 a[238:239], v9 offset:43520
    s_waitcnt vmcnt(7) lgkmcnt(8)
    v_mfma_f32_32x32x16_bf16 v[16:31], a[76:79], a[248:251], v[16:31]
    buffer_load_dwordx4 a[108:111], v1, s[44:47], s11 offen offset:3072 sc1
    ds_read_b64_tr_b16 a[240:241], v8 offset:45056
    ds_read_b64_tr_b16 a[242:243], v8 offset:45568
    v_mfma_f32_32x32x16_bf16 v[32:47], a[76:79], a[252:255], v[32:47]
    ds_read_b64_tr_b16 a[244:245], v9 offset:45056
    ds_read_b64_tr_b16 a[246:247], v9 offset:45568
    s_waitcnt vmcnt(7) lgkmcnt(8)
    v_mfma_f32_32x32x16_bf16 v[16:31], a[80:83], a[224:227], v[16:31]
    ds_read_b64_tr_b16 a[248:249], v8 offset:47104
    ds_read_b64_tr_b16 a[250:251], v8 offset:47616
    v_mfma_f32_32x32x16_bf16 v[32:47], a[80:83], a[228:231], v[32:47]
    ds_read_b64_tr_b16 a[252:253], v9 offset:47104
    ds_read_b64_tr_b16 a[254:255], v9 offset:47616
    s_waitcnt vmcnt(6) lgkmcnt(8)
    v_mfma_f32_32x32x16_bf16 v[16:31], a[84:87], a[232:235], v[16:31]
    ds_read_b64_tr_b16 a[224:225], v8 offset:49152
    ds_read_b64_tr_b16 a[226:227], v8 offset:49664
    v_mfma_f32_32x32x16_bf16 v[32:47], a[84:87], a[236:239], v[32:47]
    ds_read_b64_tr_b16 a[228:229], v9 offset:49152
    ds_read_b64_tr_b16 a[230:231], v9 offset:49664
    s_waitcnt vmcnt(5) lgkmcnt(8)
    v_mfma_f32_32x32x16_bf16 v[16:31], a[88:91], a[240:243], v[16:31]
    ds_read_b64_tr_b16 a[232:233], v8 offset:51200
    ds_read_b64_tr_b16 a[234:235], v8 offset:51712
    v_mfma_f32_32x32x16_bf16 v[32:47], a[88:91], a[244:247], v[32:47]
    ds_read_b64_tr_b16 a[236:237], v9 offset:51200
    ds_read_b64_tr_b16 a[238:239], v9 offset:51712
    s_waitcnt vmcnt(4) lgkmcnt(8)
    v_mfma_f32_32x32x16_bf16 v[16:31], a[92:95], a[248:251], v[16:31]
    ds_read_b64_tr_b16 a[240:241], v8 offset:53248
    ds_read_b64_tr_b16 a[242:243], v8 offset:53760
    v_mfma_f32_32x32x16_bf16 v[32:47], a[92:95], a[252:255], v[32:47]
    ds_read_b64_tr_b16 a[244:245], v9 offset:53248
    ds_read_b64_tr_b16 a[246:247], v9 offset:53760
    s_waitcnt vmcnt(3) lgkmcnt(8)
    v_mfma_f32_32x32x16_bf16 v[16:31], a[96:99], a[224:227], v[16:31]
    ds_read_b64_tr_b16 a[248:249], v8 offset:55296
    ds_read_b64_tr_b16 a[250:251], v8 offset:55808
    v_mfma_f32_32x32x16_bf16 v[32:47], a[96:99], a[228:231], v[32:47]
    ds_read_b64_tr_b16 a[252:253], v9 offset:55296
    ds_read_b64_tr_b16 a[254:255], v9 offset:55808
    s_waitcnt vmcnt(2) lgkmcnt(8)
    v_mfma_f32_32x32x16_bf16 v[16:31], a[100:103], a[232:235], v[16:31]
    v_mfma_f32_32x32x16_bf16 v[32:47], a[100:103], a[236:239], v[32:47]
    s_waitcnt vmcnt(1) lgkmcnt(4)
    v_mfma_f32_32x32x16_bf16 v[16:31], a[104:107], a[240:243], v[16:31]
    v_mfma_f32_32x32x16_bf16 v[32:47], a[104:107], a[244:247], v[32:47]
    s_waitcnt vmcnt(0) lgkmcnt(0)
    v_mfma_f32_32x32x16_bf16 v[16:31], a[108:111], a[248:251], v[16:31]
    v_mfma_f32_32x32x16_bf16 v[32:47], a[108:111], a[252:255], v[32:47]
    v_mfma_f32_32x32x16_bf16 v[48:63], a[112:115], a[0:3], 0
    v_mfma_f32_32x32x16_bf16 v[48:63], a[116:119], a[4:7], v[48:63]
    s_nop 8
    v_cvt_pk_bf16_f32 v104, v16, v17
    v_cvt_pk_bf16_f32 v105, v18, v19
    v_cvt_pk_bf16_f32 v106, v20, v21
    v_mfma_f32_32x32x16_bf16 v[48:63], a[120:123], a[8:11], v[48:63]
    v_cvt_pk_bf16_f32 v107, v22, v23
    buffer_store_dwordx4 v[104:107], v96, s[44:47], s9 offen offset:0 sc1
    v_cvt_pk_bf16_f32 v108, v24, v25
    v_mfma_f32_32x32x16_bf16 v[48:63], a[124:127], a[12:15], v[48:63]
    v_cvt_pk_bf16_f32 v109, v26, v27
    v_cvt_pk_bf16_f32 v110, v28, v29
    v_cvt_pk_bf16_f32 v111, v30, v31
    v_mfma_f32_32x32x16_bf16 v[48:63], a[128:131], a[16:19], v[48:63]
    buffer_store_dwordx4 v[108:111], v96, s[44:47], s9 offen offset:1024 sc1
    v_cvt_pk_bf16_f32 v112, v32, v33
    v_cvt_pk_bf16_f32 v113, v34, v35
    v_mfma_f32_32x32x16_bf16 v[48:63], a[132:135], a[20:23], v[48:63]
    v_cvt_pk_bf16_f32 v114, v36, v37
    v_cvt_pk_bf16_f32 v115, v38, v39
    buffer_store_dwordx4 v[112:115], v97, s[44:47], s9 offen offset:0 sc1
    v_mfma_f32_32x32x16_bf16 v[48:63], a[136:139], a[24:27], v[48:63]
    v_cvt_pk_bf16_f32 v116, v40, v41
    v_cvt_pk_bf16_f32 v117, v42, v43
    v_cvt_pk_bf16_f32 v118, v44, v45
    v_mfma_f32_32x32x16_bf16 v[48:63], a[140:143], a[28:31], v[48:63]
    v_cvt_pk_bf16_f32 v119, v46, v47
    buffer_store_dwordx4 v[116:119], v97, s[44:47], s9 offen offset:1024 sc1
    v_mfma_f32_32x32x16_bf16 v[48:63], a[144:147], a[32:35], v[48:63]
    v_mfma_f32_32x32x16_bf16 v[48:63], a[148:151], a[36:39], v[48:63]
    v_mfma_f32_32x32x16_bf16 v[48:63], a[152:155], a[40:43], v[48:63]
    v_mfma_f32_32x32x16_bf16 v[48:63], a[156:159], a[44:47], v[48:63]
    v_mfma_f32_32x32x16_bf16 v[48:63], a[160:163], a[48:51], v[48:63]
    v_mfma_f32_32x32x16_bf16 v[48:63], a[164:167], a[52:55], v[48:63]
    v_mfma_f32_32x32x16_bf16 v[48:63], a[168:171], a[56:59], v[48:63]
    v_mfma_f32_32x32x16_bf16 v[48:63], a[172:175], a[60:63], v[48:63]
    v_mfma_f32_32x32x16_bf16 v[48:63], a[176:179], a[64:67], v[48:63]
    v_mfma_f32_32x32x16_bf16 v[48:63], a[180:183], a[68:71], v[48:63]
    v_mfma_f32_32x32x16_bf16 v[48:63], a[184:187], a[72:75], v[48:63]
    v_mfma_f32_32x32x16_bf16 v[48:63], a[188:191], a[76:79], v[48:63]
    v_mfma_f32_32x32x16_bf16 v[48:63], a[192:195], a[80:83], v[48:63]
    v_mfma_f32_32x32x16_bf16 v[48:63], a[196:199], a[84:87], v[48:63]
    v_mfma_f32_32x32x16_bf16 v[48:63], a[200:203], a[88:91], v[48:63]
    v_mfma_f32_32x32x16_bf16 v[48:63], a[204:207], a[92:95], v[48:63]
    v_mfma_f32_32x32x16_bf16 v[48:63], a[208:211], a[96:99], v[48:63]
    s_waitcnt vmcnt(0)
    v_mov_b32 v7, s54
    s_mov_b64 exec, 1
    buffer_store_dword v7, off, s[44:47], s10 sc1
    s_mov_b64 exec, -1
    v_mfma_f32_32x32x16_bf16 v[48:63], a[212:215], a[100:103], v[48:63]
    v_mfma_f32_32x32x16_bf16 v[48:63], a[216:219], a[104:107], v[48:63]
    v_mfma_f32_32x32x16_bf16 v[48:63], a[220:223], a[108:111], v[48:63]
    s_barrier
    s_mov_b32 exec_lo, 0x91111111
    s_mov_b32 exec_hi, 0x91111111
    buffer_load_dword v127, v96, s[44:47], s9 offen offset:0 sc1
    buffer_load_dword v127, v96, s[44:47], s9 offen offset:1024 sc1
    buffer_load_dword v127, v97, s[44:47], s9 offen offset:0 sc1
    buffer_load_dword v127, v97, s[44:47], s9 offen offset:1024 sc1
    s_mov_b64 exec, -1
    s_branch L_p1_done
L_p1_h:
    s_mov_b32 s63, 0
L_poll_11:
    buffer_load_dword v5, v11, s[44:47], s8 offen offset:0 sc1
    s_add_u32 s63, s63, 1
    s_cmp_ge_u32 s63, 131072
    s_waitcnt vmcnt(0)
    s_cbranch_scc1 L_polled_12
    v_cmp_ne_u32 vcc, s54, v5
    s_cbranch_vccnz L_poll_11
L_polled_12:
    s_cmp_lg_u32 s55, 0
    s_cbranch_scc1 L_acq_13
    buffer_inv sc1
    s_waitcnt vmcnt(0)
L_acq_13:
    buffer_load_dwordx4 a[0:3], v1, s[44:47], s11 offen offset:0 sc1
    ds_read_b64_tr_b16 a[112:113], v10 offset:0
    ds_read_b64_tr_b16 a[114:115], v10 offset:256
    buffer_load_dwordx4 a[4:7], v1, s[44:47], s11 offen offset:1024 sc1
    ds_read_b64_tr_b16 a[116:117], v10 offset:1024
    ds_read_b64_tr_b16 a[118:119], v10 offset:1280
    buffer_load_dwordx4 a[8:11], v1, s[44:47], s11 offen offset:2048 sc1
    ds_read_b64_tr_b16 a[120:121], v10 offset:2048
    ds_read_b64_tr_b16 a[122:123], v10 offset:2304
    buffer_load_dwordx4 a[12:15], v1, s[44:47], s11 offen offset:3072 sc1
    ds_read_b64_tr_b16 a[124:125], v10 offset:3072
    ds_read_b64_tr_b16 a[126:127], v10 offset:3328
    s_add_u32 s11, s11, 4096
    buffer_load_dwordx4 a[16:19], v1, s[44:47], s11 offen offset:0 sc1
    ds_read_b64_tr_b16 a[128:129], v10 offset:4096
    ds_read_b64_tr_b16 a[130:131], v10 offset:4352
    buffer_load_dwordx4 a[20:23], v1, s[44:47], s11 offen offset:1024 sc1
    ds_read_b64_tr_b16 a[132:133], v10 offset:5120
    ds_read_b64_tr_b16 a[134:135], v10 offset:5376
    buffer_load_dwordx4 a[24:27], v1, s[44:47], s11 offen offset:2048 sc1
    ds_read_b64_tr_b16 a[136:137], v10 offset:6144
    ds_read_b64_tr_b16 a[138:139], v10 offset:6400
    buffer_load_dwordx4 a[28:31], v1, s[44:47], s11 offen offset:3072 sc1
    ds_read_b64_tr_b16 a[140:141], v10 offset:7168
    ds_read_b64_tr_b16 a[142:143], v10 offset:7424
    s_add_u32 s11, s11, 4096
    buffer_load_dwordx4 a[32:35], v1, s[44:47], s11 offen offset:0 sc1
    ds_read_b64_tr_b16 a[144:145], v10 offset:8192
    ds_read_b64_tr_b16 a[146:147], v10 offset:8448
    buffer_load_dwordx4 a[36:39], v1, s[44:47], s11 offen offset:1024 sc1
    ds_read_b64_tr_b16 a[148:149], v10 offset:9216
    ds_read_b64_tr_b16 a[150:151], v10 offset:9472
    buffer_load_dwordx4 a[40:43], v1, s[44:47], s11 offen offset:2048 sc1
    ds_read_b64_tr_b16 a[152:153], v10 offset:10240
    ds_read_b64_tr_b16 a[154:155], v10 offset:10496
    buffer_load_dwordx4 a[44:47], v1, s[44:47], s11 offen offset:3072 sc1
    ds_read_b64_tr_b16 a[156:157], v10 offset:11264
    ds_read_b64_tr_b16 a[158:159], v10 offset:11520
    s_add_u32 s11, s11, 4096
    buffer_load_dwordx4 a[48:51], v1, s[44:47], s11 offen offset:0 sc1
    ds_read_b64_tr_b16 a[160:161], v10 offset:12288
    ds_read_b64_tr_b16 a[162:163], v10 offset:12544
    buffer_load_dwordx4 a[52:55], v1, s[44:47], s11 offen offset:1024 sc1
    ds_read_b64_tr_b16 a[164:165], v10 offset:13312
    ds_read_b64_tr_b16 a[166:167], v10 offset:13568
    buffer_load_dwordx4 a[56:59], v1, s[44:47], s11 offen offset:2048 sc1
    ds_read_b64_tr_b16 a[168:169], v10 offset:14336
    ds_read_b64_tr_b16 a[170:171], v10 offset:14592
    buffer_load_dwordx4 a[60:63], v1, s[44:47], s11 offen offset:3072 sc1
    ds_read_b64_tr_b16 a[172:173], v10 offset:15360
    ds_read_b64_tr_b16 a[174:175], v10 offset:15616
    s_add_u32 s11, s11, 4096
    buffer_load_dwordx4 a[64:67], v1, s[44:47], s11 offen offset:0 sc1
    ds_read_b64_tr_b16 a[176:177], v10 offset:16384
    ds_read_b64_tr_b16 a[178:179], v10 offset:16640
    buffer_load_dwordx4 a[68:71], v1, s[44:47], s11 offen offset:1024 sc1
    ds_read_b64_tr_b16 a[180:181], v10 offset:17408
    ds_read_b64_tr_b16 a[182:183], v10 offset:17664
    buffer_load_dwordx4 a[72:75], v1, s[44:47], s11 offen offset:2048 sc1
    ds_read_b64_tr_b16 a[184:185], v10 offset:18432
    ds_read_b64_tr_b16 a[186:187], v10 offset:18688
    buffer_load_dwordx4 a[76:79], v1, s[44:47], s11 offen offset:3072 sc1
    ds_read_b64_tr_b16 a[188:189], v10 offset:19456
    ds_read_b64_tr_b16 a[190:191], v10 offset:19712
    s_add_u32 s11, s11, 4096
    buffer_load_dwordx4 a[80:83], v1, s[44:47], s11 offen offset:0 sc1
    ds_read_b64_tr_b16 a[192:193], v10 offset:20480
    ds_read_b64_tr_b16 a[194:195], v10 offset:20736
    buffer_load_dwordx4 a[84:87], v1, s[44:47], s11 offen offset:1024 sc1
    ds_read_b64_tr_b16 a[196:197], v10 offset:21504
    ds_read_b64_tr_b16 a[198:199], v10 offset:21760
    buffer_load_dwordx4 a[88:91], v1, s[44:47], s11 offen offset:2048 sc1
    ds_read_b64_tr_b16 a[200:201], v10 offset:22528
    ds_read_b64_tr_b16 a[202:203], v10 offset:22784
    buffer_load_dwordx4 a[92:95], v1, s[44:47], s11 offen offset:3072 sc1
    ds_read_b64_tr_b16 a[204:205], v10 offset:23552
    ds_read_b64_tr_b16 a[206:207], v10 offset:23808
    s_add_u32 s11, s11, 4096
    buffer_load_dwordx4 a[96:99], v1, s[44:47], s11 offen offset:0 sc1
    ds_read_b64_tr_b16 a[208:209], v10 offset:24576
    ds_read_b64_tr_b16 a[210:211], v10 offset:24832
    buffer_load_dwordx4 a[100:103], v1, s[44:47], s11 offen offset:1024 sc1
    ds_read_b64_tr_b16 a[212:213], v10 offset:25600
    ds_read_b64_tr_b16 a[214:215], v10 offset:25856
    buffer_load_dwordx4 a[104:107], v1, s[44:47], s11 offen offset:2048 sc1
    ds_read_b64_tr_b16 a[216:217], v10 offset:26624
    ds_read_b64_tr_b16 a[218:219], v10 offset:26880
    buffer_load_dwordx4 a[108:111], v1, s[44:47], s11 offen offset:3072 sc1
    ds_read_b64_tr_b16 a[220:221], v10 offset:27648
    ds_read_b64_tr_b16 a[222:223], v10 offset:27904
    s_mul_i32 s10, s53, 14
    s_add_u32 s10, s10, s51
    s_lshl_b32 s10, s10, 7
    s_add_u32 s10, s10, 131072
    v_lshrrev_b32 v4, 4, v0
    v_min_u32 v4, 2, v4
    v_cmp_eq_u32 vcc, 1, v4
    v_mul_u32_u24 v5, 168, v4
    s_nop 0
    v_cndmask_b32 v210, 0, 1.0, vcc
    v_cndmask_b32 v6, 0, 56, vcc
    v_add_u32 v5, v5, v6
    v_and_b32 v6, 15, v0
    s_lshl_b32 s56, s62, 4
    s_add_u32 s56, s56, 224
    v_add3_u32 v5, v5, v6, s56
    v_lshlrev_b32 v208, 4, v5
    v_lshl_add_u32 v209, v4, 4, v6
    v_lshlrev_b32 v209, 4, v209
    v_lshrrev_b32 v4, 2, v0
    v_mul_u32_u24 v4, 896, v4
    v_and_b32 v5, 3, v0
    v_lshl_add_u32 v214, v5, 4, v4
    s_lshl_b32 s56, s48, 2
    s_add_u32 s56, s56, s61
    s_lshl_b32 s56, s56, 2
    s_add_u32 s56, s56, s50
    s_mul_i32 s56, s56, 14336
    s_lshl_b32 s57, s62, 7
    s_add_u32 s100, s56, s57
    v_and_b32 v4, 31, v0
    v_lshrrev_b32 v7, 5, v0
    v_lshlrev_b32 v7, 2, v7
    v_sub_u32 v4, v4, v7
    v_mov_b32 v6, 0xffff
    v_mov_b32 v7, 0xffff0000
    v_cmp_le_i32 s[64:65], 0, v4
    v_cmp_le_i32 s[66:67], 1, v4
    v_cmp_le_i32 s[68:69], 2, v4
    v_cmp_le_i32 s[70:71], 3, v4
    v_cmp_le_i32 s[72:73], 8, v4
    v_cmp_le_i32 s[74:75], 9, v4
    v_cmp_le_i32 s[76:77], 10, v4
    v_cmp_le_i32 s[78:79], 11, v4
    v_cmp_le_i32 s[80:81], 16, v4
    v_cmp_le_i32 s[82:83], 17, v4
    v_cmp_le_i32 s[84:85], 18, v4
    v_cmp_le_i32 s[86:87], 19, v4
    v_cmp_le_i32 s[88:89], 24, v4
    v_cmp_le_i32 s[90:91], 25, v4
    v_cmp_le_i32 s[92:93], 26, v4
    v_cmp_le_i32 s[94:95], 27, v4
    v_cndmask_b32 v4, 0, v6, s[64:65]
    v_cndmask_b32 v5, 0, v7, s[66:67]
    v_or_b32 v72, v4, v5
    v_cndmask_b32 v4, 0, v6, s[68:69]
    v_cndmask_b32 v5, 0, v7, s[70:71]
    v_or_b32 v73, v4, v5
    v_cndmask_b32 v4, 0, v6, s[72:73]
    v_cndmask_b32 v5, 0, v7, s[74:75]
    v_or_b32 v74, v4, v5
    v_cndmask_b32 v4, 0, v6, s[76:77]
    v_cndmask_b32 v5, 0, v7, s[78:79]
    v_or_b32 v75, v4, v5
    v_cndmask_b32 v4, 0, v6, s[80:81]
    v_cndmask_b32 v5, 0, v7, s[82:83]
    v_or_b32 v76, v4, v5
    v_cndmask_b32 v4, 0, v6, s[84:85]
    v_cndmask_b32 v5, 0, v7, s[86:87]
    v_or_b32 v77, v4, v5
    v_cndmask_b32 v4, 0, v6, s[88:89]
    v_cndmask_b32 v5, 0, v7, s[90:91]
    v_or_b32 v78, v4, v5
    v_cndmask_b32 v4, 0, v6, s[92:93]
    v_cndmask_b32 v5, 0, v7, s[94:95]
    v_or_b32 v79, v4, v5
    s_mul_i32 s42, s50, 12288
    s_add_u32 s42, s42, 3584
    v_add_u32 v4, 1792, v1
    v_subrev_u32 v5, 16, v0
    v_lshlrev_b32 v5, 9, v5
    v_add_u32 v5, 2496, v5
    v_cmp_gt_u32 vcc, 16, v0
    v_mov_b32 v6, 0x3f803f80
    s_nop 0
    v_cndmask_b32 v4, v5, v4, vcc
    v_cndmask_b32 v196, v6, 0, vcc
    v_add_u32 v201, s42, v4
    v_mov_b32 v197, v196
    v_mov_b32 v198, v196
    v_mov_b32 v199, v196
    s_and_b32 s43, s53, 0xfc
    s_mul_i32 s57, s50, 3
    s_add_u32 s43, s43, s57
    s_sub_u32 s43, s43, 8
    v_bfe_u32 v4, v0, 2, 2
    v_min_u32 v4, 2, v4
    v_add_u32 v4, s43, v4
    v_max_i32 v4, 0, v4
    v_mul_u32_u24 v4, 14, v4
    s_mul_i32 s56, s51, 28
    v_and_b32 v5, 1, v0
    v_mul_u32_u24 v5, 27, v5
    v_add_u32 v5, s56, v5
    v_lshrrev_b32 v5, 6, v5
    v_add_u32 v4, v4, v5
    v_bfe_u32 v5, v0, 1, 1
    v_mul_u32_u24 v5, 7, v5
    v_add_u32 v4, v4, v5
    v_lshlrev_b32 v4, 7, v4
    v_add_u32 v200, 131072, v4
    v_mov_b32 v184, 0
    v_mov_b32 v185, 0
    v_mov_b32 v186, 0
    v_mov_b32 v187, 0
    v_mov_b32 v188, 0
    v_mov_b32 v189, 0
    v_mov_b32 v190, 0
    v_mov_b32 v191, 0
    v_mov_b32 v5, 0x0000f149
    v_cmp_le_u32 vcc, 48, v0
    v_add_u32 v202, s42, v1
    s_nop 0
    v_cndmask_b32 v188, 0, v5, vcc
    v_cndmask_b32 v190, 0, v5, vcc
    s_lshl_b32 s56, s49, 3
    s_add_u32 s56, s56, s48
    s_lshl_b32 s56, s56, 2
    s_add_u32 s56, s56, s50
    s_min_u32 s56, s56, 784
    s_mul_i32 s57, s56, 9363
    s_lshr_b32 s57, s57, 16
    s_mul_i32 s58, s57, 7
    s_sub_u32 s58, s56, s58
    s_mul_i32 s41, s58, 112
    s_add_u32 s41, s41, s57
    s_cmp_ge_u32 s56, 784
    s_cselect_b32 s41, 784, s41
    s_mul_i32 s40, s57, 14336
    s_lshl_b32 s58, s58, 7
    s_add_u32 s40, s40, s58
    v_add_u32 v211, 6144, v14
    v_lshrrev_b32 v212, 5, v0
    v_mul_u32_u24 v212, 4, v212
    v_bfe_u32 v5, v0, 2, 2
    v_add_u32 v212, v212, v5
    v_lshlrev_b32 v212, 7, v212
    v_bfe_u32 v4, v0, 4, 1
    v_lshl_add_u32 v212, v4, 5, v212
    v_and_b32 v4, 3, v0
    v_lshl_add_u32 v212, v4, 3, v212
    v_lshrrev_b32 v5, 1, v5
    v_lshl_add_u32 v212, v5, 6, v212
    s_lshl_b32 s56, s50, 11
    s_add_u32 s56, s56, 52736
    v_add_u32 v212, s56, v212
    v_xor_b32 v213, 64, v212
    s_sub_u32 s60, s49, 28
    s_lshl_b32 s60, s60, 2
    s_add_u32 s60, s60, s50
    v_lshlrev_b32 v6, 7, v0
    s_lshl_b32 s56, s48, 9
    s_add_u32 s56, s56, 8192
    s_mov_b64 exec, 15
    buffer_load_dword v127, v6, s[44:47], s56 offen sc1
    s_add_u32 s56, s56, 4096
    buffer_load_dword v127, v6, s[44:47], s56 offen sc1
    s_lshl_b32 s56, s48, 10
    s_add_u32 s56, s56, 16384
    s_mov_b64 exec, 0xff
    buffer_load_dword v127, v6, s[44:47], s56 offen sc1
    s_mov_b64 exec, -1
    s_waitcnt vmcnt(30) lgkmcnt(15)
    v_mfma_f32_32x32x16_bf16 v[48:63], a[112:115], a[0:3], 0
    s_waitcnt vmcnt(29)
    v_mfma_f32_32x32x16_bf16 v[48:63], a[116:119], a[4:7], v[48:63]
    s_waitcnt vmcnt(28)
    v_mfma_f32_32x32x16_bf16 v[48:63], a[120:123], a[8:11], v[48:63]
    s_waitcnt vmcnt(27)
    v_mfma_f32_32x32x16_bf16 v[48:63], a[124:127], a[12:15], v[48:63]
    s_waitcnt vmcnt(26)
    v_mfma_f32_32x32x16_bf16 v[48:63], a[128:131], a[16:19], v[48:63]
    s_waitcnt vmcnt(25)
    v_mfma_f32_32x32x16_bf16 v[48:63], a[132:135], a[20:23], v[48:63]
    s_waitcnt vmcnt(24)
    v_mfma_f32_32x32x16_bf16 v[48:63], a[136:139], a[24:27], v[48:63]
    s_waitcnt vmcnt(23)
    v_mfma_f32_32x32x16_bf16 v[48:63], a[140:143], a[28:31], v[48:63]
    s_waitcnt vmcnt(22)
    v_mfma_f32_32x32x16_bf16 v[48:63], a[144:147], a[32:35], v[48:63]
    s_waitcnt vmcnt(21)
    v_mfma_f32_32x32x16_bf16 v[48:63], a[148:151], a[36:39], v[48:63]
    s_waitcnt vmcnt(20)
    v_mfma_f32_32x32x16_bf16 v[48:63], a[152:155], a[40:43], v[48:63]
    s_waitcnt vmcnt(19)
    v_mfma_f32_32x32x16_bf16 v[48:63], a[156:159], a[44:47], v[48:63]
    s_waitcnt vmcnt(18)
    v_mfma_f32_32x32x16_bf16 v[48:63], a[160:163], a[48:51], v[48:63]
    s_waitcnt vmcnt(17)
    v_mfma_f32_32x32x16_bf16 v[48:63], a[164:167], a[52:55], v[48:63]
    s_waitcnt vmcnt(16)
    v_mfma_f32_32x32x16_bf16 v[48:63], a[168:171], a[56:59], v[48:63]
    s_waitcnt vmcnt(15)
    v_mfma_f32_32x32x16_bf16 v[48:63], a[172:175], a[60:63], v[48:63]
    s_waitcnt vmcnt(14)
    v_mfma_f32_32x32x16_bf16 v[48:63], a[176:179], a[64:67], v[48:63]
    s_waitcnt vmcnt(13)
    v_mfma_f32_32x32x16_bf16 v[48:63], a[180:183], a[68:71], v[48:63]
    s_waitcnt vmcnt(12)
    v_mfma_f32_32x32x16_bf16 v[48:63], a[184:187], a[72:75], v[48:63]
    s_waitcnt vmcnt(11)
    v_mfma_f32_32x32x16_bf16 v[48:63], a[188:191], a[76:79], v[48:63]
    s_waitcnt vmcnt(10) lgkmcnt(14)
    v_mfma_f32_32x32x16_bf16 v[48:63], a[192:195], a[80:83], v[48:63]
    s_waitcnt vmcnt(9) lgkmcnt(12)
    v_mfma_f32_32x32x16_bf16 v[48:63], a[196:199], a[84:87], v[48:63]
    s_waitcnt vmcnt(8) lgkmcnt(10)
    v_mfma_f32_32x32x16_bf16 v[48:63], a[200:203], a[88:91], v[48:63]
    s_waitcnt vmcnt(7) lgkmcnt(8)
    v_mfma_f32_32x32x16_bf16 v[48:63], a[204:207], a[92:95], v[48:63]
    s_waitcnt vmcnt(6) lgkmcnt(6)
    v_mfma_f32_32x32x16_bf16 v[48:63], a[208:211], a[96:99], v[48:63]
    s_waitcnt vmcnt(5) lgkmcnt(4)
    v_mfma_f32_32x32x16_bf16 v[48:63], a[212:215], a[100:103], v[48:63]
    s_waitcnt vmcnt(4) lgkmcnt(2)
    v_mfma_f32_32x32x16_bf16 v[48:63], a[216:219], a[104:107], v[48:63]
    s_waitcnt vmcnt(3) lgkmcnt(0)
    v_mfma_f32_32x32x16_bf16 v[48:63], a[220:223], a[108:111], v[48:63]
    s_barrier
L_p1_done:
    buffer_load_dwordx4 v[240:243], v214, s[4:7], s100 offen
    buffer_load_dwordx4 v[244:247], v214, s[4:7], s100 offen offset:64
    s_mov_b32 s56, 0x3e8b97f6
    s_nop 7
    v_pk_mul_f32 v[48:49], v[48:49], s[56:57] op_sel_hi:[1,0]
    v_pk_mul_f32 v[50:51], v[50:51], s[56:57] op_sel_hi:[1,0]
    v_pk_mul_f32 v[52:53], v[52:53], s[56:57] op_sel_hi:[1,0]
    v_pk_mul_f32 v[54:55], v[54:55], s[56:57] op_sel_hi:[1,0]
    v_pk_mul_f32 v[56:57], v[56:57], s[56:57] op_sel_hi:[1,0]
    v_pk_mul_f32 v[58:59], v[58:59], s[56:57] op_sel_hi:[1,0]
    v_pk_mul_f32 v[60:61], v[60:61], s[56:57] op_sel_hi:[1,0]
    v_pk_mul_f32 v[62:63], v[62:63], s[56:57] op_sel_hi:[1,0]
    v_cvt_pk_bf16_f32 v64, v48, v49
    v_cvt_pk_bf16_f32 v65, v50, v51
    v_cvt_pk_bf16_f32 v66, v52, v53
    v_cvt_pk_bf16_f32 v67, v54, v55
    v_cvt_pk_bf16_f32 v68, v56, v57
    v_cvt_pk_bf16_f32 v69, v58, v59
    v_cvt_pk_bf16_f32 v70, v60, v61
    v_cvt_pk_bf16_f32 v71, v62, v63
    v_mov_b32 v11, 0x00003f80
    v_cndmask_b32 v70, v70, v11, s[96:97]
    v_cndmask_b32 v71, v71, 0, s[96:97]
    v_lshlrev_b32 v4, 3, v0
    v_add_u32 v4, 163328, v4
    ds_write_b64 v4, v[184:185]
    s_mov_b64 exec, 0xfffff
    ds_write_b128 v201, v[196:199] offset:0
    ds_write_b128 v201, v[196:199] offset:4096
    ds_write_b128 v201, v[196:199] offset:8192
    s_mov_b64 exec, -1
    buffer_load_dword v203, v200, s[44:47], 0 offen offset:0 sc1
    s_lshl_b32 s56, s50, 12
    s_add_u32 s56, s56, 3584
    v_add_u32 v10, s56, v1
    v_lshl_add_u32 v15, v0, 3, s56
    v_lshrrev_b32 v4, 5, v0
    v_lshlrev_b32 v4, 4, v4
    v_bfe_u32 v5, v0, 4, 1
    v_lshl_add_u32 v4, v5, 2, v4
    v_bfe_u32 v6, v0, 2, 2
    v_add_u32 v4, v4, v6
    v_lshlrev_b32 v4, 7, v4
    v_lshrrev_b32 v6, 1, v6
    v_lshl_add_u32 v5, v5, 1, v6
    v_and_b32 v6, 3, v0
    v_lshl_add_u32 v4, v6, 3, v4
    v_add_u32 v4, 105984, v4
    v_xor_b32 v6, 0, v5
    v_lshl_add_u32 v48, v6, 5, v4
    v_xor_b32 v6, 1, v5
    v_lshl_add_u32 v49, v6, 5, v4
    v_xor_b32 v6, 2, v5
    v_lshl_add_u32 v50, v6, 5, v4
    v_xor_b32 v6, 3, v5
    v_lshl_add_u32 v51, v6, 5, v4
    v_and_b32 v4, 15, v0
    v_lshrrev_b32 v5, 4, v0
    v_lshlrev_b32 v52, 4, v4
    v_lshl_add_u32 v52, v5, 9, v52
    v_lshlrev_b32 v6, 7, v4
    v_lshl_add_u32 v6, v5, 3, v6
    s_lshl_b32 s56, s50, 11
    s_add_u32 s56, s56, 122368
    v_add_u32 v53, s56, v6
    v_lshlrev_b32 v54, 2, v4
    v_lshlrev_b32 v55, 4, v5
    s_lshl_b32 s56, s48, 2
    s_add_u32 s33, s56, s61
    s_lshl_b32 s56, s33, 1
    s_lshr_b32 s57, s50, 1
    s_add_u32 s56, s56, s57
    s_mul_i32 s28, s56, 28672
    s_lshl_b32 s57, s62, 12
    s_add_u32 s28, s28, s57
    s_and_b32 s57, s50, 1
    s_lshl_b32 s57, s57, 8
    s_add_u32 s28, s28, s57
    s_add_u32 s28, s28, 1114112
    s_lshl_b32 s31, s56, 6
    s_add_u32 s31, s31, 8192
    s_mul_i32 s29, s33, 7
    s_add_u32 s29, s29, s62
    s_lshl_b32 s29, s29, 10
    s_lshl_b32 s57, s50, 8
    s_add_u32 s29, s29, s57
    s_add_u32 s29, s29, 851968
    s_lshl_b32 s30, s33, 5
    s_lshl_b32 s57, s62, 2
    s_add_u32 s30, s30, s57
    s_add_u32 s30, s30, s50
    s_lshl_b32 s30, s30, 2
    s_add_u32 s30, s30, 12288
    s_lshl_b32 s32, s33, 2
    s_add_u32 s32, s32, s50
    s_lshl_b32 s32, s32, 14
    s_add_u32 s32, s32, 3145728
    ds_read_b64_tr_b16 a[0:1], v48 offset:0
    ds_read_b64_tr_b16 a[2:3], v48 offset:1024
    ds_read_b64_tr_b16 a[4:5], v49 offset:0
    ds_read_b64_tr_b16 a[6:7], v49 offset:1024
    ds_read_b64_tr_b16 a[8:9], v50 offset:0
    ds_read_b64_tr_b16 a[10:11], v50 offset:1024
    ds_read_b64_tr_b16 a[12:13], v51 offset:0
    ds_read_b64_tr_b16 a[14:15], v51 offset:1024
    ds_read_b64_tr_b16 a[16:17], v50 offset:3584
    ds_read_b64_tr_b16 a[18:19], v50 offset:4608
    ds_read_b64_tr_b16 a[20:21], v51 offset:3584
    ds_read_b64_tr_b16 a[22:23], v51 offset:4608
    ds_read_b64_tr_b16 a[24:25], v48 offset:3584
    ds_read_b64_tr_b16 a[26:27], v48 offset:4608
    ds_read_b64_tr_b16 a[28:29], v49 offset:3584
    ds_read_b64_tr_b16 a[30:31], v49 offset:4608
    ds_read_b64_tr_b16 a[32:33], v48 offset:7168
    ds_read_b64_tr_b16 a[34:35], v48 offset:8192
    ds_read_b64_tr_b16 a[36:37], v49 offset:7168
    ds_read_b64_tr_b16 a[38:39], v49 offset:8192
    ds_read_b64_tr_b16 a[40:41], v50 offset:7168
    ds_read_b64_tr_b16 a[42:43], v50 offset:8192
    ds_read_b64_tr_b16 a[44:45], v51 offset:7168
    ds_read_b64_tr_b16 a[46:47], v51 offset:8192
    ds_read_b64_tr_b16 a[48:49], v50 offset:10752
    ds_read_b64_tr_b16 a[50:51], v50 offset:11776
    ds_read_b64_tr_b16 a[52:53], v51 offset:10752
    ds_read_b64_tr_b16 a[54:55], v51 offset:11776
    ds_read_b64_tr_b16 a[56:57], v48 offset:10752
    ds_read_b64_tr_b16 a[58:59], v48 offset:11776
    ds_read_b64_tr_b16 a[60:61], v49 offset:10752
    ds_read_b64_tr_b16 a[62:63], v49 offset:11776
    ds_read_b64_tr_b16 a[64:65], v48 offset:14336
    ds_read_b64_tr_b16 a[66:67], v48 offset:15360
    ds_read_b64_tr_b16 a[68:69], v49 offset:14336
    ds_read_b64_tr_b16 a[70:71], v49 offset:15360
    ds_read_b64_tr_b16 a[72:73], v50 offset:14336
    ds_read_b64_tr_b16 a[74:75], v50 offset:15360
    ds_read_b64_tr_b16 a[76:77], v51 offset:14336
    ds_read_b64_tr_b16 a[78:79], v51 offset:15360
    ds_read_b64_tr_b16 a[80:81], v50 offset:17920
    ds_read_b64_tr_b16 a[82:83], v50 offset:18944
    ds_read_b64_tr_b16 a[84:85], v51 offset:17920
    ds_read_b64_tr_b16 a[86:87], v51 offset:18944
    ds_read_b64_tr_b16 a[88:89], v48 offset:17920
    ds_read_b64_tr_b16 a[90:91], v48 offset:18944
    ds_read_b64_tr_b16 a[92:93], v49 offset:17920
    ds_read_b64_tr_b16 a[94:95], v49 offset:18944
    ds_read_b64_tr_b16 a[96:97], v48 offset:21504
    ds_read_b64_tr_b16 a[98:99], v48 offset:22528
    ds_read_b64_tr_b16 a[100:101], v49 offset:21504
    ds_read_b64_tr_b16 a[102:103], v49 offset:22528
    ds_read_b64_tr_b16 a[104:105], v50 offset:21504
    ds_read_b64_tr_b16 a[106:107], v50 offset:22528
    ds_read_b64_tr_b16 a[108:109], v51 offset:21504
    ds_read_b64_tr_b16 a[110:111], v51 offset:22528
    ds_read_b64_tr_b16 a[112:113], v50 offset:25088
    ds_read_b64_tr_b16 a[114:115], v50 offset:26112
    ds_read_b64_tr_b16 a[116:117], v51 offset:25088
    ds_read_b64_tr_b16 a[118:119], v51 offset:26112
    ds_read_b64_tr_b16 a[120:121], v48 offset:25088
    ds_read_b64_tr_b16 a[122:123], v48 offset:26112
    ds_read_b64_tr_b16 a[124:125], v49 offset:25088
    ds_read_b64_tr_b16 a[126:127], v49 offset:26112
    s_lshl_b32 s60, s51, 6
    s_add_u32 s60, s60, s43
    s_lshl_b32 s60, s60, 12
    s_add_u32 s60, s60, 5242880
    s_waitcnt vmcnt(0)
    v_cmp_ne_u32 vcc, s54, v203
    s_cbranch_vccz L_chkd_15
    s_mov_b32 s63, 0
L_chk_14:
    buffer_load_dword v203, v200, s[44:47], 0 offen offset:0 sc1
    s_add_u32 s63, s63, 1
    s_cmp_ge_u32 s63, 131072
    s_waitcnt vmcnt(0)
    s_cbranch_scc1 L_chkd_15
    v_cmp_ne_u32 vcc, s54, v203
    s_cbranch_vccnz L_chk_14
L_chkd_15:
    s_cmp_lg_u32 s55, 0
    s_cbranch_scc1 L_acq_16
    buffer_inv sc1
    s_waitcnt vmcnt(0)
L_acq_16:
    s_cmp_lt_i32 s43, 0
    s_cbranch_scc1 L_kvfill_17
    s_add_u32 m0, s42, 0
    s_add_u32 s56, s60, 0
    buffer_load_dwordx4 v1, s[44:47], s56 offen sc1 lds
    s_mov_b32 exec_hi, 0xffff
    buffer_load_dwordx4 v1, s[44:47], s56 offen offset:1024 sc1 lds
    s_mov_b32 exec_lo, 0x0fffffff
    s_mov_b32 exec_hi, 0x0fffffff
    buffer_load_dwordx4 v1, s[44:47], s56 offen offset:2048 sc1 lds
    buffer_load_dwordx4 v1, s[44:47], s56 offen offset:3072 sc1 lds
    s_mov_b64 exec, -1
    s_branch L_kvdone_18
L_kvfill_17:
    ds_write_b128 v202, v[184:187] offset:0
    ds_write_b128 v202, v[188:191] offset:1024
    ds_write_b128 v202, v[184:187] offset:2048
    ds_write_b128 v202, v[184:187] offset:3072
L_kvdone_18:
    s_cmp_lt_i32 s43, -1
    s_cbranch_scc1 L_kvfill_19
    s_add_u32 m0, s42, 4096
    s_add_u32 s56, s60, 4096
    buffer_load_dwordx4 v1, s[44:47], s56 offen sc1 lds
    s_mov_b32 exec_hi, 0xffff
    buffer_load_dwordx4 v1, s[44:47], s56 offen offset:1024 sc1 lds
    s_mov_b32 exec_lo, 0x0fffffff
    s_mov_b32 exec_hi, 0x0fffffff
    buffer_load_dwordx4 v1, s[44:47], s56 offen offset:2048 sc1 lds
    buffer_load_dwordx4 v1, s[44:47], s56 offen offset:3072 sc1 lds
    s_mov_b64 exec, -1
    s_branch L_kvdone_20
L_kvfill_19:
    ds_write_b128 v202, v[184:187] offset:4096
    ds_write_b128 v202, v[188:191] offset:5120
    ds_write_b128 v202, v[184:187] offset:6144
    ds_write_b128 v202, v[184:187] offset:7168
L_kvdone_20:
    s_cmp_lt_i32 s43, -2
    s_cbranch_scc1 L_kvfill_21
    s_add_u32 m0, s42, 8192
    s_add_u32 s56, s60, 8192
    buffer_load_dwordx4 v1, s[44:47], s56 offen sc1 lds
    s_mov_b32 exec_hi, 0xffff
    buffer_load_dwordx4 v1, s[44:47], s56 offen offset:1024 sc1 lds
    s_mov_b32 exec_lo, 0x0fffffff
    s_mov_b32 exec_hi, 0x0fffffff
    buffer_load_dwordx4 v1, s[44:47], s56 offen offset:2048 sc1 lds
    buffer_load_dwordx4 v1, s[44:47], s56 offen offset:3072 sc1 lds
    s_mov_b64 exec, -1
    s_branch L_kvdone_22
L_kvfill_21:
    ds_write_b128 v202, v[184:187] offset:8192
    ds_write_b128 v202, v[188:191] offset:9216
    ds_write_b128 v202, v[184:187] offset:10240
    ds_write_b128 v202, v[184:187] offset:11264
L_kvdone_22:
    s_lshl_b32 s56, s50, 11
    s_add_u32 s56, s56, 52736
    v_lshrrev_b32 v4, 2, v0
    v_lshlrev_b32 v4, 7, v4
    v_and_b32 v5, 3, v0
    v_lshl_add_u32 v4, v5, 4, v4
    v_add_u32 v6, s56, v4
    v_and_b32 v4, 15, v0
    v_lshlrev_b32 v4, 7, v4
    v_lshrrev_b32 v5, 4, v0
    v_lshl_add_u32 v4, v5, 3, v4
    v_add_u32 v7, s56, v4
    ds_write_b128 v6, v[240:243]
    ds_write_b128 v6, v[244:247] offset:64
    ds_read_b64 v[248:249], v7 offset:0
    ds_read_b64 v[250:251], v7 offset:32
    ds_read_b64 v[252:253], v7 offset:64
    ds_read_b64 v[254:255], v7 offset:96
    s_waitcnt vmcnt(0) lgkmcnt(0)
    s_barrier
    ds_read2st64_b64 a[224:227], v15 offset0:0 offset1:1
    ds_read2st64_b64 a[228:231], v15 offset0:2 offset1:3
    ds_read2st64_b64 a[232:235], v15 offset0:64 offset1:65
    ds_read2st64_b64 a[236:239], v15 offset0:66 offset1:67
    ds_read2st64_b64 a[240:243], v15 offset0:8 offset1:9
    ds_read2st64_b64 a[244:247], v15 offset0:10 offset1:11
    s_mul_i32 s100, s62, 112
    s_mul_i32 s57, s50, 28
    s_add_u32 s100, s100, s57
    s_lshl_b32 s100, s100, 11
    s_add_u32 s100, s100, 16777216
    s_lshl_b32 s3, s61, 1
    s_add_u32 s3, s3, s62
    s_cmp_ge_u32 s3, 7
    s_cselect_b32 s57, 7, 0
    s_sub_u32 s3, s3, s57
    s_waitcnt lgkmcnt(4)
    v_mfma_f32_32x32x16_bf16 v[80:95], a[224:227], v[64:67], 0
    ds_read2st64_b64 a[248:251], v15 offset0:16 offset1:17
    ds_read2st64_b64 a[252:255], v15 offset0:18 offset1:19
    s_lshl_b32 s59, s50, 11
    s_add_u32 m0, s59, 52736
    s_nop 0
    buffer_load_dwordx4 v14, s[24:27], s40 offen lds
    buffer_load_dwordx4 v211, s[24:27], s40 offen offset:1024 lds
    v_mfma_f32_32x32x16_bf16 v[80:95], a[228:231], v[68:71], v[80:95]
    s_waitcnt lgkmcnt(4)
    v_mfma_f32_32x32x16_bf16 v[96:111], a[232:235], v[64:67], 0
    ds_read2st64_b64 a[224:227], v15 offset0:24 offset1:25
    ds_read2st64_b64 a[228:231], v15 offset0:26 offset1:27
    s_add_u32 s59, s99, 0
    s_add_u32 m0, s101, 89600
    s_nop 0
    buffer_load_dwordx4 v12, s[16:19], s59 offen lds
    v_mfma_f32_32x32x16_bf16 v[96:111], a[236:239], v[68:71], v[96:111]
    s_waitcnt lgkmcnt(4)
    v_mfma_f32_32x32x16_bf16 v[112:127], a[240:243], v[64:67], 0
    ds_read2st64_b64 a[232:235], v15 offset0:32 offset1:33
    ds_read2st64_b64 a[236:239], v15 offset0:34 offset1:35
    s_add_u32 s59, s99, 0
    s_add_u32 m0, s101, 93696
    s_nop 0
    buffer_load_dwordx4 v12, s[20:23], s59 offen lds
    v_mfma_f32_32x32x16_bf16 v[112:127], a[244:247], v[68:71], v[112:127]
    s_nop 2
    v_cndmask_b32 v128, v80, v96, s[64:65]
    v_cndmask_b32 v129, v81, v97, s[66:67]
    v_cndmask_b32 v130, v82, v98, s[68:69]
    v_cndmask_b32 v131, v83, v99, s[70:71]
    v_cndmask_b32 v132, v84, v100, s[72:73]
    v_cndmask_b32 v133, v85, v101, s[74:75]
    v_cndmask_b32 v134, v86, v102, s[76:77]
    v_cndmask_b32 v135, v87, v103, s[78:79]
    v_cndmask_b32 v136, v88, v104, s[80:81]
    v_cndmask_b32 v137, v89, v105, s[82:83]
    v_cndmask_b32 v138, v90, v106, s[84:85]
    v_cndmask_b32 v139, v91, v107, s[86:87]
    v_cndmask_b32 v140, v92, v108, s[88:89]
    v_cndmask_b32 v141, v93, v109, s[90:91]
    v_cndmask_b32 v142, v94, v110, s[92:93]
    v_cndmask_b32 v143, v95, v111, s[94:95]
    s_waitcnt lgkmcnt(4)
    v_mfma_f32_32x32x16_bf16 v[80:95], a[248:251], v[64:67], 0
    ds_read2st64_b64 a[240:243], v15 offset0:40 offset1:41
    ds_read2st64_b64 a[244:247], v15 offset0:42 offset1:43
    v_max_f32 v11, v128, v129
    v_max3_f32 v11, v11, v130, v131
    v_max3_f32 v11, v11, v132, v133
    v_max3_f32 v11, v11, v134, v135
    v_max3_f32 v11, v11, v136, v137
    v_max3_f32 v11, v11, v138, v139
    v_max3_f32 v11, v11, v140, v141
    v_max3_f32 v11, v11, v142, v143
    s_add_u32 s59, s99, 114688
    s_add_u32 m0, s101, 97792
    s_nop 0
    buffer_load_dwordx4 v12, s[16:19], s59 offen lds
    v_mfma_f32_32x32x16_bf16 v[80:95], a[252:255], v[68:71], v[80:95]
    v_max3_f32 v11, v11, v112, v113
    v_max3_f32 v11, v11, v114, v115
    v_max3_f32 v11, v11, v116, v117
    v_max3_f32 v11, v11, v118, v119
    s_waitcnt lgkmcnt(4)
    v_mfma_f32_32x32x16_bf16 v[96:111], a[224:227], v[64:67], 0
    ds_read2st64_b64 a[248:251], v15 offset0:48 offset1:49
    ds_read2st64_b64 a[252:255], v15 offset0:50 offset1:51
    v_max3_f32 v11, v11, v120, v121
    v_max3_f32 v11, v11, v122, v123
    v_max3_f32 v11, v11, v124, v125
    v_max3_f32 v11, v11, v126, v127
    s_add_u32 s59, s99, 114688
    s_add_u32 m0, s101, 101888
    s_nop 0
    buffer_load_dwordx4 v12, s[20:23], s59 offen lds
    v_mfma_f32_32x32x16_bf16 v[96:111], a[228:231], v[68:71], v[96:111]
    v_max3_f32 v11, v11, v80, v81
    v_max3_f32 v11, v11, v82, v83
    v_max3_f32 v11, v11, v84, v85
    v_max3_f32 v11, v11, v86, v87
    ds_read_b128 v[16:19], v10 offset:2048
    ds_read_b128 v[20:23], v10 offset:3072
    s_waitcnt lgkmcnt(6)
    v_mfma_f32_32x32x16_bf16 v[112:127], a[232:235], v[64:67], 0
    ds_read2st64_b64 a[224:227], v15 offset0:56 offset1:57
    ds_read2st64_b64 a[228:231], v15 offset0:58 offset1:59
    v_max3_f32 v11, v11, v88, v89
    v_max3_f32 v11, v11, v90, v91
    v_max3_f32 v11, v11, v92, v93
    v_max3_f32 v11, v11, v94, v95
    s_add_u32 s59, s99, 229376
    s_add_u32 m0, s101, 61440
    s_nop 0
    buffer_load_dwordx4 v12, s[16:19], s59 offen lds
    v_mfma_f32_32x32x16_bf16 v[112:127], a[236:239], v[68:71], v[112:127]
    v_max3_f32 v11, v11, v96, v97
    v_max3_f32 v11, v11, v98, v99
    v_max3_f32 v11, v11, v100, v101
    v_max3_f32 v11, v11, v102, v103
    ds_read_b128 v[24:27], v10 offset:34816
    ds_read_b128 v[28:31], v10 offset:35840
    s_waitcnt lgkmcnt(8)
    v_mfma_f32_32x32x16_bf16 v[80:95], a[240:243], v[64:67], 0
    ds_read2st64_b64 a[232:235], v15 offset0:8 offset1:9
    ds_read2st64_b64 a[236:239], v15 offset0:10 offset1:11
    v_max3_f32 v11, v11, v104, v105
    v_max3_f32 v11, v11, v106, v107
    v_max3_f32 v11, v11, v108, v109
    v_max3_f32 v11, v11, v110, v111
    s_add_u32 s59, s99, 229376
    s_add_u32 m0, s101, 65536
    s_nop 0
    buffer_load_dwordx4 v12, s[20:23], s59 offen lds
    v_mfma_f32_32x32x16_bf16 v[80:95], a[244:247], v[68:71], v[80:95]
    v_max3_f32 v11, v11, v112, v113
    v_max3_f32 v11, v11, v114, v115
    v_max3_f32 v11, v11, v116, v117
    v_max3_f32 v11, v11, v118, v119
    ds_read_b128 v[32:35], v10 offset:6144
    ds_read_b128 v[36:39], v10 offset:7168
    s_waitcnt lgkmcnt(10)
    v_mfma_f32_32x32x16_bf16 v[96:111], a[248:251], v[64:67], 0
    ds_read2st64_b64 a[240:243], v15 offset0:16 offset1:17
    ds_read2st64_b64 a[244:247], v15 offset0:18 offset1:19
    v_max3_f32 v11, v11, v120, v121
    v_max3_f32 v11, v11, v122, v123
    v_max3_f32 v11, v11, v124, v125
    v_max3_f32 v11, v11, v126, v127
    s_add_u32 s59, s99, 344064
    s_add_u32 m0, s101, 69632
    s_nop 0
    buffer_load_dwordx4 v12, s[16:19], s59 offen lds
    v_mfma_f32_32x32x16_bf16 v[96:111], a[252:255], v[68:71], v[96:111]
    v_max3_f32 v11, v11, v80, v81
    v_max3_f32 v11, v11, v82, v83
    v_max3_f32 v11, v11, v84, v85
    v_max3_f32 v11, v11, v86, v87
    s_waitcnt lgkmcnt(8)
    v_mfma_f32_32x32x16_bf16 v[112:127], a[224:227], v[64:67], 0
    ds_read2st64_b64 a[248:251], v15 offset0:24 offset1:25
    ds_read2st64_b64 a[252:255], v15 offset0:26 offset1:27
    v_max3_f32 v11, v11, v88, v89
    v_max3_f32 v11, v11, v90, v91
    v_max3_f32 v11, v11, v92, v93
    v_max3_f32 v11, v11, v94, v95
    v_mfma_f32_32x32x16_bf16 v[112:127], a[228:231], v[68:71], v[112:127]
    v_max3_f32 v11, v11, v96, v97
    v_max3_f32 v11, v11, v98, v99
    v_max3_f32 v11, v11, v100, v101
    v_max3_f32 v11, v11, v102, v103
    v_max3_f32 v11, v11, v104, v105
    v_max3_f32 v11, v11, v106, v107
    v_max3_f32 v11, v11, v108, v109
    v_max3_f32 v11, v11, v110, v111
    s_nop 3
    v_max3_f32 v11, v11, v112, v113
    v_max3_f32 v11, v11, v114, v115
    v_max3_f32 v11, v11, v116, v117
    v_max3_f32 v11, v11, v118, v119
    v_max3_f32 v11, v11, v120, v121
    v_max3_f32 v11, v11, v122, v123
    v_max3_f32 v11, v11, v124, v125
    v_max3_f32 v11, v11, v126, v127
    v_mov_b32 v4, v11
    s_nop 1
    v_permlane32_swap_b32 v11, v4
    v_max_f32 v11, v11, v4
    v_sub_f32 v144, 0, v11
    v_sub_f32 v145, 0, v11
    v_sub_f32 v146, 0, v11
    v_sub_f32 v147, 0, v11
    v_sub_f32 v148, 0, v11
    v_sub_f32 v149, 0, v11
    v_sub_f32 v150, 0, v11
    v_sub_f32 v151, 0, v11
    v_sub_f32 v152, 0, v11
    v_sub_f32 v153, 0, v11
    v_sub_f32 v154, 0, v11
    v_sub_f32 v155, 0, v11
    v_sub_f32 v156, 0, v11
    v_sub_f32 v157, 0, v11
    v_sub_f32 v158, 0, v11
    v_sub_f32 v159, 0, v11
    s_waitcnt lgkmcnt(6)
    s_nop 0
    v_mfma_f32_32x32x16_bf16 v[80:95], a[232:235], v[64:67], v[144:159]
    v_sub_f32 v128, v128, v11
    v_sub_f32 v129, v129, v11
    v_sub_f32 v130, v130, v11
    v_sub_f32 v131, v131, v11
    v_sub_f32 v132, v132, v11
    v_sub_f32 v133, v133, v11
    v_sub_f32 v134, v134, v11
    v_sub_f32 v135, v135, v11
    v_mfma_f32_32x32x16_bf16 v[80:95], a[236:239], v[68:71], v[80:95]
    v_sub_f32 v136, v136, v11
    v_sub_f32 v137, v137, v11
    v_sub_f32 v138, v138, v11
    v_sub_f32 v139, v139, v11
    v_sub_f32 v140, v140, v11
    v_sub_f32 v141, v141, v11
    v_sub_f32 v142, v142, v11
    v_sub_f32 v143, v143, v11
    s_waitcnt lgkmcnt(2)
    v_mfma_f32_32x32x16_bf16 v[96:111], a[240:243], v[64:67], v[144:159]
    ds_read2st64_b64 a[224:227], v15 offset0:32 offset1:33
    ds_read2st64_b64 a[228:231], v15 offset0:34 offset1:35
    v_exp_f32 v128, v128
    v_exp_f32 v129, v129
    v_exp_f32 v130, v130
    v_exp_f32 v131, v131
    v_exp_f32 v132, v132
    v_exp_f32 v133, v133
    v_exp_f32 v134, v134
    v_exp_f32 v135, v135
    v_mfma_f32_32x32x16_bf16 v[96:111], a[244:247], v[68:71], v[96:111]
    ds_read_b128 v[40:43], v10 offset:10240
    ds_read_b128 v[44:47], v10 offset:11264
    v_exp_f32 v136, v136
    v_exp_f32 v137, v137
    v_exp_f32 v138, v138
    v_exp_f32 v139, v139
    v_exp_f32 v140, v140
    v_exp_f32 v141, v141
    v_exp_f32 v142, v142
    v_exp_f32 v143, v143
    v_cvt_pk_bf16_f32 v176, v128, v129
    v_cvt_pk_bf16_f32 v177, v130, v131
    v_cvt_pk_bf16_f32 v178, v132, v133
    v_cvt_pk_bf16_f32 v179, v134, v135
    v_cvt_pk_bf16_f32 v180, v136, v137
    v_cvt_pk_bf16_f32 v181, v138, v139
    v_cvt_pk_bf16_f32 v182, v140, v141
    v_cvt_pk_bf16_f32 v183, v142, v143
    v_and_b32 v184, v176, v72
    v_xor_b32 v176, v176, v184
    v_and_b32 v185, v177, v73
    v_xor_b32 v177, v177, v185
    v_and_b32 v186, v178, v74
    v_xor_b32 v178, v178, v186
    v_and_b32 v187, v179, v75
    v_xor_b32 v179, v179, v187
    v_and_b32 v188, v180, v76
    v_xor_b32 v180, v180, v188
    v_and_b32 v189, v181, v77
    v_xor_b32 v181, v181, v189
    v_and_b32 v190, v182, v78
    v_xor_b32 v182, v182, v190
    v_and_b32 v191, v183, v79
    v_xor_b32 v183, v183, v191
    s_add_u32 s59, s99, 344064
    s_add_u32 m0, s101, 73728
    s_nop 0
    buffer_load_dwordx4 v12, s[20:23], s59 offen lds
    v_mfma_f32_32x32x16_bf16 v[160:175], v[16:19], v[176:179], 0
    v_exp_f32 v80, v80
    v_exp_f32 v81, v81
    v_exp_f32 v82, v82
    v_exp_f32 v83, v83
    v_mfma_f32_32x32x16_bf16 v[160:175], v[20:23], v[180:183], v[160:175]
    v_exp_f32 v84, v84
    v_exp_f32 v85, v85
    v_exp_f32 v86, v86
    v_mfma_f32_32x32x16_bf16 v[160:175], v[24:27], v[184:187], v[160:175]
    v_exp_f32 v87, v87
    v_exp_f32 v88, v88
    v_exp_f32 v89, v89
    v_mfma_f32_32x32x16_bf16 v[160:175], v[28:31], v[188:191], v[160:175]
    v_exp_f32 v90, v90
    v_exp_f32 v91, v91
    v_exp_f32 v92, v92
    v_exp_f32 v93, v93
    s_waitcnt lgkmcnt(4)
    v_mfma_f32_32x32x16_bf16 v[112:127], a[248:251], v[64:67], v[144:159]
    v_exp_f32 v94, v94
    v_exp_f32 v95, v95
    v_cvt_pk_bf16_f32 v200, v80, v81
    v_cvt_pk_bf16_f32 v201, v82, v83
    v_mfma_f32_32x32x16_bf16 v[112:127], a[252:255], v[68:71], v[112:127]
    v_cvt_pk_bf16_f32 v202, v84, v85
    v_cvt_pk_bf16_f32 v203, v86, v87
    v_cvt_pk_bf16_f32 v204, v88, v89
    v_cvt_pk_bf16_f32 v205, v90, v91
    v_cvt_pk_bf16_f32 v206, v92, v93
    v_cvt_pk_bf16_f32 v207, v94, v95
    ds_read2st64_b64 a[232:235], v15 offset0:40 offset1:41
    ds_read2st64_b64 a[236:239], v15 offset0:42 offset1:43
    ds_read_b128 v[16:19], v10 offset:14336
    ds_read_b128 v[20:23], v10 offset:15360
    ds_read_b128 v[24:27], v10 offset:18432
    ds_read_b128 v[28:31], v10 offset:19456
    v_mfma_f32_32x32x16_bf16 v[160:175], v[32:35], v[200:203], v[160:175]
    v_exp_f32 v96, v96
    v_exp_f32 v97, v97
    v_exp_f32 v98, v98
    v_exp_f32 v99, v99
    v_exp_f32 v100, v100
    v_mfma_f32_32x32x16_bf16 v[160:175], v[36:39], v[204:207], v[160:175]
    v_exp_f32 v101, v101
    v_exp_f32 v102, v102
    v_exp_f32 v103, v103
    v_exp_f32 v104, v104
    v_exp_f32 v105, v105
    s_waitcnt lgkmcnt(8)
    v_mfma_f32_32x32x16_bf16 v[80:95], a[224:227], v[64:67], v[144:159]
    v_exp_f32 v106, v106
    v_exp_f32 v107, v107
    v_exp_f32 v108, v108
    v_exp_f32 v109, v109
    v_exp_f32 v110, v110
    v_mfma_f32_32x32x16_bf16 v[80:95], a[228:231], v[68:71], v[80:95]
    v_exp_f32 v111, v111
    v_cvt_pk_bf16_f32 v192, v96, v97
    v_cvt_pk_bf16_f32 v193, v98, v99
    v_cvt_pk_bf16_f32 v194, v100, v101
    v_cvt_pk_bf16_f32 v195, v102, v103
    v_cvt_pk_bf16_f32 v196, v104, v105
    v_cvt_pk_bf16_f32 v197, v106, v107
    v_cvt_pk_bf16_f32 v198, v108, v109
    v_cvt_pk_bf16_f32 v199, v110, v111
    ds_read2st64_b64 a[240:243], v15 offset0:48 offset1:49
    ds_read2st64_b64 a[244:247], v15 offset0:50 offset1:51
    ds_read_b128 v[32:35], v10 offset:22528
    ds_read_b128 v[36:39], v10 offset:23552
    s_waitcnt lgkmcnt(10)
    v_mfma_f32_32x32x16_bf16 v[160:175], v[40:43], v[192:195], v[160:175]
    v_exp_f32 v112, v112
    v_exp_f32 v113, v113
    v_exp_f32 v114, v114
    v_exp_f32 v115, v115
    v_exp_f32 v116, v116
    v_mfma_f32_32x32x16_bf16 v[160:175], v[44:47], v[196:199], v[160:175]
    v_exp_f32 v117, v117
    v_exp_f32 v118, v118
    v_exp_f32 v119, v119
    v_exp_f32 v120, v120
    v_exp_f32 v121, v121
    s_waitcnt lgkmcnt(8)
    v_mfma_f32_32x32x16_bf16 v[96:111], a[232:235], v[64:67], v[144:159]
    v_exp_f32 v122, v122
    v_exp_f32 v123, v123
    s_mov_b32 s56, 65536
    buffer_load_dwordx4 v[216:219], v208, s[44:47], s56 offen sc1
    s_mov_b32 s56, 76288
    buffer_load_dwordx4 v[220:223], v208, s[44:47], s56 offen sc1
    s_mov_b32 s56, 87040
    buffer_load_dwordx4 v[224:227], v208, s[44:47], s56 offen sc1
    s_mov_b32 s56, 97792
    buffer_load_dwordx4 v[228:231], v208, s[44:47], s56 offen sc1
    v_exp_f32 v124, v124
    v_exp_f32 v125, v125
    v_exp_f32 v126, v126
    v_mfma_f32_32x32x16_bf16 v[96:111], a[236:239], v[68:71], v[96:111]
    v_exp_f32 v127, v127
    v_cvt_pk_bf16_f32 v200, v112, v113
    v_cvt_pk_bf16_f32 v201, v114, v115
    v_cvt_pk_bf16_f32 v202, v116, v117
    v_cvt_pk_bf16_f32 v203, v118, v119
    v_cvt_pk_bf16_f32 v204, v120, v121
    v_cvt_pk_bf16_f32 v205, v122, v123
    v_cvt_pk_bf16_f32 v206, v124, v125
    v_cvt_pk_bf16_f32 v207, v126, v127
    ds_read2st64_b64 a[248:251], v15 offset0:56 offset1:57
    ds_read2st64_b64 a[252:255], v15 offset0:58 offset1:59
    ds_read_b128 v[40:43], v10 offset:26624
    ds_read_b128 v[44:47], v10 offset:27648
    s_waitcnt lgkmcnt(10)
    v_mfma_f32_32x32x16_bf16 v[160:175], v[16:19], v[200:203], v[160:175]
    v_exp_f32 v80, v80
    v_exp_f32 v81, v81
    v_exp_f32 v82, v82
    v_exp_f32 v83, v83
    v_exp_f32 v84, v84
    v_mfma_f32_32x32x16_bf16 v[160:175], v[20:23], v[204:207], v[160:175]
    v_exp_f32 v85, v85
    v_exp_f32 v86, v86
    v_exp_f32 v87, v87
    v_exp_f32 v88, v88
    v_exp_f32 v89, v89
    s_waitcnt lgkmcnt(6)
    v_mfma_f32_32x32x16_bf16 v[112:127], a[240:243], v[64:67], v[144:159]
    v_exp_f32 v90, v90
    v_exp_f32 v91, v91
    v_exp_f32 v92, v92
    v_exp_f32 v93, v93
    v_exp_f32 v94, v94
    v_mfma_f32_32x32x16_bf16 v[112:127], a[244:247], v[68:71], v[112:127]
    v_exp_f32 v95, v95
    v_cvt_pk_bf16_f32 v192, v80, v81
    v_cvt_pk_bf16_f32 v193, v82, v83
    v_cvt_pk_bf16_f32 v194, v84, v85
    v_cvt_pk_bf16_f32 v195, v86, v87
    v_cvt_pk_bf16_f32 v196, v88, v89
    v_cvt_pk_bf16_f32 v197, v90, v91
    v_cvt_pk_bf16_f32 v198, v92, v93
    v_cvt_pk_bf16_f32 v199, v94, v95
    s_waitcnt vmcnt(12)
    ds_read_b64_tr_b16 v[240:241], v212 offset:0
    ds_read_b64_tr_b16 v[242:243], v212 offset:1024
    ds_read_b64_tr_b16 v[244:245], v213 offset:0
    ds_read_b64_tr_b16 v[246:247], v213 offset:1024
    ds_read_b128 v[16:19], v10 offset:30720
    ds_read_b128 v[20:23], v10 offset:31744
    v_mfma_f32_32x32x16_bf16 v[160:175], v[24:27], v[192:195], v[160:175]
    v_exp_f32 v96, v96
    v_exp_f32 v97, v97
    v_exp_f32 v98, v98
    v_exp_f32 v99, v99
    v_exp_f32 v100, v100
    v_mfma_f32_32x32x16_bf16 v[160:175], v[28:31], v[196:199], v[160:175]
    v_exp_f32 v101, v101
    v_exp_f32 v102, v102
    v_exp_f32 v103, v103
    v_exp_f32 v104, v104
    v_exp_f32 v105, v105
    s_waitcnt lgkmcnt(8)
    v_mfma_f32_32x32x16_bf16 v[80:95], a[248:251], v[64:67], v[144:159]
    v_exp_f32 v106, v106
    v_exp_f32 v107, v107
    v_exp_f32 v108, v108
    v_exp_f32 v109, v109
    v_exp_f32 v110, v110
    v_mfma_f32_32x32x16_bf16 v[80:95], a[252:255], v[68:71], v[80:95]
    v_exp_f32 v111, v111
    v_cvt_pk_bf16_f32 v200, v96, v97
    v_cvt_pk_bf16_f32 v201, v98, v99
    v_cvt_pk_bf16_f32 v202, v100, v101
    v_cvt_pk_bf16_f32 v203, v102, v103
    v_cvt_pk_bf16_f32 v204, v104, v105
    v_cvt_pk_bf16_f32 v205, v106, v107
    v_cvt_pk_bf16_f32 v206, v108, v109
    v_cvt_pk_bf16_f32 v207, v110, v111
    s_lshl_b32 s59, s41, 11
    s_add_u32 s59, s59, 16777216
    s_cmp_ge_u32 s41, 784
    s_cselect_b32 s59, 0x7ff00000, s59
    s_waitcnt lgkmcnt(2)
    buffer_store_dwordx4 v[240:243], v1, s[44:47], s59 offen offset:0 sc1
    buffer_store_dwordx4 v[244:247], v1, s[44:47], s59 offen offset:1024 sc1
    v_mfma_f32_32x32x16_bf16 v[160:175], v[32:35], v[200:203], v[160:175]
    v_exp_f32 v112, v112
    v_exp_f32 v113, v113
    v_exp_f32 v114, v114
    v_exp_f32 v115, v115
    v_exp_f32 v116, v116
    v_exp_f32 v117, v117
    v_exp_f32 v118, v118
    v_exp_f32 v119, v119
    v_exp_f32 v120, v120
    v_exp_f32 v121, v121
    v_mfma_f32_32x32x16_bf16 v[160:175], v[36:39], v[204:207], v[160:175]
    v_exp_f32 v122, v122
    v_exp_f32 v123, v123
    v_exp_f32 v124, v124
    v_exp_f32 v125, v125
    v_exp_f32 v126, v126
    v_exp_f32 v127, v127
    v_cvt_pk_bf16_f32 v192, v112, v113
    v_cvt_pk_bf16_f32 v193, v114, v115
    v_cvt_pk_bf16_f32 v194, v116, v117
    v_cvt_pk_bf16_f32 v195, v118, v119
    v_cvt_pk_bf16_f32 v196, v120, v121
    v_cvt_pk_bf16_f32 v197, v122, v123
    v_cvt_pk_bf16_f32 v198, v124, v125
    v_cvt_pk_bf16_f32 v199, v126, v127
    v_mfma_f32_32x32x16_bf16 v[160:175], v[40:43], v[192:195], v[160:175]
    v_exp_f32 v80, v80
    v_exp_f32 v81, v81
    v_exp_f32 v82, v82
    v_exp_f32 v83, v83
    v_exp_f32 v84, v84
    v_exp_f32 v85, v85
    v_exp_f32 v86, v86
    v_exp_f32 v87, v87
    v_exp_f32 v88, v88
    v_exp_f32 v89, v89
    v_mfma_f32_32x32x16_bf16 v[160:175], v[44:47], v[196:199], v[160:175]
    v_exp_f32 v90, v90
    v_exp_f32 v91, v91
    v_exp_f32 v92, v92
    v_exp_f32 v93, v93
    v_exp_f32 v94, v94
    v_exp_f32 v95, v95
    v_cvt_pk_bf16_f32 v200, v80, v81
    v_cvt_pk_bf16_f32 v201, v82, v83
    v_cvt_pk_bf16_f32 v202, v84, v85
    v_cvt_pk_bf16_f32 v203, v86, v87
    v_cvt_pk_bf16_f32 v204, v88, v89
    v_cvt_pk_bf16_f32 v205, v90, v91
    v_cvt_pk_bf16_f32 v206, v92, v93
    v_cvt_pk_bf16_f32 v207, v94, v95
    s_waitcnt lgkmcnt(0)
    v_mfma_f32_32x32x16_bf16 v[160:175], v[16:19], v[200:203], v[160:175]
    v_bfe_u32 v4, v0, 4, 1
    v_lshlrev_b32 v4, 14, v4
    v_lshrrev_b32 v5, 5, v0
    v_lshl_add_u32 v4, v5, 8, v4
    v_mfma_f32_32x32x16_bf16 v[160:175], v[20:23], v[204:207], v[160:175]
    v_and_b32 v5, 15, v0
    v_lshl_add_u32 v4, v5, 4, v4
    s_lshl_b32 s56, s53, 5
    s_add_u32 s56, s56, s51
    s_lshl_b32 s56, s56, 10
    s_add_u32 s56, s56, 3145728
    s_lshl_b32 s57, s53, 4
    s_add_u32 s57, s57, s51
    s_lshl_b32 s57, s57, 2
    s_add_u32 s57, s57, 8192
    s_nop 1
    v_mov_b32 v5, v172
    v_mov_b32 v6, v172
    s_nop 1
    v_permlane32_swap_b32 v5, v6
    v_rcp_f32 v6, v6
    s_nop 0
    v_mul_f32 v160, v6, v160
    v_mul_f32 v161, v6, v161
    v_mul_f32 v162, v6, v162
    v_mul_f32 v163, v6, v163
    v_mul_f32 v164, v6, v164
    v_mul_f32 v165, v6, v165
    v_mul_f32 v166, v6, v166
    v_mul_f32 v167, v6, v167
    v_cvt_pk_bf16_f32 v176, v160, v161
    v_cvt_pk_bf16_f32 v177, v162, v163
    v_cvt_pk_bf16_f32 v178, v164, v165
    v_cvt_pk_bf16_f32 v179, v166, v167
    buffer_store_dwordx4 v[176:179], v4, s[44:47], s56 offen offset:0 sc1
    v_mul_f32 v168, v6, v168
    v_mul_f32 v169, v6, v169
    v_mul_f32 v170, v6, v170
    v_mul_f32 v171, v6, v171
    v_mul_f32 v172, v6, v172
    v_mul_f32 v173, v6, v173
    v_mul_f32 v174, v6, v174
    v_mul_f32 v175, v6, v175
    v_cvt_pk_bf16_f32 v180, v168, v169
    v_cvt_pk_bf16_f32 v181, v170, v171
    v_cvt_pk_bf16_f32 v182, v172, v173
    v_cvt_pk_bf16_f32 v183, v174, v175
    v_cndmask_b32 v182, v182, 0, s[96:97]
    v_cndmask_b32 v183, v183, 0, s[96:97]
    buffer_store_dwordx4 v[180:183], v4, s[44:47], s56 offen offset:512 sc1
    s_waitcnt vmcnt(0)
    v_mov_b32 v7, s54
    s_cmp_lg_u32 s55, 0
    s_cbranch_scc0 L_slowpub_23
    s_mov_b64 exec, 1
    buffer_store_dword v7, off, s[44:47], s57
    s_branch L_pub_24
L_slowpub_23:
    buffer_wbl2 sc1
    s_waitcnt vmcnt(0)
    s_mov_b64 exec, 1
    buffer_store_dword v7, off, s[44:47], s57 sc1
L_pub_24:
    s_mov_b64 exec, -1
    s_cmp_ge_u32 s49, 28
    s_cbranch_scc1 L_spare
    s_mov_b32 s63, 0
    s_mov_b32 s59, 0x0c0c0400
    s_mov_b32 s60, 0x04000c0c
L_gath_25:
    v_perm_b32 v232, v217, v216, s59
    v_perm_b32 v233, v219, v218, s60
    v_or_b32 v232, v232, v233
    v_xor_b32 v234, s54, v232
    v_perm_b32 v232, v221, v220, s59
    v_perm_b32 v233, v223, v222, s60
    v_or_b32 v232, v232, v233
    v_xor_b32 v235, s54, v232
    v_perm_b32 v232, v225, v224, s59
    v_perm_b32 v233, v227, v226, s60
    v_or_b32 v232, v232, v233
    v_xor_b32 v236, s54, v232
    v_perm_b32 v232, v229, v228, s59
    v_perm_b32 v233, v231, v230, s60
    v_or_b32 v232, v232, v233
    v_xor_b32 v237, s54, v232
    v_or3_b32 v232, v234, v235, v236
    v_or_b32 v232, v232, v237
    v_cmp_ne_u32 vcc, 0, v232
    s_cbranch_vccz L_gathd_26
    s_mov_b32 s56, 65536
    buffer_load_dwordx4 v[216:219], v208, s[44:47], s56 offen sc1
    s_mov_b32 s56, 76288
    buffer_load_dwordx4 v[220:223], v208, s[44:47], s56 offen sc1
    s_mov_b32 s56, 87040
    buffer_load_dwordx4 v[224:227], v208, s[44:47], s56 offen sc1
    s_mov_b32 s56, 97792
    buffer_load_dwordx4 v[228:231], v208, s[44:47], s56 offen sc1
    s_add_u32 s63, s63, 1
    s_cmp_ge_u32 s63, 131072
    s_waitcnt vmcnt(0)
    s_cbranch_scc0 L_gath_25
L_gathd_26:
    v_and_b32 v216, 0xffffff00, v216
    v_and_b32 v217, 0xffffff00, v217
    v_and_b32 v218, 0xffffff00, v218
    v_and_b32 v219, 0xffffff00, v219
    v_and_b32 v220, 0xffffff00, v220
    v_and_b32 v221, 0xffffff00, v221
    v_and_b32 v222, 0xffffff00, v222
    v_and_b32 v223, 0xffffff00, v223
    v_and_b32 v224, 0xffffff00, v224
    v_and_b32 v225, 0xffffff00, v225
    v_and_b32 v226, 0xffffff00, v226
    v_and_b32 v227, 0xffffff00, v227
    v_and_b32 v228, 0xffffff00, v228
    v_and_b32 v229, 0xffffff00, v229
    v_and_b32 v230, 0xffffff00, v230
    v_and_b32 v231, 0xffffff00, v231
    v_add_f32 v216, v216, v220
    v_add_f32 v224, v224, v228
    v_add_f32 v217, v217, v221
    v_add_f32 v225, v225, v229
    v_add_f32 v218, v218, v222
    v_add_f32 v226, v226, v230
    v_add_f32 v219, v219, v223
    v_add_f32 v227, v227, v231
    v_add_f32 v216, v216, v224
    v_add_f32 v217, v217, v225
    v_add_f32 v218, v218, v226
    v_add_f32 v219, v219, v227
    v_cvt_pk_bf16_f32 v232, v216, v217
    v_lshlrev_b32 v216, 16, v232
    v_and_b32 v217, 0xffff0000, v232
    v_cvt_pk_bf16_f32 v232, v218, v219
    v_lshlrev_b32 v218, 16, v232
    v_and_b32 v219, 0xffff0000, v232
    v_add_f32 v216, v216, v210
    v_add_f32 v217, v217, v210
    v_add_f32 v218, v218, v210
    v_add_f32 v219, v219, v210
    v_cvt_pk_bf16_f32 v232, v216, v217
    v_lshlrev_b32 v216, 16, v232
    v_and_b32 v217, 0xffff0000, v232
    v_cvt_pk_bf16_f32 v232, v218, v219
    v_lshlrev_b32 v218, 16, v232
    v_and_b32 v219, 0xffff0000, v232
    ds_write_b128 v209, v[216:219] offset:1792
    ds_read_b128 v[64:67], v55 offset:1792
    ds_read_b128 v[80:83], v55 offset:2048
    ds_read_b128 v[68:71], v55 offset:1856
    ds_read_b128 v[84:87], v55 offset:2112
    ds_read_b128 v[72:75], v55 offset:1920
    ds_read_b128 v[88:91], v55 offset:2176
    ds_read_b128 v[76:79], v55 offset:1984
    ds_read_b128 v[92:95], v55 offset:2240
    buffer_load_dword v56, v54, s[44:47], s31 offen offset:0 sc1
    ds_read_b64_tr_b16 a[128:129], v48 offset:28672
    ds_read_b64_tr_b16 a[130:131], v48 offset:29696
    ds_read_b64_tr_b16 a[132:133], v49 offset:28672
    ds_read_b64_tr_b16 a[134:135], v49 offset:29696
    ds_read_b64_tr_b16 a[136:137], v50 offset:28672
    ds_read_b64_tr_b16 a[138:139], v50 offset:29696
    ds_read_b64_tr_b16 a[140:141], v51 offset:28672
    ds_read_b64_tr_b16 a[142:143], v51 offset:29696
    ds_read_b64_tr_b16 a[144:145], v50 offset:32256
    ds_read_b64_tr_b16 a[146:147], v50 offset:33280
    ds_read_b64_tr_b16 a[148:149], v51 offset:32256
    ds_read_b64_tr_b16 a[150:151], v51 offset:33280
    ds_read_b64_tr_b16 a[152:153], v48 offset:32256
    ds_read_b64_tr_b16 a[154:155], v48 offset:33280
    ds_read_b64_tr_b16 a[156:157], v49 offset:32256
    ds_read_b64_tr_b16 a[158:159], v49 offset:33280
    v_lshlrev_b32 v96, 16, v248
    v_and_b32 v97, 0xffff0000, v248
    v_lshlrev_b32 v98, 16, v249
    v_and_b32 v99, 0xffff0000, v249
    v_lshlrev_b32 v100, 16, v250
    v_and_b32 v101, 0xffff0000, v250
    v_lshlrev_b32 v102, 16, v251
    v_and_b32 v103, 0xffff0000, v251
    v_lshlrev_b32 v104, 16, v252
    v_and_b32 v105, 0xffff0000, v252
    v_lshlrev_b32 v106, 16, v253
    v_and_b32 v107, 0xffff0000, v253
    v_lshlrev_b32 v108, 16, v254
    v_and_b32 v109, 0xffff0000, v254
    v_lshlrev_b32 v110, 16, v255
    v_and_b32 v111, 0xffff0000, v255
    s_waitcnt vmcnt(0)
    v_cmp_ne_u32 vcc, s54, v56
    s_cbranch_vccz L_chkd_28
    s_mov_b32 s63, 0
L_chk_27:
    buffer_load_dword v56, v54, s[44:47], s31 offen offset:0 sc1
    s_add_u32 s63, s63, 1
    s_cmp_ge_u32 s63, 131072
    s_waitcnt vmcnt(0)
    s_cbranch_scc1 L_chkd_28
    v_cmp_ne_u32 vcc, s54, v56
    s_cbranch_vccnz L_chk_27
L_chkd_28:
    s_cmp_lg_u32 s55, 0
    s_cbranch_scc1 L_acq_29
    buffer_inv sc1
    s_waitcnt vmcnt(0)
L_acq_29:
    buffer_load_dwordx4 v[128:131], v1, s[44:47], s32 offen offset:0 sc1
    buffer_load_dwordx4 v[132:135], v1, s[44:47], s32 offen offset:1024 sc1
    buffer_load_dwordx4 v[136:139], v1, s[44:47], s32 offen offset:2048 sc1
    buffer_load_dwordx4 v[140:143], v1, s[44:47], s32 offen offset:3072 sc1
    s_add_u32 s32, s32, 4096
    buffer_load_dwordx4 v[144:147], v1, s[44:47], s32 offen offset:0 sc1
    buffer_load_dwordx4 v[148:151], v1, s[44:47], s32 offen offset:1024 sc1
    buffer_load_dwordx4 v[152:155], v1, s[44:47], s32 offen offset:2048 sc1
    buffer_load_dwordx4 v[156:159], v1, s[44:47], s32 offen offset:3072 sc1
    v_lshrrev_b32 v24, 5, v0
    v_mul_u32_u24 v24, 4, v24
    v_bfe_u32 v5, v0, 2, 2
    v_add_u32 v24, v24, v5
    v_lshlrev_b32 v24, 7, v24
    v_bfe_u32 v4, v0, 4, 1
    v_lshl_add_u32 v24, v4, 5, v24
    v_and_b32 v4, 3, v0
    v_lshl_add_u32 v24, v4, 3, v24
    v_lshrrev_b32 v5, 1, v5
    v_lshl_add_u32 v24, v5, 6, v24
    v_xor_b32 v25, 64, v24
    v_add_u32 v26, 65536, v24
    v_add_u32 v27, 65536, v25
    v_add_u32 v28, 131072, v24
    v_add_u32 v29, 131072, v25
    s_lshl_b32 s56, s50, 13
    s_add_u32 s92, s56, 130560
    v_min_u32 v30, 27, v0
    v_lshlrev_b32 v30, 2, v30
    s_lshl_b32 s60, s48, 2
    s_add_u32 s60, s60, s50
    s_lshl_b32 s81, s60, 7
    s_add_u32 s81, s81, 12288
    s_mul_i32 s88, s60, 57344
    s_add_u32 s88, s88, 1114112
    s_add_u32 s89, s88, 28672
    s_mul_i32 s64, s60, 7168
    s_add_u32 s64, s64, 851968
    s_mul_i32 s65, s60, 229376
    s_lshl_b32 s57, s49, 12
    s_add_u32 s65, s65, s57
    s_add_u32 s65, s65, 9437184
    s_add_u32 s66, s65, 114688
    s_lshl_b32 s67, s60, 6
    s_add_u32 s67, s67, s49
    s_lshl_b32 s67, s67, 2
    s_add_u32 s67, s67, 16384
    s_add_u32 s68, s67, 128
    s_lshl_b32 s69, s48, 2
    s_add_u32 s69, s69, s61
    s_lshl_b32 s70, s69, 8
    s_mul_i32 s57, s50, 28
    s_add_u32 s70, s70, s57
    s_add_u32 s70, s70, 16384
    s_mul_i32 s71, s69, 229376
    s_mul_i32 s57, s50, 28672
    s_add_u32 s71, s71, s57
    s_add_u32 s71, s71, 9437184
    s_lshl_b32 s74, s61, 1
    s_add_u32 s74, s74, s62
    s_cmp_ge_u32 s74, 7
    s_cselect_b32 s57, 7, 0
    s_sub_u32 s74, s74, s57
    s_lshl_b32 s75, s49, 7
    s_add_u32 s75, s75, 24576
    s_lshl_b32 s76, s49, 12
    s_add_u32 s76, s76, 524288
    s_lshl_b32 s77, s69, 3
    s_add_u32 s77, s77, s50
    s_mul_i32 s77, s77, 7168
    s_lshl_b32 s57, s62, 7
    s_add_u32 s77, s77, s57
    s_add_u32 s78, s77, 28672
    s_waitcnt vmcnt(7)
    v_mfma_f32_16x16x32_bf16 v[32:35], a[0:3], v[128:131], 0
    s_add_u32 s32, s32, 4096
    buffer_load_dwordx4 v[160:163], v1, s[44:47], s32 offen offset:0 sc1
    ds_read_b64_tr_b16 a[160:161], v48 offset:35840
    ds_read_b64_tr_b16 a[162:163], v48 offset:36864
    v_mfma_f32_16x16x32_bf16 v[36:39], a[4:7], v[128:131], 0
    ds_read_b64_tr_b16 a[164:165], v49 offset:35840
    ds_read_b64_tr_b16 a[166:167], v49 offset:36864
    v_mfma_f32_16x16x32_bf16 v[40:43], a[8:11], v[128:131], 0
    ds_read_b64_tr_b16 a[168:169], v50 offset:35840
    ds_read_b64_tr_b16 a[170:171], v50 offset:36864
    v_mfma_f32_16x16x32_bf16 v[44:47], a[12:15], v[128:131], 0
    ds_read_b64_tr_b16 a[172:173], v51 offset:35840
    ds_read_b64_tr_b16 a[174:175], v51 offset:36864
    s_waitcnt vmcnt(7)
    v_mfma_f32_16x16x32_bf16 v[32:35], a[16:19], v[132:135], v[32:35]
    buffer_load_dwordx4 v[164:167], v1, s[44:47], s32 offen offset:1024 sc1
    ds_read_b64_tr_b16 a[176:177], v50 offset:39424
    ds_read_b64_tr_b16 a[178:179], v50 offset:40448
    v_mfma_f32_16x16x32_bf16 v[36:39], a[20:23], v[132:135], v[36:39]
    ds_read_b64_tr_b16 a[180:181], v51 offset:39424
    ds_read_b64_tr_b16 a[182:183], v51 offset:40448
    v_mfma_f32_16x16x32_bf16 v[40:43], a[24:27], v[132:135], v[40:43]
    ds_read_b64_tr_b16 a[184:185], v48 offset:39424
    ds_read_b64_tr_b16 a[186:187], v48 offset:40448
    v_mfma_f32_16x16x32_bf16 v[44:47], a[28:31], v[132:135], v[44:47]
    ds_read_b64_tr_b16 a[188:189], v49 offset:39424
    ds_read_b64_tr_b16 a[190:191], v49 offset:40448
    s_waitcnt vmcnt(7)
    v_mfma_f32_16x16x32_bf16 v[32:35], a[32:35], v[136:139], v[32:35]
    buffer_load_dwordx4 v[168:171], v1, s[44:47], s32 offen offset:2048 sc1
    ds_read_b64_tr_b16 a[192:193], v48 offset:43008
    ds_read_b64_tr_b16 a[194:195], v48 offset:44032
    v_mfma_f32_16x16x32_bf16 v[36:39], a[36:39], v[136:139], v[36:39]
    ds_read_b64_tr_b16 a[196:197], v49 offset:43008
    ds_read_b64_tr_b16 a[198:199], v49 offset:44032
    v_mfma_f32_16x16x32_bf16 v[40:43], a[40:43], v[136:139], v[40:43]
    ds_read_b64_tr_b16 a[200:201], v50 offset:43008
    ds_read_b64_tr_b16 a[202:203], v50 offset:44032
    v_mfma_f32_16x16x32_bf16 v[44:47], a[44:47], v[136:139], v[44:47]
    ds_read_b64_tr_b16 a[204:205], v51 offset:43008
    ds_read_b64_tr_b16 a[206:207], v51 offset:44032
    s_waitcnt vmcnt(7)
    v_mfma_f32_16x16x32_bf16 v[32:35], a[48:51], v[140:143], v[32:35]
    buffer_load_dwordx4 v[172:175], v1, s[44:47], s32 offen offset:3072 sc1
    ds_read_b64_tr_b16 a[208:209], v50 offset:46592
    ds_read_b64_tr_b16 a[210:211], v50 offset:47616
    v_mfma_f32_16x16x32_bf16 v[36:39], a[52:55], v[140:143], v[36:39]
    ds_read_b64_tr_b16 a[212:213], v51 offset:46592
    ds_read_b64_tr_b16 a[214:215], v51 offset:47616
    v_mfma_f32_16x16x32_bf16 v[40:43], a[56:59], v[140:143], v[40:43]
    ds_read_b64_tr_b16 a[216:217], v48 offset:46592
    ds_read_b64_tr_b16 a[218:219], v48 offset:47616
    v_mfma_f32_16x16x32_bf16 v[44:47], a[60:63], v[140:143], v[44:47]
    ds_read_b64_tr_b16 a[220:221], v49 offset:46592
    ds_read_b64_tr_b16 a[222:223], v49 offset:47616
    s_waitcnt vmcnt(7)
    v_mfma_f32_16x16x32_bf16 v[32:35], a[64:67], v[144:147], v[32:35]
    s_add_u32 s32, s32, 4096
    buffer_load_dwordx4 v[176:179], v1, s[44:47], s32 offen offset:0 sc1
    ds_read_b64_tr_b16 a[224:225], v48 offset:50176
    ds_read_b64_tr_b16 a[226:227], v48 offset:51200
    v_mfma_f32_16x16x32_bf16 v[36:39], a[68:71], v[144:147], v[36:39]
    ds_read_b64_tr_b16 a[228:229], v49 offset:50176
    ds_read_b64_tr_b16 a[230:231], v49 offset:51200
    v_mfma_f32_16x16x32_bf16 v[40:43], a[72:75], v[144:147], v[40:43]
    ds_read_b64_tr_b16 a[232:233], v50 offset:50176
    ds_read_b64_tr_b16 a[234:235], v50 offset:51200
    v_mfma_f32_16x16x32_bf16 v[44:47], a[76:79], v[144:147], v[44:47]
    ds_read_b64_tr_b16 a[236:237], v51 offset:50176
    ds_read_b64_tr_b16 a[238:239], v51 offset:51200
    s_waitcnt vmcnt(7)
    v_mfma_f32_16x16x32_bf16 v[32:35], a[80:83], v[148:151], v[32:35]
    buffer_load_dwordx4 v[180:183], v1, s[44:47], s32 offen offset:1024 sc1
    ds_read_b64_tr_b16 a[240:241], v50 offset:53760
    ds_read_b64_tr_b16 a[242:243], v50 offset:54784
    v_mfma_f32_16x16x32_bf16 v[36:39], a[84:87], v[148:151], v[36:39]
    ds_read_b64_tr_b16 a[244:245], v51 offset:53760
    ds_read_b64_tr_b16 a[246:247], v51 offset:54784
    v_mfma_f32_16x16x32_bf16 v[40:43], a[88:91], v[148:151], v[40:43]
    ds_read_b64_tr_b16 a[248:249], v48 offset:53760
    ds_read_b64_tr_b16 a[250:251], v48 offset:54784
    v_mfma_f32_16x16x32_bf16 v[44:47], a[92:95], v[148:151], v[44:47]
    ds_read_b64_tr_b16 a[252:253], v49 offset:53760
    ds_read_b64_tr_b16 a[254:255], v49 offset:54784
    s_waitcnt vmcnt(7)
    v_mfma_f32_16x16x32_bf16 v[32:35], a[96:99], v[152:155], v[32:35]
    buffer_load_dwordx4 v[184:187], v1, s[44:47], s32 offen offset:2048 sc1
    v_mfma_f32_16x16x32_bf16 v[36:39], a[100:103], v[152:155], v[36:39]
    v_mfma_f32_16x16x32_bf16 v[40:43], a[104:107], v[152:155], v[40:43]
    v_mfma_f32_16x16x32_bf16 v[44:47], a[108:111], v[152:155], v[44:47]
    s_waitcnt vmcnt(7)
    v_mfma_f32_16x16x32_bf16 v[32:35], a[112:115], v[156:159], v[32:35]
    buffer_load_dwordx4 v[188:191], v1, s[44:47], s32 offen offset:3072 sc1
    v_mfma_f32_16x16x32_bf16 v[36:39], a[116:119], v[156:159], v[36:39]
    v_mfma_f32_16x16x32_bf16 v[40:43], a[120:123], v[156:159], v[40:43]
    v_mfma_f32_16x16x32_bf16 v[44:47], a[124:127], v[156:159], v[44:47]
    s_waitcnt vmcnt(7) lgkmcnt(15)
    v_mfma_f32_16x16x32_bf16 v[32:35], a[128:131], v[160:163], v[32:35]
    v_mfma_f32_16x16x32_bf16 v[36:39], a[132:135], v[160:163], v[36:39]
    v_mfma_f32_16x16x32_bf16 v[40:43], a[136:139], v[160:163], v[40:43]
    v_mfma_f32_16x16x32_bf16 v[44:47], a[140:143], v[160:163], v[44:47]
    s_waitcnt vmcnt(6)
    v_mfma_f32_16x16x32_bf16 v[32:35], a[144:147], v[164:167], v[32:35]
    v_mfma_f32_16x16x32_bf16 v[36:39], a[148:151], v[164:167], v[36:39]
    v_mfma_f32_16x16x32_bf16 v[40:43], a[152:155], v[164:167], v[40:43]
    v_mfma_f32_16x16x32_bf16 v[44:47], a[156:159], v[164:167], v[44:47]
    s_waitcnt vmcnt(5)
    v_mfma_f32_16x16x32_bf16 v[32:35], a[160:163], v[168:171], v[32:35]
    v_mfma_f32_16x16x32_bf16 v[36:39], a[164:167], v[168:171], v[36:39]
    v_mfma_f32_16x16x32_bf16 v[40:43], a[168:171], v[168:171], v[40:43]
    v_mfma_f32_16x16x32_bf16 v[44:47], a[172:175], v[168:171], v[44:47]
    s_waitcnt vmcnt(4)
    v_mfma_f32_16x16x32_bf16 v[32:35], a[176:179], v[172:175], v[32:35]
    v_mfma_f32_16x16x32_bf16 v[36:39], a[180:183], v[172:175], v[36:39]
    v_mfma_f32_16x16x32_bf16 v[40:43], a[184:187], v[172:175], v[40:43]
    v_mfma_f32_16x16x32_bf16 v[44:47], a[188:191], v[172:175], v[44:47]
    s_waitcnt vmcnt(3)
    v_mfma_f32_16x16x32_bf16 v[32:35], a[192:195], v[176:179], v[32:35]
    v_mfma_f32_16x16x32_bf16 v[36:39], a[196:199], v[176:179], v[36:39]
    v_mfma_f32_16x16x32_bf16 v[40:43], a[200:203], v[176:179], v[40:43]
    v_mfma_f32_16x16x32_bf16 v[44:47], a[204:207], v[176:179], v[44:47]
    s_waitcnt vmcnt(2)
    v_mfma_f32_16x16x32_bf16 v[32:35], a[208:211], v[180:183], v[32:35]
    v_mfma_f32_16x16x32_bf16 v[36:39], a[212:215], v[180:183], v[36:39]
    v_mfma_f32_16x16x32_bf16 v[40:43], a[216:219], v[180:183], v[40:43]
    v_mfma_f32_16x16x32_bf16 v[44:47], a[220:223], v[180:183], v[44:47]
    s_waitcnt vmcnt(1) lgkmcnt(8)
    v_mfma_f32_16x16x32_bf16 v[32:35], a[224:227], v[184:187], v[32:35]
    v_mfma_f32_16x16x32_bf16 v[36:39], a[228:231], v[184:187], v[36:39]
    v_mfma_f32_16x16x32_bf16 v[40:43], a[232:235], v[184:187], v[40:43]
    v_mfma_f32_16x16x32_bf16 v[44:47], a[236:239], v[184:187], v[44:47]
    s_waitcnt vmcnt(0) lgkmcnt(0)
    v_mfma_f32_16x16x32_bf16 v[32:35], a[240:243], v[188:191], v[32:35]
    v_mfma_f32_16x16x32_bf16 v[36:39], a[244:247], v[188:191], v[36:39]
    v_mfma_f32_16x16x32_bf16 v[40:43], a[248:251], v[188:191], v[40:43]
    v_mfma_f32_16x16x32_bf16 v[44:47], a[252:255], v[188:191], v[44:47]
    s_nop 4
    v_fmac_f32 v96, v64, v32
    v_fmac_f32 v97, v65, v33
    v_fmac_f32 v98, v66, v34
    v_fmac_f32 v99, v67, v35
    v_fmac_f32 v100, v68, v36
    v_fmac_f32 v101, v69, v37
    v_fmac_f32 v102, v70, v38
    v_fmac_f32 v103, v71, v39
    v_cvt_pk_bf16_f32 v112, v96, v97
    v_cvt_pk_bf16_f32 v113, v98, v99
    v_cvt_pk_bf16_f32 v114, v100, v101
    v_cvt_pk_bf16_f32 v115, v102, v103
    v_lshlrev_b32 v96, 16, v112
    v_and_b32 v97, 0xffff0000, v112
    v_lshlrev_b32 v98, 16, v113
    v_and_b32 v99, 0xffff0000, v113
    v_lshlrev_b32 v100, 16, v114
    v_and_b32 v101, 0xffff0000, v114
    v_lshlrev_b32 v102, 16, v115
    v_and_b32 v103, 0xffff0000, v115
    v_pk_mul_f32 v[80:81], v[80:81], v[96:97]
    v_pk_mul_f32 v[82:83], v[82:83], v[98:99]
    v_pk_mul_f32 v[84:85], v[84:85], v[100:101]
    v_pk_mul_f32 v[86:87], v[86:87], v[102:103]
    v_cvt_pk_bf16_f32 v120, v80, v81
    v_cvt_pk_bf16_f32 v121, v82, v83
    v_cvt_pk_bf16_f32 v122, v84, v85
    v_cvt_pk_bf16_f32 v123, v86, v87
    buffer_store_dwordx4 v[120:123], v52, s[44:47], s28 offen offset:0
    v_fmac_f32 v104, v72, v40
    v_fmac_f32 v105, v73, v41
    v_fmac_f32 v106, v74, v42
    v_fmac_f32 v107, v75, v43
    v_fmac_f32 v108, v76, v44
    v_fmac_f32 v109, v77, v45
    v_fmac_f32 v110, v78, v46
    v_fmac_f32 v111, v79, v47
    v_cvt_pk_bf16_f32 v116, v104, v105
    v_cvt_pk_bf16_f32 v117, v106, v107
    v_cvt_pk_bf16_f32 v118, v108, v109
    v_cvt_pk_bf16_f32 v119, v110, v111
    v_lshlrev_b32 v104, 16, v116
    v_and_b32 v105, 0xffff0000, v116
    v_lshlrev_b32 v106, 16, v117
    v_and_b32 v107, 0xffff0000, v117
    v_lshlrev_b32 v108, 16, v118
    v_and_b32 v109, 0xffff0000, v118
    v_lshlrev_b32 v110, 16, v119
    v_and_b32 v111, 0xffff0000, v119
    v_pk_mul_f32 v[88:89], v[88:89], v[104:105]
    v_pk_mul_f32 v[90:91], v[90:91], v[106:107]
    v_pk_mul_f32 v[92:93], v[92:93], v[108:109]
    v_pk_mul_f32 v[94:95], v[94:95], v[110:111]
    v_cvt_pk_bf16_f32 v124, v88, v89
    v_cvt_pk_bf16_f32 v125, v90, v91
    v_cvt_pk_bf16_f32 v126, v92, v93
    v_cvt_pk_bf16_f32 v127, v94, v95
    buffer_store_dwordx4 v[124:127], v52, s[44:47], s28 offen offset:2048
    v_pk_add_f32 v[4:5], v[96:97], v[98:99]
    v_pk_add_f32 v[6:7], v[100:101], v[102:103]
    v_pk_add_f32 v[4:5], v[4:5], v[104:105]
    v_pk_add_f32 v[6:7], v[6:7], v[106:107]
    v_pk_add_f32 v[4:5], v[4:5], v[108:109]
    v_pk_add_f32 v[6:7], v[6:7], v[110:111]
    v_pk_add_f32 v[4:5], v[4:5], v[6:7]
    v_add_f32 v8, v4, v5
    v_mov_b32 v7, v8
    s_nop 1
    v_permlane16_swap_b32 v8, v7
    v_add_f32 v8, v8, v7
    v_mov_b32 v7, v8
    s_nop 1
    v_permlane32_swap_b32 v8, v7
    v_add_f32 v8, v8, v7
    s_waitcnt vmcnt(0)
    v_mov_b32 v7, s54
    s_cmp_lg_u32 s55, 0
    s_cbranch_scc0 L_slowpub_30
    s_mov_b64 exec, 1
    buffer_store_dword v7, off, s[44:47], s30
    s_branch L_pub_31
L_slowpub_30:
    buffer_wbl2 sc1
    s_waitcnt vmcnt(0)
    s_mov_b64 exec, 1
    buffer_store_dword v7, off, s[44:47], s30 sc1
L_pub_31:
    s_mov_b64 exec, -1
    v_mul_f32 v6, 0x3c800000, v8
    v_pk_add_f32 v[96:97], v[96:97], v[6:7] op_sel_hi:[1,0] neg_lo:[0,1] neg_hi:[0,1]
    v_pk_add_f32 v[98:99], v[98:99], v[6:7] op_sel_hi:[1,0] neg_lo:[0,1] neg_hi:[0,1]
    v_pk_add_f32 v[100:101], v[100:101], v[6:7] op_sel_hi:[1,0] neg_lo:[0,1] neg_hi:[0,1]
    v_pk_add_f32 v[102:103], v[102:103], v[6:7] op_sel_hi:[1,0] neg_lo:[0,1] neg_hi:[0,1]
    v_pk_add_f32 v[104:105], v[104:105], v[6:7] op_sel_hi:[1,0] neg_lo:[0,1] neg_hi:[0,1]
    v_pk_add_f32 v[106:107], v[106:107], v[6:7] op_sel_hi:[1,0] neg_lo:[0,1] neg_hi:[0,1]
    v_pk_add_f32 v[108:109], v[108:109], v[6:7] op_sel_hi:[1,0] neg_lo:[0,1] neg_hi:[0,1]
    v_pk_add_f32 v[110:111], v[110:111], v[6:7] op_sel_hi:[1,0] neg_lo:[0,1] neg_hi:[0,1]
    v_pk_mul_f32 v[4:5], v[96:97], v[96:97]
    v_pk_mul_f32 v[6:7], v[98:99], v[98:99]
    v_pk_fma_f32 v[4:5], v[100:101], v[100:101], v[4:5]
    v_pk_fma_f32 v[6:7], v[102:103], v[102:103], v[6:7]
    v_pk_fma_f32 v[4:5], v[104:105], v[104:105], v[4:5]
    v_pk_fma_f32 v[6:7], v[106:107], v[106:107], v[6:7]
    v_pk_fma_f32 v[4:5], v[108:109], v[108:109], v[4:5]
    v_pk_fma_f32 v[6:7], v[110:111], v[110:111], v[6:7]
    v_pk_add_f32 v[4:5], v[4:5], v[6:7]
    v_add_f32 v9, v4, v5
    v_mov_b32 v7, v9
    s_nop 1
    v_permlane16_swap_b32 v9, v7
    v_add_f32 v9, v9, v7
    v_mov_b32 v7, v9
    s_nop 1
    v_permlane32_swap_b32 v9, v7
    v_add_f32 v9, v9, v7
    v_mov_b32 v10, s54
    v_mov_b32 v11, s54
    s_barrier
    ds_write_b64 v53, v[112:113] offset:0
    ds_write_b64 v53, v[114:115] offset:32
    ds_write_b64 v53, v[116:117] offset:64
    ds_write_b64 v53, v[118:119] offset:96
    ds_read_b64_tr_b16 a[224:225], v26 offset:24064
    ds_read_b64_tr_b16 a[226:227], v26 offset:26112
    ds_read_b64_tr_b16 a[228:229], v27 offset:24064
    ds_read_b64_tr_b16 a[230:231], v27 offset:26112
    ds_read_b64_tr_b16 a[232:233], v26 offset:28160
    ds_read_b64_tr_b16 a[234:235], v26 offset:30208
    ds_read_b64_tr_b16 a[236:237], v27 offset:28160
    ds_read_b64_tr_b16 a[238:239], v27 offset:30208
    s_mov_b32 s63, 0
L_poll_32:
    buffer_load_dword v31, v30, s[44:47], s81 offen offset:0 sc1
    s_add_u32 s63, s63, 1
    s_cmp_ge_u32 s63, 131072
    s_waitcnt vmcnt(0)
    s_cbranch_scc1 L_polled_33
    v_cmp_ne_u32 vcc, s54, v31
    s_cbranch_vccnz L_poll_32
L_polled_33:
    s_cmp_lg_u32 s55, 0
    s_cbranch_scc1 L_acq_34
    buffer_inv sc1
    s_waitcnt vmcnt(0)
L_acq_34:
    buffer_load_dwordx4 v[64:67], v1, s[44:47], s88 offen offset:0 sc1
    buffer_load_dwordx4 v[68:71], v1, s[44:47], s89 offen offset:0 sc1
    buffer_load_dwordx4 v[72:75], v1, s[44:47], s88 offen offset:1024 sc1
    buffer_load_dwordx4 v[76:79], v1, s[44:47], s89 offen offset:1024 sc1
    buffer_load_dwordx4 v[80:83], v1, s[44:47], s88 offen offset:2048 sc1
    buffer_load_dwordx4 v[84:87], v1, s[44:47], s89 offen offset:2048 sc1
    s_waitcnt vmcnt(5) lgkmcnt(6)
    v_mfma_f32_32x32x16_bf16 v[128:143], a[224:227], v[64:67], 0
    ds_read_b64_tr_b16 a[240:241], v26 offset:25088
    buffer_load_dwordx4 v[88:91], v1, s[44:47], s88 offen offset:3072 sc1
    s_waitcnt vmcnt(5)
    v_mfma_f32_32x32x16_bf16 v[192:207], a[224:227], v[68:71], 0
    ds_read_b64_tr_b16 a[242:243], v26 offset:27136
    buffer_load_dwordx4 v[92:95], v1, s[44:47], s89 offen offset:3072 sc1
    s_waitcnt lgkmcnt(6)
    v_mfma_f32_32x32x16_bf16 v[144:159], a[228:231], v[64:67], 0
    ds_read_b64_tr_b16 a[244:245], v27 offset:25088
    s_add_u32 s88, s88, 4096
    buffer_load_dwordx4 v[96:99], v1, s[44:47], s88 offen offset:0 sc1
    v_mfma_f32_32x32x16_bf16 v[208:223], a[228:231], v[68:71], 0
    ds_read_b64_tr_b16 a[246:247], v27 offset:27136
    s_add_u32 s89, s89, 4096
    buffer_load_dwordx4 v[100:103], v1, s[44:47], s89 offen offset:0 sc1
    s_waitcnt lgkmcnt(6)
    v_mfma_f32_32x32x16_bf16 v[160:175], a[232:235], v[64:67], 0
    ds_read_b64_tr_b16 a[248:249], v26 offset:29184
    buffer_load_dwordx4 v[104:107], v1, s[44:47], s88 offen offset:1024 sc1
    s_add_u32 s59, s99, 458752
    s_add_u32 m0, s101, 77824
    s_nop 0
    buffer_load_dwordx4 v12, s[16:19], s59 offen lds
    v_mfma_f32_32x32x16_bf16 v[224:239], a[232:235], v[68:71], 0
    ds_read_b64_tr_b16 a[250:251], v26 offset:31232
    buffer_load_dwordx4 v[108:111], v1, s[44:47], s89 offen offset:1024 sc1
    s_mov_b64 exec, 0xffff
    buffer_store_dwordx4 v[8:11], v1, s[44:47], s29 offen sc1
    s_mov_b64 exec, -1
    s_waitcnt lgkmcnt(6)
    v_mfma_f32_32x32x16_bf16 v[176:191], a[236:239], v[64:67], 0
    ds_read_b64_tr_b16 a[252:253], v27 offset:29184
    s_lshl_b32 s59, s41, 7
    s_add_u32 s59, s59, 720896
    s_cmp_ge_u32 s41, 784
    s_cselect_b32 s59, 0x7ff00000, s59
    v_mov_b32 v4, s54
    s_mov_b64 exec, 1
    buffer_store_dword v4, off, s[44:47], s59 sc1
    s_mov_b64 exec, -1
    v_mfma_f32_32x32x16_bf16 v[240:255], a[236:239], v[68:71], 0
    ds_read_b64_tr_b16 a[254:255], v27 offset:31232
    s_waitcnt vmcnt(12) lgkmcnt(6)
    v_mfma_f32_32x32x16_bf16 v[128:143], a[240:243], v[72:75], v[128:143]
    ds_read_b64_tr_b16 a[224:225], v26 offset:32256
    buffer_load_dwordx4 v[64:67], v1, s[44:47], s88 offen offset:2048 sc1
    s_waitcnt vmcnt(12)
    v_mfma_f32_32x32x16_bf16 v[192:207], a[240:243], v[76:79], v[192:207]
    ds_read_b64_tr_b16 a[226:227], v26 offset:34304
    s_add_u32 s59, s99, 458752
    s_add_u32 m0, s101, 81920
    s_nop 0
    buffer_load_dwordx4 v12, s[20:23], s59 offen lds
    s_waitcnt lgkmcnt(6)
    v_mfma_f32_32x32x16_bf16 v[144:159], a[244:247], v[72:75], v[144:159]
    ds_read_b64_tr_b16 a[228:229], v27 offset:32256
    v_mfma_f32_32x32x16_bf16 v[208:223], a[244:247], v[76:79], v[208:223]
    ds_read_b64_tr_b16 a[230:231], v27 offset:34304
    s_waitcnt lgkmcnt(6)
    v_mfma_f32_32x32x16_bf16 v[160:175], a[248:251], v[72:75], v[160:175]
    ds_read_b64_tr_b16 a[232:233], v26 offset:36352
    buffer_load_dwordx4 v[68:71], v1, s[44:47], s89 offen offset:2048 sc1
    v_mfma_f32_32x32x16_bf16 v[224:239], a[248:251], v[76:79], v[224:239]
    ds_read_b64_tr_b16 a[234:235], v26 offset:38400
    s_waitcnt lgkmcnt(6)
    v_mfma_f32_32x32x16_bf16 v[176:191], a[252:255], v[72:75], v[176:191]
    ds_read_b64_tr_b16 a[236:237], v27 offset:36352
    s_add_u32 s59, s99, 573440
    s_add_u32 m0, s101, 3584
    s_nop 0
    buffer_load_dwordx4 v12, s[16:19], s59 offen lds
    v_mfma_f32_32x32x16_bf16 v[240:255], a[252:255], v[76:79], v[240:255]
    ds_read_b64_tr_b16 a[238:239], v27 offset:38400
    s_waitcnt vmcnt(14) lgkmcnt(6)
    v_mfma_f32_32x32x16_bf16 v[128:143], a[224:227], v[80:83], v[128:143]
    ds_read_b64_tr_b16 a[240:241], v26 offset:33280
    buffer_load_dwordx4 v[72:75], v1, s[44:47], s88 offen offset:3072 sc1
    s_waitcnt vmcnt(14)
    v_mfma_f32_32x32x16_bf16 v[192:207], a[224:227], v[84:87], v[192:207]
    ds_read_b64_tr_b16 a[242:243], v26 offset:35328
    s_waitcnt lgkmcnt(6)
    v_mfma_f32_32x32x16_bf16 v[144:159], a[228:231], v[80:83], v[144:159]
    ds_read_b64_tr_b16 a[244:245], v27 offset:33280
    v_mfma_f32_32x32x16_bf16 v[208:223], a[228:231], v[84:87], v[208:223]
    ds_read_b64_tr_b16 a[246:247], v27 offset:35328
    s_add_u32 s59, s99, 573440
    s_add_u32 m0, s101, 7680
    s_nop 0
    buffer_load_dwordx4 v12, s[20:23], s59 offen lds
    s_waitcnt lgkmcnt(6)
    v_mfma_f32_32x32x16_bf16 v[160:175], a[232:235], v[80:83], v[160:175]
    ds_read_b64_tr_b16 a[248:249], v26 offset:37376
    buffer_load_dwordx4 v[76:79], v1, s[44:47], s89 offen offset:3072 sc1
    v_mfma_f32_32x32x16_bf16 v[224:239], a[232:235], v[84:87], v[224:239]
    ds_read_b64_tr_b16 a[250:251], v26 offset:39424
    s_waitcnt lgkmcnt(6)
    v_mfma_f32_32x32x16_bf16 v[176:191], a[236:239], v[80:83], v[176:191]
    ds_read_b64_tr_b16 a[252:253], v27 offset:37376
    v_mfma_f32_32x32x16_bf16 v[240:255], a[236:239], v[84:87], v[240:255]
    ds_read_b64_tr_b16 a[254:255], v27 offset:39424
    s_waitcnt vmcnt(15) lgkmcnt(6)
    v_mfma_f32_32x32x16_bf16 v[128:143], a[240:243], v[88:91], v[128:143]
    ds_read_b64_tr_b16 a[224:225], v24 offset:61440
    s_add_u32 s88, s88, 4096
    buffer_load_dwordx4 v[80:83], v1, s[44:47], s88 offen offset:0 sc1
    s_add_u32 s59, s99, 688128
    s_add_u32 m0, s101, 11776
    s_nop 0
    buffer_load_dwordx4 v12, s[16:19], s59 offen lds
    s_waitcnt vmcnt(16)
    v_mfma_f32_32x32x16_bf16 v[192:207], a[240:243], v[92:95], v[192:207]
    ds_read_b64_tr_b16 a[226:227], v24 offset:63488
    s_waitcnt lgkmcnt(6)
    v_mfma_f32_32x32x16_bf16 v[144:159], a[244:247], v[88:91], v[144:159]
    ds_read_b64_tr_b16 a[228:229], v25 offset:61440
    v_mfma_f32_32x32x16_bf16 v[208:223], a[244:247], v[92:95], v[208:223]
    ds_read_b64_tr_b16 a[230:231], v25 offset:63488
    s_waitcnt lgkmcnt(6)
    v_mfma_f32_32x32x16_bf16 v[160:175], a[248:251], v[88:91], v[160:175]
    ds_read_b64_tr_b16 a[232:233], v26 offset:0
    s_add_u32 s89, s89, 4096
    buffer_load_dwordx4 v[84:87], v1, s[44:47], s89 offen offset:0 sc1
    v_mfma_f32_32x32x16_bf16 v[224:239], a[248:251], v[92:95], v[224:239]
    ds_read_b64_tr_b16 a[234:235], v26 offset:2048
    s_add_u32 s59, s99, 688128
    s_add_u32 m0, s101, 15872
    s_nop 0
    buffer_load_dwordx4 v12, s[20:23], s59 offen lds
    s_waitcnt lgkmcnt(6)
    v_mfma_f32_32x32x16_bf16 v[176:191], a[252:255], v[88:91], v[176:191]
    ds_read_b64_tr_b16 a[236:237], v27 offset:0
    v_mfma_f32_32x32x16_bf16 v[240:255], a[252:255], v[92:95], v[240:255]
    ds_read_b64_tr_b16 a[238:239], v27 offset:2048
    s_waitcnt vmcnt(17) lgkmcnt(6)
    v_mfma_f32_32x32x16_bf16 v[128:143], a[224:227], v[96:99], v[128:143]
    ds_read_b64_tr_b16 a[240:241], v24 offset:62464
    buffer_load_dwordx4 v[88:91], v1, s[44:47], s88 offen offset:1024 sc1
    s_waitcnt vmcnt(17)
    v_mfma_f32_32x32x16_bf16 v[192:207], a[224:227], v[100:103], v[192:207]
    ds_read_b64_tr_b16 a[242:243], v24 offset:64512
    s_waitcnt lgkmcnt(6)
    v_mfma_f32_32x32x16_bf16 v[144:159], a[228:231], v[96:99], v[144:159]
    ds_read_b64_tr_b16 a[244:245], v25 offset:62464
    s_add_u32 s59, s99, 802816
    s_add_u32 m0, s101, 19968
    s_nop 0
    buffer_load_dwordx4 v12, s[16:19], s59 offen lds
    v_mfma_f32_32x32x16_bf16 v[208:223], a[228:231], v[100:103], v[208:223]
    ds_read_b64_tr_b16 a[246:247], v25 offset:64512
    s_waitcnt lgkmcnt(6)
    v_mfma_f32_32x32x16_bf16 v[160:175], a[232:235], v[96:99], v[160:175]
    ds_read_b64_tr_b16 a[248:249], v26 offset:1024
    buffer_load_dwordx4 v[92:95], v1, s[44:47], s89 offen offset:1024 sc1
    v_mfma_f32_32x32x16_bf16 v[224:239], a[232:235], v[100:103], v[224:239]
    ds_read_b64_tr_b16 a[250:251], v26 offset:3072
    s_waitcnt lgkmcnt(6)
    v_mfma_f32_32x32x16_bf16 v[176:191], a[236:239], v[96:99], v[176:191]
    ds_read_b64_tr_b16 a[252:253], v27 offset:1024
    v_mfma_f32_32x32x16_bf16 v[240:255], a[236:239], v[100:103], v[240:255]
    ds_read_b64_tr_b16 a[254:255], v27 offset:3072
    s_add_u32 s59, s99, 802816
    s_add_u32 m0, s101, 24064
    s_nop 0
    buffer_load_dwordx4 v12, s[20:23], s59 offen lds
    s_waitcnt vmcnt(19) lgkmcnt(6)
    v_mfma_f32_32x32x16_bf16 v[128:143], a[240:243], v[104:107], v[128:143]
    ds_read_b64_tr_b16 a[224:225], v26 offset:4096
    buffer_load_dwordx4 v[96:99], v1, s[44:47], s88 offen offset:2048 sc1
    s_waitcnt vmcnt(18)
    v_mfma_f32_32x32x16_bf16 v[192:207], a[240:243], v[108:111], v[192:207]
    ds_read_b64_tr_b16 a[226:227], v26 offset:6144
    s_waitcnt lgkmcnt(6)
    v_mfma_f32_32x32x16_bf16 v[144:159], a[244:247], v[104:107], v[144:159]
    ds_read_b64_tr_b16 a[228:229], v27 offset:4096
    v_mfma_f32_32x32x16_bf16 v[208:223], a[244:247], v[108:111], v[208:223]
    ds_read_b64_tr_b16 a[230:231], v27 offset:6144
    s_waitcnt lgkmcnt(6)
    v_mfma_f32_32x32x16_bf16 v[160:175], a[248:251], v[104:107], v[160:175]
    ds_read_b64_tr_b16 a[232:233], v26 offset:8192
    buffer_load_dwordx4 v[100:103], v1, s[44:47], s89 offen offset:2048 sc1
    s_add_u32 s59, s99, 917504
    s_add_u32 m0, s101, 28160
    s_nop 0
    buffer_load_dwordx4 v12, s[16:19], s59 offen lds
    v_mfma_f32_32x32x16_bf16 v[224:239], a[248:251], v[108:111], v[224:239]
    ds_read_b64_tr_b16 a[234:235], v26 offset:10240
    s_waitcnt lgkmcnt(6)
    v_mfma_f32_32x32x16_bf16 v[176:191], a[252:255], v[104:107], v[176:191]
    ds_read_b64_tr_b16 a[236:237], v27 offset:8192
    v_mfma_f32_32x32x16_bf16 v[240:255], a[252:255], v[108:111], v[240:255]
    ds_read_b64_tr_b16 a[238:239], v27 offset:10240
    s_waitcnt vmcnt(17) lgkmcnt(6)
    v_mfma_f32_32x32x16_bf16 v[128:143], a[224:227], v[64:67], v[128:143]
    ds_read_b64_tr_b16 a[240:241], v26 offset:5120
    buffer_load_dwordx4 v[104:107], v1, s[44:47], s88 offen offset:3072 sc1
    buffer_load_dwordx4 v[32:35], v1, s[44:47], s64 offen offset:0 sc1
    s_waitcnt vmcnt(17)
    v_mfma_f32_32x32x16_bf16 v[192:207], a[224:227], v[68:71], v[192:207]
    ds_read_b64_tr_b16 a[242:243], v26 offset:7168
    s_add_u32 s59, s99, 917504
    s_add_u32 m0, s101, 32256
    s_nop 0
    buffer_load_dwordx4 v12, s[20:23], s59 offen lds
    s_waitcnt lgkmcnt(6)
    v_mfma_f32_32x32x16_bf16 v[144:159], a[228:231], v[64:67], v[144:159]
    ds_read_b64_tr_b16 a[244:245], v27 offset:5120
    buffer_load_dwordx4 v[36:39], v1, s[44:47], s64 offen offset:1024 sc1
    v_mfma_f32_32x32x16_bf16 v[208:223], a[228:231], v[68:71], v[208:223]
    ds_read_b64_tr_b16 a[246:247], v27 offset:7168
    s_waitcnt lgkmcnt(6)
    v_mfma_f32_32x32x16_bf16 v[160:175], a[232:235], v[64:67], v[160:175]
    ds_read_b64_tr_b16 a[248:249], v26 offset:9216
    buffer_load_dwordx4 v[108:111], v1, s[44:47], s89 offen offset:3072 sc1
    buffer_load_dwordx4 v[40:43], v1, s[44:47], s64 offen offset:2048 sc1
    v_mfma_f32_32x32x16_bf16 v[224:239], a[232:235], v[68:71], v[224:239]
    ds_read_b64_tr_b16 a[250:251], v26 offset:11264
    s_waitcnt lgkmcnt(6)
    v_mfma_f32_32x32x16_bf16 v[176:191], a[236:239], v[64:67], v[176:191]
    ds_read_b64_tr_b16 a[252:253], v27 offset:9216
    s_add_u32 s59, s99, 1032192
    s_add_u32 m0, s101, 36352
    s_nop 0
    buffer_load_dwordx4 v12, s[16:19], s59 offen lds
    buffer_load_dwordx4 v[44:47], v1, s[44:47], s64 offen offset:3072 sc1
    v_mfma_f32_32x32x16_bf16 v[240:255], a[236:239], v[68:71], v[240:255]
    ds_read_b64_tr_b16 a[254:255], v27 offset:11264
    s_waitcnt vmcnt(15)
    s_barrier
    s_waitcnt lgkmcnt(6)
    v_mfma_f32_32x32x16_bf16 v[128:143], a[240:243], v[72:75], v[128:143]
    ds_read_b64_tr_b16 a[224:225], v26 offset:12288
    s_add_u32 s88, s88, 4096
    buffer_load_dwordx4 v[64:67], v1, s[44:47], s88 offen offset:0 sc1
    s_add_u32 s82, s64, 4096
    buffer_load_dwordx4 v[48:51], v1, s[44:47], s82 offen offset:0 sc1
    v_mfma_f32_32x32x16_bf16 v[192:207], a[240:243], v[76:79], v[192:207]
    ds_read_b64_tr_b16 a[226:227], v26 offset:14336
    s_waitcnt lgkmcnt(6)
    v_mfma_f32_32x32x16_bf16 v[144:159], a[244:247], v[72:75], v[144:159]
    ds_read_b64_tr_b16 a[228:229], v27 offset:12288
    buffer_load_dwordx4 v[52:55], v1, s[44:47], s82 offen offset:1024 sc1
    v_mfma_f32_32x32x16_bf16 v[208:223], a[244:247], v[76:79], v[208:223]
    ds_read_b64_tr_b16 a[230:231], v27 offset:14336
    s_add_u32 s59, s99, 1032192
    s_add_u32 m0, s101, 40448
    s_nop 0
    buffer_load_dwordx4 v12, s[20:23], s59 offen lds
    s_waitcnt lgkmcnt(6)
    v_mfma_f32_32x32x16_bf16 v[160:175], a[248:251], v[72:75], v[160:175]
    ds_read_b64_tr_b16 a[232:233], v26 offset:16384
    s_add_u32 s89, s89, 4096
    buffer_load_dwordx4 v[68:71], v1, s[44:47], s89 offen offset:0 sc1
    buffer_load_dwordx4 v[56:59], v1, s[44:47], s82 offen offset:2048 sc1
    v_mfma_f32_32x32x16_bf16 v[224:239], a[248:251], v[76:79], v[224:239]
    ds_read_b64_tr_b16 a[234:235], v26 offset:18432
    s_waitcnt lgkmcnt(6)
    v_mfma_f32_32x32x16_bf16 v[176:191], a[252:255], v[72:75], v[176:191]
    ds_read_b64_tr_b16 a[236:237], v27 offset:16384
    v_mfma_f32_32x32x16_bf16 v[240:255], a[252:255], v[76:79], v[240:255]
    ds_read_b64_tr_b16 a[238:239], v27 offset:18432
    s_waitcnt lgkmcnt(6)
    v_mfma_f32_32x32x16_bf16 v[128:143], a[224:227], v[80:83], v[128:143]
    ds_read_b64_tr_b16 a[240:241], v26 offset:13312
    buffer_load_dwordx4 v[72:75], v1, s[44:47], s88 offen offset:1024 sc1
    s_add_u32 s59, s99, 1146880
    s_add_u32 m0, s101, 44544
    s_nop 0
    buffer_load_dwordx4 v12, s[16:19], s59 offen lds
    v_mfma_f32_32x32x16_bf16 v[192:207], a[224:227], v[84:87], v[192:207]
    ds_read_b64_tr_b16 a[242:243], v26 offset:15360
    s_waitcnt lgkmcnt(6)
    v_mfma_f32_32x32x16_bf16 v[144:159], a[228:231], v[80:83], v[144:159]
    ds_read_b64_tr_b16 a[244:245], v27 offset:13312
    v_mfma_f32_32x32x16_bf16 v[208:223], a[228:231], v[84:87], v[208:223]
    ds_read_b64_tr_b16 a[246:247], v27 offset:15360
    s_waitcnt lgkmcnt(6)
    v_mfma_f32_32x32x16_bf16 v[160:175], a[232:235], v[80:83], v[160:175]
    ds_read_b64_tr_b16 a[248:249], v26 offset:17408
    buffer_load_dwordx4 v[76:79], v1, s[44:47], s89 offen offset:1024 sc1
    v_mfma_f32_32x32x16_bf16 v[224:239], a[232:235], v[84:87], v[224:239]
    ds_read_b64_tr_b16 a[250:251], v26 offset:19456
    s_add_u32 s59, s99, 1146880
    s_add_u32 m0, s101, 48640
    s_nop 0
    buffer_load_dwordx4 v12, s[20:23], s59 offen lds
    s_waitcnt lgkmcnt(6)
    v_mfma_f32_32x32x16_bf16 v[176:191], a[236:239], v[80:83], v[176:191]
    ds_read_b64_tr_b16 a[252:253], v27 offset:17408
    v_mfma_f32_32x32x16_bf16 v[240:255], a[236:239], v[84:87], v[240:255]
    ds_read_b64_tr_b16 a[254:255], v27 offset:19456
    s_waitcnt vmcnt(24) lgkmcnt(6)
    v_mfma_f32_32x32x16_bf16 v[128:143], a[240:243], v[88:91], v[128:143]
    ds_read_b64_tr_b16 a[224:225], v24 offset:3584
    buffer_load_dwordx4 v[80:83], v1, s[44:47], s88 offen offset:2048 sc1
    s_waitcnt vmcnt(23)
    v_mfma_f32_32x32x16_bf16 v[192:207], a[240:243], v[92:95], v[192:207]
    ds_read_b64_tr_b16 a[226:227], v24 offset:5632
    s_waitcnt lgkmcnt(6)
    v_mfma_f32_32x32x16_bf16 v[144:159], a[244:247], v[88:91], v[144:159]
    ds_read_b64_tr_b16 a[228:229], v25 offset:3584
    s_add_u32 s59, s99, 1261568
    s_add_u32 m0, s101, 52736
    s_nop 0
    buffer_load_dwordx4 v12, s[16:19], s59 offen lds
    v_mfma_f32_32x32x16_bf16 v[208:223], a[244:247], v[92:95], v[208:223]
    ds_read_b64_tr_b16 a[230:231], v25 offset:5632
    s_waitcnt lgkmcnt(6)
    v_mfma_f32_32x32x16_bf16 v[160:175], a[248:251], v[88:91], v[160:175]
    ds_read_b64_tr_b16 a[232:233], v24 offset:7680
    buffer_load_dwordx4 v[84:87], v1, s[44:47], s88 offen offset:3072 sc1
    v_mfma_f32_32x32x16_bf16 v[224:239], a[248:251], v[92:95], v[224:239]
    ds_read_b64_tr_b16 a[234:235], v24 offset:9728
    s_waitcnt lgkmcnt(6)
    v_mfma_f32_32x32x16_bf16 v[176:191], a[252:255], v[88:91], v[176:191]
    ds_read_b64_tr_b16 a[236:237], v25 offset:7680
    v_mfma_f32_32x32x16_bf16 v[240:255], a[252:255], v[92:95], v[240:255]
    ds_read_b64_tr_b16 a[238:239], v25 offset:9728
    s_add_u32 s59, s99, 1261568
    s_add_u32 m0, s101, 56832
    s_nop 0
    buffer_load_dwordx4 v12, s[20:23], s59 offen lds
    s_waitcnt vmcnt(24) lgkmcnt(6)
    v_mfma_f32_32x32x16_bf16 v[128:143], a[224:227], v[96:99], v[128:143]
    ds_read_b64_tr_b16 a[240:241], v24 offset:4608
    s_add_u32 s88, s88, 4096
    buffer_load_dwordx4 v[88:91], v1, s[44:47], s88 offen offset:0 sc1
    s_waitcnt vmcnt(24)
    v_mfma_f32_32x32x16_bf16 v[192:207], a[224:227], v[100:103], v[192:207]
    ds_read_b64_tr_b16 a[242:243], v24 offset:6656
    s_waitcnt lgkmcnt(6)
    v_mfma_f32_32x32x16_bf16 v[144:159], a[228:231], v[96:99], v[144:159]
    ds_read_b64_tr_b16 a[244:245], v25 offset:4608
    v_mfma_f32_32x32x16_bf16 v[208:223], a[228:231], v[100:103], v[208:223]
    ds_read_b64_tr_b16 a[246:247], v25 offset:6656
    s_waitcnt lgkmcnt(6)
    v_mfma_f32_32x32x16_bf16 v[160:175], a[232:235], v[96:99], v[160:175]
    ds_read_b64_tr_b16 a[248:249], v24 offset:8704
    buffer_load_dwordx4 v[92:95], v1, s[44:47], s88 offen offset:1024 sc1
    s_add_u32 s59, s99, 1376256
    s_add_u32 m0, s101, 105984
    s_nop 0
    buffer_load_dwordx4 v12, s[16:19], s59 offen lds
    v_mfma_f32_32x32x16_bf16 v[224:239], a[232:235], v[100:103], v[224:239]
    ds_read_b64_tr_b16 a[250:251], v24 offset:10752
    s_waitcnt lgkmcnt(6)
    v_mfma_f32_32x32x16_bf16 v[176:191], a[236:239], v[96:99], v[176:191]
    ds_read_b64_tr_b16 a[252:253], v25 offset:8704
    s_waitcnt vmcnt(11)
    s_mov_b32 s63, 0
L_stat_35:
    v_xor_b32 v4, s54, v34
    v_xor_b32 v5, s54, v38
    v_or_b32 v4, v4, v5
    v_xor_b32 v5, s54, v42
    v_or_b32 v4, v4, v5
    v_xor_b32 v5, s54, v46
    v_or_b32 v4, v4, v5
    v_xor_b32 v5, s54, v50
    v_or_b32 v4, v4, v5
    v_xor_b32 v5, s54, v54
    v_or_b32 v4, v4, v5
    v_xor_b32 v5, s54, v58
    v_or_b32 v4, v4, v5
    v_cmp_ne_u32 vcc, 0, v4
    s_cbranch_vccz L_statd_36
    buffer_load_dwordx4 v[32:35], v1, s[44:47], s64 offen offset:0 sc1
    buffer_load_dwordx4 v[36:39], v1, s[44:47], s64 offen offset:1024 sc1
    buffer_load_dwordx4 v[40:43], v1, s[44:47], s64 offen offset:2048 sc1
    buffer_load_dwordx4 v[44:47], v1, s[44:47], s64 offen offset:3072 sc1
    s_add_u32 s82, s64, 4096
    buffer_load_dwordx4 v[48:51], v1, s[44:47], s82 offen offset:0 sc1
    buffer_load_dwordx4 v[52:55], v1, s[44:47], s82 offen offset:1024 sc1
    buffer_load_dwordx4 v[56:59], v1, s[44:47], s82 offen offset:2048 sc1
    s_add_u32 s63, s63, 1
    s_cmp_ge_u32 s63, 131072
    s_waitcnt vmcnt(0)
    s_cbranch_scc0 L_stat_35
L_statd_36:
    v_mfma_f32_32x32x16_bf16 v[240:255], a[236:239], v[100:103], v[240:255]
    ds_read_b64_tr_b16 a[254:255], v25 offset:10752
    v_add_f32 v4, v32, v36
    v_add_f32 v5, v40, v44
    v_add_f32 v6, v48, v52
    s_waitcnt lgkmcnt(6)
    v_mfma_f32_32x32x16_bf16 v[128:143], a[240:243], v[104:107], v[128:143]
    ds_read_b64_tr_b16 a[224:225], v24 offset:11776
    buffer_load_dwordx4 v[96:99], v1, s[44:47], s88 offen offset:2048 sc1
    v_add_f32 v4, v4, v5
    v_add_f32 v6, v6, v56
    s_mul_i32 s59, s62, 112
    s_mul_i32 s60, s50, 28
    s_add_u32 s59, s59, s60
    s_lshl_b32 s59, s59, 7
    s_add_u32 s41, s59, 720896
    v_min_u32 v28, 27, v0
    v_lshlrev_b32 v28, 7, v28
    buffer_load_dword v29, v28, s[44:47], s41 offen offset:0 sc1
    v_mfma_f32_32x32x16_bf16 v[192:207], a[240:243], v[108:111], v[192:207]
    ds_read_b64_tr_b16 a[226:227], v24 offset:13824
    s_add_u32 s59, s99, 1376256
    s_add_u32 m0, s101, 110080
    s_nop 0
    buffer_load_dwordx4 v12, s[20:23], s59 offen lds
    v_add_f32 v4, v4, v6
    v_mul_f32 v4, 0x3b124925, v4
    s_waitcnt lgkmcnt(6)
    v_mfma_f32_32x32x16_bf16 v[144:159], a[244:247], v[104:107], v[144:159]
    ds_read_b64_tr_b16 a[228:229], v25 offset:11776
    v_add_f32 v5, v33, v37
    v_add_f32 v6, v41, v45
    v_add_f32 v7, v49, v53
    v_mfma_f32_32x32x16_bf16 v[208:223], a[244:247], v[108:111], v[208:223]
    ds_read_b64_tr_b16 a[230:231], v25 offset:13824
    v_add_f32 v5, v5, v6
    v_add_f32 v7, v7, v57
    s_waitcnt lgkmcnt(6)
    v_mfma_f32_32x32x16_bf16 v[160:175], a[248:251], v[104:107], v[160:175]
    ds_read_b64_tr_b16 a[232:233], v24 offset:15872
    buffer_load_dwordx4 v[100:103], v1, s[44:47], s88 offen offset:3072 sc1
    v_add_f32 v5, v5, v7
    v_mov_b32 v7, 0x3c800000
    v_mfma_f32_32x32x16_bf16 v[224:239], a[248:251], v[108:111], v[224:239]
    ds_read_b64_tr_b16 a[234:235], v24 offset:17920
    v_mov_b32 v6, 0
    v_fma_f32 v46, v32, v7, -v4
    v_fmac_f32 v6, v46, v46
    s_waitcnt lgkmcnt(6)
    v_mfma_f32_32x32x16_bf16 v[176:191], a[252:255], v[104:107], v[176:191]
    ds_read_b64_tr_b16 a[236:237], v25 offset:15872
    s_add_u32 s59, s99, 1490944
    s_add_u32 m0, s101, 114176
    s_nop 0
    buffer_load_dwordx4 v12, s[16:19], s59 offen lds
    v_fma_f32 v46, v36, v7, -v4
    v_fmac_f32 v6, v46, v46
    v_mfma_f32_32x32x16_bf16 v[240:255], a[252:255], v[108:111], v[240:255]
    ds_read_b64_tr_b16 a[238:239], v25 offset:17920
    v_fma_f32 v46, v40, v7, -v4
    v_fmac_f32 v6, v46, v46
    s_waitcnt lgkmcnt(6)
    v_mfma_f32_32x32x16_bf16 v[128:143], a[224:227], v[64:67], v[128:143]
    ds_read_b64_tr_b16 a[240:241], v24 offset:12800
    s_add_u32 s88, s88, 4096
    buffer_load_dwordx4 v[104:107], v1, s[44:47], s88 offen offset:0 sc1
    v_fma_f32 v46, v44, v7, -v4
    v_fmac_f32 v6, v46, v46
    v_fma_f32 v46, v48, v7, -v4
    v_mfma_f32_32x32x16_bf16 v[192:207], a[224:227], v[68:71], v[192:207]
    ds_read_b64_tr_b16 a[242:243], v24 offset:14848
    v_fmac_f32 v6, v46, v46
    v_fma_f32 v46, v52, v7, -v4
    s_waitcnt lgkmcnt(6)
    v_mfma_f32_32x32x16_bf16 v[144:159], a[228:231], v[64:67], v[144:159]
    ds_read_b64_tr_b16 a[244:245], v25 offset:12800
    v_fmac_f32 v6, v46, v46
    v_fma_f32 v46, v56, v7, -v4
    v_mfma_f32_32x32x16_bf16 v[208:223], a[228:231], v[68:71], v[208:223]
    ds_read_b64_tr_b16 a[246:247], v25 offset:14848
    s_add_u32 s59, s99, 1490944
    s_add_u32 m0, s101, 118272
    s_nop 0
    buffer_load_dwordx4 v12, s[20:23], s59 offen lds
    v_fmac_f32 v6, v46, v46
    v_mul_f32 v6, 0x42800000, v6
    v_add_f32 v5, v5, v6
    s_waitcnt lgkmcnt(6)
    v_mfma_f32_32x32x16_bf16 v[160:175], a[232:235], v[64:67], v[160:175]
    ds_read_b64_tr_b16 a[248:249], v24 offset:16896
    buffer_load_dwordx4 v[108:111], v1, s[44:47], s88 offen offset:1024 sc1
    v_mul_f32 v5, 0x3b124925, v5
    v_add_f32 v5, 0x3727c5ac, v5
    v_mfma_f32_32x32x16_bf16 v[224:239], a[232:235], v[68:71], v[224:239]
    ds_read_b64_tr_b16 a[250:251], v24 offset:18944
    v_rcp_f32 v120, v5
    v_sqrt_f32 v5, v5
    s_waitcnt lgkmcnt(6)
    v_mfma_f32_32x32x16_bf16 v[176:191], a[236:239], v[64:67], v[176:191]
    ds_read_b64_tr_b16 a[252:253], v25 offset:16896
    v_sub_f32 v4, 0, v4
    v_cvt_pk_bf16_f32 v6, v4, v5
    v_lshlrev_b32 v7, 16, v6
    v_mfma_f32_32x32x16_bf16 v[240:255], a[236:239], v[68:71], v[240:255]
    ds_read_b64_tr_b16 a[254:255], v25 offset:18944
    s_barrier
    v_and_b32 v46, 0xffff0000, v6
    v_sub_f32 v4, v4, v7
    s_waitcnt vmcnt(18) lgkmcnt(6)
    v_mfma_f32_32x32x16_bf16 v[128:143], a[240:243], v[72:75], v[128:143]
    ds_read_b64_tr_b16 a[224:225], v24 offset:19968
    buffer_load_dwordx4 v[64:67], v1, s[44:47], s88 offen offset:2048 sc1
    v_sub_f32 v5, v5, v46
    v_cvt_pk_bf16_f32 v7, v4, v5
    s_waitcnt vmcnt(17)
    v_mfma_f32_32x32x16_bf16 v[192:207], a[240:243], v[76:79], v[192:207]
    ds_read_b64_tr_b16 a[226:227], v24 offset:22016
    s_mov_b32 s56, 0x01000100
    s_mov_b32 s57, 0x03020504
    s_mov_b32 s58, 0x07060302
    s_waitcnt lgkmcnt(6)
    v_mfma_f32_32x32x16_bf16 v[144:159], a[244:247], v[72:75], v[144:159]
    ds_read_b64_tr_b16 a[228:229], v25 offset:19968
    v_perm_b32 v112, v7, v6, s56
    v_perm_b32 v113, v7, v6, s57
    v_mfma_f32_32x32x16_bf16 v[208:223], a[244:247], v[76:79], v[208:223]
    ds_read_b64_tr_b16 a[230:231], v25 offset:22016
    v_perm_b32 v114, v7, v6, s58
    v_mov_b32 v115, 0
    s_waitcnt lgkmcnt(6)
    v_mfma_f32_32x32x16_bf16 v[160:175], a[248:251], v[72:75], v[160:175]
    ds_read_b64_tr_b16 a[232:233], v24 offset:24064
    buffer_load_dwordx4 v[68:71], v1, s[44:47], s88 offen offset:3072 sc1
    v_mov_b32 v119, 0
    v_mov_b32 v116, v112
    v_mov_b32 v117, v113
    v_mfma_f32_32x32x16_bf16 v[224:239], a[248:251], v[76:79], v[224:239]
    ds_read_b64_tr_b16 a[234:235], v24 offset:26112
    v_mov_b32 v118, v114
    v_mov_b32 v121, v120
    s_waitcnt lgkmcnt(6)
    v_mfma_f32_32x32x16_bf16 v[176:191], a[252:255], v[72:75], v[176:191]
    ds_read_b64_tr_b16 a[236:237], v25 offset:24064
    v_permlane32_swap_b32 v112, v116
    v_permlane32_swap_b32 v113, v117
    v_mfma_f32_32x32x16_bf16 v[240:255], a[252:255], v[76:79], v[240:255]
    ds_read_b64_tr_b16 a[238:239], v25 offset:26112
    v_permlane32_swap_b32 v114, v118
    v_permlane32_swap_b32 v120, v121
    s_waitcnt vmcnt(8)
    v_cmp_ne_u32 vcc, s54, v29
    s_cbranch_vccz L_chkd_38
    s_mov_b32 s63, 0
L_chk_37:
    buffer_load_dword v29, v28, s[44:47], s41 offen offset:0 sc1
    s_add_u32 s63, s63, 1
    s_cmp_ge_u32 s63, 131072
    s_waitcnt vmcnt(0)
    s_cbranch_scc1 L_chkd_38
    v_cmp_ne_u32 vcc, s54, v29
    s_cbranch_vccnz L_chk_37
L_chkd_38:
    s_waitcnt lgkmcnt(6)
    v_mfma_f32_32x32x16_bf16 v[128:143], a[224:227], v[80:83], v[128:143]
    ds_read_b64_tr_b16 a[240:241], v24 offset:20992
    ds_read_b64_tr_b16 a[242:243], v24 offset:23040
    s_add_u32 s88, s88, 4096
    buffer_load_dwordx4 v[72:75], v1, s[44:47], s88 offen offset:0 sc1
    s_lshl_b32 s52, s3, 13
    s_add_u32 s52, s52, s100
    s_add_u32 s3, s3, 1
    s_cmp_eq_u32 s3, 7
    s_cselect_b32 s3, 0, s3
    buffer_load_dwordx4 a[0:3], v1, s[44:47], s52 offen offset:0 sc1
    s_waitcnt lgkmcnt(6)
    v_mfma_f32_32x32x16_bf16 v[144:159], a[228:231], v[80:83], v[144:159]
    ds_read_b64_tr_b16 a[244:245], v25 offset:20992
    ds_read_b64_tr_b16 a[246:247], v25 offset:23040
    s_waitcnt lgkmcnt(6)
    v_mfma_f32_32x32x16_bf16 v[160:175], a[232:235], v[80:83], v[160:175]
    ds_read_b64_tr_b16 a[248:249], v24 offset:25088
    ds_read_b64_tr_b16 a[250:251], v24 offset:27136
    s_waitcnt lgkmcnt(6)
    v_mfma_f32_32x32x16_bf16 v[176:191], a[236:239], v[80:83], v[176:191]
    ds_read_b64_tr_b16 a[252:253], v25 offset:25088
    ds_read_b64_tr_b16 a[254:255], v25 offset:27136
    buffer_load_dwordx4 a[4:7], v1, s[44:47], s52 offen offset:1024 sc1
    s_waitcnt lgkmcnt(6)
    v_mfma_f32_32x32x16_bf16 v[128:143], a[240:243], v[84:87], v[128:143]
    ds_read_b64_tr_b16 a[224:225], v24 offset:28160
    ds_read_b64_tr_b16 a[226:227], v24 offset:30208
    buffer_load_dwordx4 v[76:79], v1, s[44:47], s88 offen offset:1024 sc1
    v_and_b32 v30, 3, v0
    v_lshlrev_b32 v30, 2, v30
    buffer_load_dword v31, v30, s[44:47], s75 offen offset:0 sc1
    s_waitcnt lgkmcnt(6)
    v_mfma_f32_32x32x16_bf16 v[144:159], a[244:247], v[84:87], v[144:159]
    ds_read_b64_tr_b16 a[228:229], v25 offset:28160
    ds_read_b64_tr_b16 a[230:231], v25 offset:30208
    s_waitcnt lgkmcnt(6)
    v_mfma_f32_32x32x16_bf16 v[160:175], a[248:251], v[84:87], v[160:175]
    ds_read_b64_tr_b16 a[232:233], v24 offset:32256
    ds_read_b64_tr_b16 a[234:235], v24 offset:34304
    s_waitcnt lgkmcnt(6)
    v_mfma_f32_32x32x16_bf16 v[176:191], a[252:255], v[84:87], v[176:191]
    ds_read_b64_tr_b16 a[236:237], v25 offset:32256
    ds_read_b64_tr_b16 a[238:239], v25 offset:34304
    buffer_load_dwordx4 a[8:11], v1, s[44:47], s52 offen offset:2048 sc1
    s_waitcnt lgkmcnt(6)
    v_mfma_f32_32x32x16_bf16 v[128:143], a[224:227], v[88:91], v[128:143]
    ds_read_b64_tr_b16 a[240:241], v24 offset:29184
    ds_read_b64_tr_b16 a[242:243], v24 offset:31232
    buffer_load_dwordx4 v[80:83], v1, s[44:47], s88 offen offset:2048 sc1
    s_waitcnt lgkmcnt(6)
    v_mfma_f32_32x32x16_bf16 v[144:159], a[228:231], v[88:91], v[144:159]
    ds_read_b64_tr_b16 a[244:245], v25 offset:29184
    ds_read_b64_tr_b16 a[246:247], v25 offset:31232
    s_waitcnt lgkmcnt(6)
    v_mfma_f32_32x32x16_bf16 v[160:175], a[232:235], v[88:91], v[160:175]
    ds_read_b64_tr_b16 a[248:249], v24 offset:33280
    ds_read_b64_tr_b16 a[250:251], v24 offset:35328
    s_waitcnt lgkmcnt(6)
    v_mfma_f32_32x32x16_bf16 v[176:191], a[236:239], v[88:91], v[176:191]
    ds_read_b64_tr_b16 a[252:253], v25 offset:33280
    ds_read_b64_tr_b16 a[254:255], v25 offset:35328
    buffer_load_dwordx4 a[12:15], v1, s[44:47], s52 offen offset:3072 sc1
    s_waitcnt lgkmcnt(6)
    v_mfma_f32_32x32x16_bf16 v[128:143], a[240:243], v[92:95], v[128:143]
    ds_read_b64_tr_b16 a[224:225], v24 offset:36352
    ds_read_b64_tr_b16 a[226:227], v24 offset:38400
    buffer_load_dwordx4 v[84:87], v1, s[44:47], s88 offen offset:3072 sc1
    s_waitcnt lgkmcnt(6)
    v_mfma_f32_32x32x16_bf16 v[144:159], a[244:247], v[92:95], v[144:159]
    ds_read_b64_tr_b16 a[228:229], v25 offset:36352
    ds_read_b64_tr_b16 a[230:231], v25 offset:38400
    s_waitcnt lgkmcnt(6)
    v_mfma_f32_32x32x16_bf16 v[160:175], a[248:251], v[92:95], v[160:175]
    ds_read_b64_tr_b16 a[232:233], v24 offset:40448
    ds_read_b64_tr_b16 a[234:235], v24 offset:42496
    s_add_u32 s52, s52, 4096
    buffer_load_dwordx4 a[16:19], v1, s[44:47], s52 offen offset:0 sc1
    s_waitcnt lgkmcnt(6)
    v_mfma_f32_32x32x16_bf16 v[176:191], a[252:255], v[92:95], v[176:191]
    ds_read_b64_tr_b16 a[236:237], v25 offset:40448
    ds_read_b64_tr_b16 a[238:239], v25 offset:42496
    s_waitcnt lgkmcnt(6)
    v_mfma_f32_32x32x16_bf16 v[128:143], a[224:227], v[96:99], v[128:143]
    ds_read_b64_tr_b16 a[240:241], v24 offset:37376
    ds_read_b64_tr_b16 a[242:243], v24 offset:39424
    buffer_load_dwordx4 v[88:91], v1, s[44:47], s89 offen offset:2048 sc1
    s_waitcnt lgkmcnt(6)
    v_mfma_f32_32x32x16_bf16 v[144:159], a[228:231], v[96:99], v[144:159]
    ds_read_b64_tr_b16 a[244:245], v25 offset:37376
    ds_read_b64_tr_b16 a[246:247], v25 offset:39424
    s_waitcnt lgkmcnt(6)
    v_mfma_f32_32x32x16_bf16 v[160:175], a[232:235], v[96:99], v[160:175]
    ds_read_b64_tr_b16 a[248:249], v24 offset:41472
    ds_read_b64_tr_b16 a[250:251], v24 offset:43520
    buffer_load_dwordx4 a[20:23], v1, s[44:47], s52 offen offset:1024 sc1
    s_waitcnt lgkmcnt(6)
    v_mfma_f32_32x32x16_bf16 v[176:191], a[236:239], v[96:99], v[176:191]
    ds_read_b64_tr_b16 a[252:253], v25 offset:41472
    ds_read_b64_tr_b16 a[254:255], v25 offset:43520
    s_waitcnt vmcnt(19)
    s_barrier
    s_waitcnt vmcnt(18) lgkmcnt(6)
    v_mfma_f32_32x32x16_bf16 v[128:143], a[240:243], v[100:103], v[128:143]
    ds_read_b64_tr_b16 a[224:225], v24 offset:44544
    ds_read_b64_tr_b16 a[226:227], v24 offset:46592
    buffer_load_dwordx4 v[92:95], v1, s[44:47], s89 offen offset:3072 sc1
    s_waitcnt lgkmcnt(6)
    v_mfma_f32_32x32x16_bf16 v[144:159], a[244:247], v[100:103], v[144:159]
    ds_read_b64_tr_b16 a[228:229], v25 offset:44544
    ds_read_b64_tr_b16 a[230:231], v25 offset:46592
    s_waitcnt lgkmcnt(6)
    v_mfma_f32_32x32x16_bf16 v[160:175], a[248:251], v[100:103], v[160:175]
    ds_read_b64_tr_b16 a[232:233], v24 offset:48640
    ds_read_b64_tr_b16 a[234:235], v24 offset:50688
    buffer_load_dwordx4 a[24:27], v1, s[44:47], s52 offen offset:2048 sc1
    s_waitcnt lgkmcnt(6)
    v_mfma_f32_32x32x16_bf16 v[176:191], a[252:255], v[100:103], v[176:191]
    ds_read_b64_tr_b16 a[236:237], v25 offset:48640
    ds_read_b64_tr_b16 a[238:239], v25 offset:50688
    s_waitcnt vmcnt(18) lgkmcnt(6)
    v_mfma_f32_32x32x16_bf16 v[128:143], a[224:227], v[104:107], v[128:143]
    ds_read_b64_tr_b16 a[240:241], v24 offset:45568
    ds_read_b64_tr_b16 a[242:243], v24 offset:47616
    s_add_u32 s89, s89, 4096
    buffer_load_dwordx4 v[96:99], v1, s[44:47], s89 offen offset:0 sc1
    s_waitcnt lgkmcnt(6)
    v_mfma_f32_32x32x16_bf16 v[144:159], a[228:231], v[104:107], v[144:159]
    ds_read_b64_tr_b16 a[244:245], v25 offset:45568
    ds_read_b64_tr_b16 a[246:247], v25 offset:47616
    buffer_load_dwordx4 a[28:31], v1, s[44:47], s52 offen offset:3072 sc1
    s_waitcnt lgkmcnt(6)
    v_mfma_f32_32x32x16_bf16 v[160:175], a[232:235], v[104:107], v[160:175]
    ds_read_b64_tr_b16 a[248:249], v24 offset:49664
    ds_read_b64_tr_b16 a[250:251], v24 offset:51712
    s_waitcnt lgkmcnt(6)
    v_mfma_f32_32x32x16_bf16 v[176:191], a[236:239], v[104:107], v[176:191]
    ds_read_b64_tr_b16 a[252:253], v25 offset:49664
    ds_read_b64_tr_b16 a[254:255], v25 offset:51712
    s_waitcnt vmcnt(18) lgkmcnt(6)
    v_mfma_f32_32x32x16_bf16 v[128:143], a[240:243], v[108:111], v[128:143]
    ds_read_b64_tr_b16 a[224:225], v24 offset:52736
    ds_read_b64_tr_b16 a[226:227], v24 offset:54784
    buffer_load_dwordx4 v[100:103], v1, s[44:47], s89 offen offset:1024 sc1
    s_waitcnt vmcnt(12)
    v_cmp_ne_u32 vcc, s54, v31
    s_cbranch_vccz L_chkd_40
    s_mov_b32 s63, 0
L_chk_39:
    buffer_load_dword v31, v30, s[44:47], s75 offen offset:0 sc1
    s_add_u32 s63, s63, 1
    s_cmp_ge_u32 s63, 131072
    s_waitcnt vmcnt(0)
    s_cbranch_scc1 L_chkd_40
    v_cmp_ne_u32 vcc, s54, v31
    s_cbranch_vccnz L_chk_39
L_chkd_40:
    buffer_load_dwordx4 v[48:51], v1, s[44:47], s76 offen offset:0 sc1
    buffer_load_dwordx4 v[52:55], v1, s[44:47], s76 offen offset:1024 sc1
    buffer_load_dwordx4 v[56:59], v1, s[44:47], s76 offen offset:2048 sc1
    buffer_load_dwordx4 v[60:63], v1, s[44:47], s76 offen offset:3072 sc1
    s_waitcnt lgkmcnt(6)
    v_mfma_f32_32x32x16_bf16 v[144:159], a[244:247], v[108:111], v[144:159]
    ds_read_b64_tr_b16 a[228:229], v25 offset:52736
    ds_read_b64_tr_b16 a[230:231], v25 offset:54784
    s_lshl_b32 s52, s3, 13
    s_add_u32 s52, s52, s100
    s_add_u32 s3, s3, 1
    s_cmp_eq_u32 s3, 7
    s_cselect_b32 s3, 0, s3
    buffer_load_dwordx4 a[32:35], v1, s[44:47], s52 offen offset:0 sc1
    s_waitcnt lgkmcnt(6)
    v_mfma_f32_32x32x16_bf16 v[160:175], a[248:251], v[108:111], v[160:175]
    ds_read_b64_tr_b16 a[232:233], v24 offset:56832
    ds_read_b64_tr_b16 a[234:235], v24 offset:58880
    s_waitcnt lgkmcnt(6)
    v_mfma_f32_32x32x16_bf16 v[176:191], a[252:255], v[108:111], v[176:191]
    ds_read_b64_tr_b16 a[236:237], v25 offset:56832
    ds_read_b64_tr_b16 a[238:239], v25 offset:58880
    s_waitcnt lgkmcnt(6)
    v_mfma_f32_32x32x16_bf16 v[128:143], a[224:227], v[64:67], v[128:143]
    ds_read_b64_tr_b16 a[240:241], v24 offset:53760
    ds_read_b64_tr_b16 a[242:243], v24 offset:55808
    buffer_load_dwordx4 v[104:107], v1, s[44:47], s89 offen offset:2048 sc1
    s_waitcnt lgkmcnt(6)
    v_mfma_f32_32x32x16_bf16 v[144:159], a[228:231], v[64:67], v[144:159]
    ds_read_b64_tr_b16 a[244:245], v25 offset:53760
    ds_read_b64_tr_b16 a[246:247], v25 offset:55808
    buffer_load_dwordx4 a[36:39], v1, s[44:47], s52 offen offset:1024 sc1
    s_waitcnt lgkmcnt(6)
    v_mfma_f32_32x32x16_bf16 v[160:175], a[232:235], v[64:67], v[160:175]
    ds_read_b64_tr_b16 a[248:249], v24 offset:57856
    ds_read_b64_tr_b16 a[250:251], v24 offset:59904
    s_waitcnt lgkmcnt(6)
    v_mfma_f32_32x32x16_bf16 v[176:191], a[236:239], v[64:67], v[176:191]
    ds_read_b64_tr_b16 a[252:253], v25 offset:57856
    ds_read_b64_tr_b16 a[254:255], v25 offset:59904
    s_waitcnt lgkmcnt(6)
    v_mfma_f32_32x32x16_bf16 v[128:143], a[240:243], v[68:71], v[128:143]
    ds_read_b64_tr_b16 a[224:225], v26 offset:40448
    ds_read_b64_tr_b16 a[226:227], v26 offset:42496
    buffer_load_dwordx4 v[108:111], v1, s[44:47], s89 offen offset:3072 sc1
    buffer_load_dwordx4 a[40:43], v1, s[44:47], s52 offen offset:2048 sc1
    s_waitcnt lgkmcnt(6)
    v_mfma_f32_32x32x16_bf16 v[144:159], a[244:247], v[68:71], v[144:159]
    ds_read_b64_tr_b16 a[228:229], v27 offset:40448
    ds_read_b64_tr_b16 a[230:231], v27 offset:42496
    s_waitcnt lgkmcnt(6)
    v_mfma_f32_32x32x16_bf16 v[160:175], a[248:251], v[68:71], v[160:175]
    ds_read_b64_tr_b16 a[232:233], v26 offset:44544
    ds_read_b64_tr_b16 a[234:235], v26 offset:46592
    s_waitcnt lgkmcnt(6)
    v_mfma_f32_32x32x16_bf16 v[176:191], a[252:255], v[68:71], v[176:191]
    ds_read_b64_tr_b16 a[236:237], v27 offset:44544
    ds_read_b64_tr_b16 a[238:239], v27 offset:46592
    s_waitcnt lgkmcnt(6)
    v_mfma_f32_32x32x16_bf16 v[128:143], a[224:227], v[72:75], v[128:143]
    ds_read_b64_tr_b16 a[240:241], v26 offset:41472
    ds_read_b64_tr_b16 a[242:243], v26 offset:43520
    s_add_u32 s89, s89, 4096
    buffer_load_dwordx4 v[64:67], v1, s[44:47], s89 offen offset:0 sc1
    buffer_load_dwordx4 a[44:47], v1, s[44:47], s52 offen offset:3072 sc1
    s_waitcnt lgkmcnt(6)
    v_mfma_f32_32x32x16_bf16 v[144:159], a[228:231], v[72:75], v[144:159]
    ds_read_b64_tr_b16 a[244:245], v27 offset:41472
    ds_read_b64_tr_b16 a[246:247], v27 offset:43520
    s_waitcnt lgkmcnt(6)
    v_mfma_f32_32x32x16_bf16 v[160:175], a[232:235], v[72:75], v[160:175]
    ds_read_b64_tr_b16 a[248:249], v26 offset:45568
    ds_read_b64_tr_b16 a[250:251], v26 offset:47616
    s_waitcnt lgkmcnt(6)
    v_mfma_f32_32x32x16_bf16 v[176:191], a[236:239], v[72:75], v[176:191]
    ds_read_b64_tr_b16 a[252:253], v27 offset:45568
    ds_read_b64_tr_b16 a[254:255], v27 offset:47616
    s_barrier
    s_waitcnt lgkmcnt(6)
    v_mfma_f32_32x32x16_bf16 v[128:143], a[240:243], v[76:79], v[128:143]
    ds_read_b64_tr_b16 a[224:225], v26 offset:48640
    ds_read_b64_tr_b16 a[226:227], v26 offset:50688
    buffer_load_dwordx4 v[68:71], v1, s[44:47], s89 offen offset:1024 sc1
    s_add_u32 s52, s52, 4096
    buffer_load_dwordx4 a[48:51], v1, s[44:47], s52 offen offset:0 sc1
    s_waitcnt lgkmcnt(6)
    v_mfma_f32_32x32x16_bf16 v[144:159], a[244:247], v[76:79], v[144:159]
    ds_read_b64_tr_b16 a[228:229], v27 offset:48640
    ds_read_b64_tr_b16 a[230:231], v27 offset:50688
    s_waitcnt lgkmcnt(6)
    v_mfma_f32_32x32x16_bf16 v[160:175], a[248:251], v[76:79], v[160:175]
    ds_read_b64_tr_b16 a[232:233], v26 offset:52736
    ds_read_b64_tr_b16 a[234:235], v26 offset:54784
    s_waitcnt lgkmcnt(6)
    v_mfma_f32_32x32x16_bf16 v[176:191], a[252:255], v[76:79], v[176:191]
    ds_read_b64_tr_b16 a[236:237], v27 offset:52736
    ds_read_b64_tr_b16 a[238:239], v27 offset:54784
    buffer_load_dwordx4 a[52:55], v1, s[44:47], s52 offen offset:1024 sc1
    s_waitcnt vmcnt(24) lgkmcnt(6)
    v_mfma_f32_32x32x16_bf16 v[128:143], a[224:227], v[80:83], v[128:143]
    ds_read_b64_tr_b16 a[240:241], v26 offset:49664
    ds_read_b64_tr_b16 a[242:243], v26 offset:51712
    buffer_load_dwordx4 v[72:75], v1, s[44:47], s89 offen offset:2048 sc1
    s_waitcnt lgkmcnt(6)
    v_mfma_f32_32x32x16_bf16 v[144:159], a[228:231], v[80:83], v[144:159]
    ds_read_b64_tr_b16 a[244:245], v27 offset:49664
    ds_read_b64_tr_b16 a[246:247], v27 offset:51712
    s_waitcnt lgkmcnt(6)
    v_mfma_f32_32x32x16_bf16 v[160:175], a[232:235], v[80:83], v[160:175]
    ds_read_b64_tr_b16 a[248:249], v26 offset:53760
    ds_read_b64_tr_b16 a[250:251], v26 offset:55808
    s_waitcnt lgkmcnt(6)
    v_mfma_f32_32x32x16_bf16 v[176:191], a[236:239], v[80:83], v[176:191]
    ds_read_b64_tr_b16 a[252:253], v27 offset:53760
    ds_read_b64_tr_b16 a[254:255], v27 offset:55808
    buffer_load_dwordx4 a[56:59], v1, s[44:47], s52 offen offset:2048 sc1
    s_waitcnt vmcnt(24) lgkmcnt(6)
    v_mfma_f32_32x32x16_bf16 v[128:143], a[240:243], v[84:87], v[128:143]
    buffer_load_dwordx4 v[76:79], v1, s[44:47], s89 offen offset:3072 sc1
    s_waitcnt lgkmcnt(4)
    v_mfma_f32_32x32x16_bf16 v[144:159], a[244:247], v[84:87], v[144:159]
    s_waitcnt lgkmcnt(2)
    v_mfma_f32_32x32x16_bf16 v[160:175], a[248:251], v[84:87], v[160:175]
    s_waitcnt lgkmcnt(0)
    v_mfma_f32_32x32x16_bf16 v[176:191], a[252:255], v[84:87], v[176:191]
    buffer_load_dwordx4 a[60:63], v1, s[44:47], s52 offen offset:3072 sc1
    s_waitcnt vmcnt(14)
    v_mfma_f32_32x32x16_bf16 v[128:143], v[48:51], v[112:115], v[128:143]
    ds_read_b64_tr_b16 a[240:241], v24 offset:19968
    ds_read_b64_tr_b16 a[242:243], v24 offset:22016
    v_mfma_f32_32x32x16_bf16 v[144:159], v[52:55], v[112:115], v[144:159]
    ds_read_b64_tr_b16 a[244:245], v25 offset:19968
    ds_read_b64_tr_b16 a[246:247], v25 offset:22016
    v_mfma_f32_32x32x16_bf16 v[160:175], v[56:59], v[112:115], v[160:175]
    ds_read_b64_tr_b16 a[248:249], v24 offset:24064
    ds_read_b64_tr_b16 a[250:251], v24 offset:26112
    s_lshl_b32 s52, s3, 13
    s_add_u32 s52, s52, s100
    s_add_u32 s3, s3, 1
    s_cmp_eq_u32 s3, 7
    s_cselect_b32 s3, 0, s3
    buffer_load_dwordx4 a[64:67], v1, s[44:47], s52 offen offset:0 sc1
    v_mfma_f32_32x32x16_bf16 v[176:191], v[60:63], v[112:115], v[176:191]
    ds_read_b64_tr_b16 a[252:253], v25 offset:24064
    ds_read_b64_tr_b16 a[254:255], v25 offset:26112
    s_waitcnt lgkmcnt(6)
    v_mfma_f32_32x32x16_bf16 v[192:207], a[240:243], v[88:91], v[192:207]
    ds_read_b64_tr_b16 a[224:225], v24 offset:20992
    ds_read_b64_tr_b16 a[226:227], v24 offset:23040
    s_add_u32 s89, s89, 4096
    buffer_load_dwordx4 v[80:83], v1, s[44:47], s89 offen offset:0 sc1
    s_waitcnt lgkmcnt(6)
    v_mfma_f32_32x32x16_bf16 v[208:223], a[244:247], v[88:91], v[208:223]
    ds_read_b64_tr_b16 a[228:229], v25 offset:20992
    ds_read_b64_tr_b16 a[230:231], v25 offset:23040
    v_max_f32 v128, 0, v128
    v_mul_f32 v160, v120, v160
    v_max_f32 v129, 0, v129
    v_mul_f32 v161, v120, v161
    v_mul_f32 v128, v128, v160
    s_waitcnt lgkmcnt(6)
    v_mfma_f32_32x32x16_bf16 v[224:239], a[248:251], v[88:91], v[224:239]
    ds_read_b64_tr_b16 a[232:233], v24 offset:25088
    ds_read_b64_tr_b16 a[234:235], v24 offset:27136
    buffer_load_dwordx4 a[68:71], v1, s[44:47], s52 offen offset:1024 sc1
    v_mul_f32 v129, v129, v161
    v_cvt_pk_bf16_f32 v128, v128, v129
    v_max_f32 v130, 0, v130
    v_mul_f32 v162, v120, v162
    v_max_f32 v131, 0, v131
    s_waitcnt lgkmcnt(6)
    v_mfma_f32_32x32x16_bf16 v[240:255], a[252:255], v[88:91], v[240:255]
    ds_read_b64_tr_b16 a[236:237], v25 offset:25088
    ds_read_b64_tr_b16 a[238:239], v25 offset:27136
    v_mul_f32 v163, v120, v163
    v_mul_f32 v130, v130, v162
    v_mul_f32 v131, v131, v163
    v_cvt_pk_bf16_f32 v129, v130, v131
    s_waitcnt lgkmcnt(6)
    v_mfma_f32_32x32x16_bf16 v[192:207], a[224:227], v[92:95], v[192:207]
    ds_read_b64_tr_b16 a[240:241], v24 offset:28160
    ds_read_b64_tr_b16 a[242:243], v24 offset:30208
    buffer_load_dwordx4 v[84:87], v1, s[44:47], s89 offen offset:1024 sc1
    v_max_f32 v132, 0, v132
    v_mul_f32 v164, v120, v164
    v_max_f32 v133, 0, v133
    v_mul_f32 v165, v120, v165
    v_mul_f32 v132, v132, v164
    s_waitcnt lgkmcnt(6)
    v_mfma_f32_32x32x16_bf16 v[208:223], a[228:231], v[92:95], v[208:223]
    ds_read_b64_tr_b16 a[244:245], v25 offset:28160
    ds_read_b64_tr_b16 a[246:247], v25 offset:30208
    v_mul_f32 v133, v133, v165
    v_cvt_pk_bf16_f32 v130, v132, v133
    v_max_f32 v134, 0, v134
    v_mul_f32 v166, v120, v166
    v_max_f32 v135, 0, v135
    s_waitcnt lgkmcnt(6)
    v_mfma_f32_32x32x16_bf16 v[224:239], a[232:235], v[92:95], v[224:239]
    ds_read_b64_tr_b16 a[248:249], v24 offset:32256
    ds_read_b64_tr_b16 a[250:251], v24 offset:34304
    buffer_load_dwordx4 a[72:75], v1, s[44:47], s52 offen offset:2048 sc1
    v_mul_f32 v167, v120, v167
    v_mul_f32 v134, v134, v166
    v_mul_f32 v135, v135, v167
    v_cvt_pk_bf16_f32 v131, v134, v135
    s_waitcnt lgkmcnt(6)
    v_mfma_f32_32x32x16_bf16 v[240:255], a[236:239], v[92:95], v[240:255]
    ds_read_b64_tr_b16 a[252:253], v25 offset:32256
    ds_read_b64_tr_b16 a[254:255], v25 offset:34304
    buffer_store_dwordx4 v[128:131], v1, s[44:47], s65 offen offset:0 sc1
    v_max_f32 v136, 0, v136
    v_mul_f32 v168, v120, v168
    v_max_f32 v137, 0, v137
    v_mul_f32 v169, v120, v169
    s_waitcnt lgkmcnt(6)
    v_mfma_f32_32x32x16_bf16 v[192:207], a[240:243], v[96:99], v[192:207]
    ds_read_b64_tr_b16 a[224:225], v24 offset:29184
    ds_read_b64_tr_b16 a[226:227], v24 offset:31232
    buffer_load_dwordx4 v[88:91], v1, s[44:47], s89 offen offset:2048 sc1
    v_mul_f32 v136, v136, v168
    v_mul_f32 v137, v137, v169
    v_cvt_pk_bf16_f32 v132, v136, v137
    v_max_f32 v138, 0, v138
    v_mul_f32 v170, v120, v170
    s_waitcnt lgkmcnt(6)
    v_mfma_f32_32x32x16_bf16 v[208:223], a[244:247], v[96:99], v[208:223]
    ds_read_b64_tr_b16 a[228:229], v25 offset:29184
    ds_read_b64_tr_b16 a[230:231], v25 offset:31232
    buffer_load_dwordx4 a[76:79], v1, s[44:47], s52 offen offset:3072 sc1
    v_max_f32 v139, 0, v139
    v_mul_f32 v171, v120, v171
    v_mul_f32 v138, v138, v170
    v_mul_f32 v139, v139, v171
    s_waitcnt lgkmcnt(6)
    v_mfma_f32_32x32x16_bf16 v[224:239], a[248:251], v[96:99], v[224:239]
    ds_read_b64_tr_b16 a[232:233], v24 offset:33280
    ds_read_b64_tr_b16 a[234:235], v24 offset:35328
    v_cvt_pk_bf16_f32 v133, v138, v139
    v_max_f32 v140, 0, v140
    v_mul_f32 v172, v120, v172
    v_max_f32 v141, 0, v141
    v_mul_f32 v173, v120, v173
    s_waitcnt lgkmcnt(6)
    v_mfma_f32_32x32x16_bf16 v[240:255], a[252:255], v[96:99], v[240:255]
    ds_read_b64_tr_b16 a[236:237], v25 offset:33280
    ds_read_b64_tr_b16 a[238:239], v25 offset:35328
    v_mul_f32 v140, v140, v172
    v_mul_f32 v141, v141, v173
    v_cvt_pk_bf16_f32 v134, v140, v141
    v_max_f32 v142, 0, v142
    v_mul_f32 v174, v120, v174
    s_waitcnt lgkmcnt(6)
    v_mfma_f32_32x32x16_bf16 v[192:207], a[224:227], v[100:103], v[192:207]
    ds_read_b64_tr_b16 a[240:241], v24 offset:36352
    ds_read_b64_tr_b16 a[242:243], v24 offset:38400
    buffer_load_dwordx4 v[92:95], v1, s[44:47], s89 offen offset:3072 sc1
    v_max_f32 v143, 0, v143
    v_mul_f32 v175, v120, v175
    v_mul_f32 v142, v142, v174
    v_mul_f32 v143, v143, v175
    s_waitcnt lgkmcnt(6)
    v_mfma_f32_32x32x16_bf16 v[208:223], a[228:231], v[100:103], v[208:223]
    ds_read_b64_tr_b16 a[244:245], v25 offset:36352
    ds_read_b64_tr_b16 a[246:247], v25 offset:38400
    s_add_u32 s52, s52, 4096
    buffer_load_dwordx4 a[80:83], v1, s[44:47], s52 offen offset:0 sc1
    v_cvt_pk_bf16_f32 v135, v142, v143
    buffer_store_dwordx4 v[132:135], v1, s[44:47], s65 offen offset:1024 sc1
    v_max_f32 v144, 0, v144
    v_mul_f32 v176, v120, v176
    v_max_f32 v145, 0, v145
    s_waitcnt lgkmcnt(6)
    v_mfma_f32_32x32x16_bf16 v[224:239], a[232:235], v[100:103], v[224:239]
    ds_read_b64_tr_b16 a[248:249], v24 offset:40448
    ds_read_b64_tr_b16 a[250:251], v24 offset:42496
    v_mul_f32 v177, v120, v177
    v_mul_f32 v144, v144, v176
    v_mul_f32 v145, v145, v177
    v_cvt_pk_bf16_f32 v144, v144, v145
    s_waitcnt lgkmcnt(6)
    v_mfma_f32_32x32x16_bf16 v[240:255], a[236:239], v[100:103], v[240:255]
    ds_read_b64_tr_b16 a[252:253], v25 offset:40448
    ds_read_b64_tr_b16 a[254:255], v25 offset:42496
    v_max_f32 v146, 0, v146
    v_mul_f32 v178, v120, v178
    v_max_f32 v147, 0, v147
    v_mul_f32 v179, v120, v179
    v_mul_f32 v146, v146, v178
    s_waitcnt vmcnt(23) lgkmcnt(6)
    v_mfma_f32_32x32x16_bf16 v[192:207], a[240:243], v[104:107], v[192:207]
    ds_read_b64_tr_b16 a[224:225], v24 offset:37376
    ds_read_b64_tr_b16 a[226:227], v24 offset:39424
    v_mul_f32 v147, v147, v179
    v_cvt_pk_bf16_f32 v145, v146, v147
    v_max_f32 v148, 0, v148
    v_mul_f32 v180, v120, v180
    v_max_f32 v149, 0, v149
    s_waitcnt lgkmcnt(6)
    v_mfma_f32_32x32x16_bf16 v[208:223], a[244:247], v[104:107], v[208:223]
    ds_read_b64_tr_b16 a[228:229], v25 offset:37376
    ds_read_b64_tr_b16 a[230:231], v25 offset:39424
    buffer_load_dwordx4 a[84:87], v1, s[44:47], s52 offen offset:1024 sc1
    v_mul_f32 v181, v120, v181
    v_mul_f32 v148, v148, v180
    v_mul_f32 v149, v149, v181
    v_cvt_pk_bf16_f32 v146, v148, v149
    s_waitcnt lgkmcnt(6)
    v_mfma_f32_32x32x16_bf16 v[224:239], a[248:251], v[104:107], v[224:239]
    ds_read_b64_tr_b16 a[232:233], v24 offset:41472
    ds_read_b64_tr_b16 a[234:235], v24 offset:43520
    v_max_f32 v150, 0, v150
    v_mul_f32 v182, v120, v182
    v_max_f32 v151, 0, v151
    v_mul_f32 v183, v120, v183
    v_mul_f32 v150, v150, v182
    s_waitcnt lgkmcnt(6)
    v_mfma_f32_32x32x16_bf16 v[240:255], a[252:255], v[104:107], v[240:255]
    ds_read_b64_tr_b16 a[236:237], v25 offset:41472
    ds_read_b64_tr_b16 a[238:239], v25 offset:43520
    v_mul_f32 v151, v151, v183
    v_cvt_pk_bf16_f32 v147, v150, v151
    buffer_store_dwordx4 v[144:147], v1, s[44:47], s65 offen offset:2048 sc1
    v_max_f32 v152, 0, v152
    v_mul_f32 v184, v120, v184
    s_waitcnt vmcnt(23) lgkmcnt(6)
    v_mfma_f32_32x32x16_bf16 v[192:207], a[224:227], v[108:111], v[192:207]
    ds_read_b64_tr_b16 a[240:241], v24 offset:44544
    ds_read_b64_tr_b16 a[242:243], v24 offset:46592
    buffer_load_dwordx4 a[88:91], v1, s[44:47], s52 offen offset:2048 sc1
    v_max_f32 v153, 0, v153
    v_mul_f32 v185, v120, v185
    v_mul_f32 v152, v152, v184
    v_mul_f32 v153, v153, v185
    s_waitcnt lgkmcnt(6)
    v_mfma_f32_32x32x16_bf16 v[208:223], a[228:231], v[108:111], v[208:223]
    ds_read_b64_tr_b16 a[244:245], v25 offset:44544
    ds_read_b64_tr_b16 a[246:247], v25 offset:46592
    v_cvt_pk_bf16_f32 v148, v152, v153
    v_max_f32 v154, 0, v154
    v_mul_f32 v186, v120, v186
    v_max_f32 v155, 0, v155
    v_mul_f32 v187, v120, v187
    s_waitcnt lgkmcnt(6)
    v_mfma_f32_32x32x16_bf16 v[224:239], a[232:235], v[108:111], v[224:239]
    ds_read_b64_tr_b16 a[248:249], v24 offset:48640
    ds_read_b64_tr_b16 a[250:251], v24 offset:50688
    v_mul_f32 v154, v154, v186
    v_mul_f32 v155, v155, v187
    v_cvt_pk_bf16_f32 v149, v154, v155
    v_max_f32 v156, 0, v156
    v_mul_f32 v188, v120, v188
    s_waitcnt lgkmcnt(6)
    v_mfma_f32_32x32x16_bf16 v[240:255], a[236:239], v[108:111], v[240:255]
    ds_read_b64_tr_b16 a[252:253], v25 offset:48640
    ds_read_b64_tr_b16 a[254:255], v25 offset:50688
    v_max_f32 v157, 0, v157
    v_mul_f32 v189, v120, v189
    v_mul_f32 v156, v156, v188
    v_mul_f32 v157, v157, v189
    s_waitcnt vmcnt(22) lgkmcnt(6)
    v_mfma_f32_32x32x16_bf16 v[192:207], a[240:243], v[64:67], v[192:207]
    ds_read_b64_tr_b16 a[224:225], v24 offset:45568
    ds_read_b64_tr_b16 a[226:227], v24 offset:47616
    buffer_load_dwordx4 a[92:95], v1, s[44:47], s52 offen offset:3072 sc1
    v_cvt_pk_bf16_f32 v150, v156, v157
    v_max_f32 v158, 0, v158
    v_mul_f32 v190, v120, v190
    v_max_f32 v159, 0, v159
    v_mul_f32 v191, v120, v191
    s_waitcnt lgkmcnt(6)
    v_mfma_f32_32x32x16_bf16 v[208:223], a[244:247], v[64:67], v[208:223]
    ds_read_b64_tr_b16 a[228:229], v25 offset:45568
    ds_read_b64_tr_b16 a[230:231], v25 offset:47616
    v_mul_f32 v158, v158, v190
    v_mul_f32 v159, v159, v191
    v_cvt_pk_bf16_f32 v151, v158, v159
    buffer_store_dwordx4 v[148:151], v1, s[44:47], s65 offen offset:3072 sc1
    s_waitcnt lgkmcnt(6)
    v_mfma_f32_32x32x16_bf16 v[224:239], a[248:251], v[64:67], v[224:239]
    ds_read_b64_tr_b16 a[232:233], v24 offset:49664
    ds_read_b64_tr_b16 a[234:235], v24 offset:51712
    s_waitcnt lgkmcnt(6)
    v_mfma_f32_32x32x16_bf16 v[240:255], a[252:255], v[64:67], v[240:255]
    ds_read_b64_tr_b16 a[236:237], v25 offset:49664
    ds_read_b64_tr_b16 a[238:239], v25 offset:51712
    s_waitcnt vmcnt(22) lgkmcnt(6)
    v_mfma_f32_32x32x16_bf16 v[192:207], a[224:227], v[68:71], v[192:207]
    ds_read_b64_tr_b16 a[240:241], v24 offset:52736
    ds_read_b64_tr_b16 a[242:243], v24 offset:54784
    s_waitcnt lgkmcnt(6)
    v_mfma_f32_32x32x16_bf16 v[208:223], a[228:231], v[68:71], v[208:223]
    ds_read_b64_tr_b16 a[244:245], v25 offset:52736
    ds_read_b64_tr_b16 a[246:247], v25 offset:54784
    s_waitcnt lgkmcnt(6)
    v_mfma_f32_32x32x16_bf16 v[224:239], a[232:235], v[68:71], v[224:239]
    ds_read_b64_tr_b16 a[248:249], v24 offset:56832
    ds_read_b64_tr_b16 a[250:251], v24 offset:58880
    s_lshl_b32 s52, s3, 13
    s_add_u32 s52, s52, s100
    s_add_u32 s3, s3, 1
    s_cmp_eq_u32 s3, 7
    s_cselect_b32 s3, 0, s3
    buffer_load_dwordx4 a[96:99], v1, s[44:47], s52 offen offset:0 sc1
    buffer_load_dwordx4 a[100:103], v1, s[44:47], s52 offen offset:1024 sc1
    s_waitcnt lgkmcnt(6)
    v_mfma_f32_32x32x16_bf16 v[240:255], a[236:239], v[68:71], v[240:255]
    ds_read_b64_tr_b16 a[252:253], v25 offset:56832
    ds_read_b64_tr_b16 a[254:255], v25 offset:58880
    buffer_load_dwordx4 a[104:107], v1, s[44:47], s52 offen offset:2048 sc1
    s_waitcnt vmcnt(22) lgkmcnt(6)
    v_mfma_f32_32x32x16_bf16 v[192:207], a[240:243], v[72:75], v[192:207]
    ds_read_b64_tr_b16 a[224:225], v24 offset:53760
    ds_read_b64_tr_b16 a[226:227], v24 offset:55808
    buffer_load_dwordx4 a[108:111], v1, s[44:47], s52 offen offset:3072 sc1
    s_waitcnt lgkmcnt(6)
    v_mfma_f32_32x32x16_bf16 v[208:223], a[244:247], v[72:75], v[208:223]
    ds_read_b64_tr_b16 a[228:229], v25 offset:53760
    ds_read_b64_tr_b16 a[230:231], v25 offset:55808
    s_add_u32 s52, s52, 4096
    buffer_load_dwordx4 a[112:115], v1, s[44:47], s52 offen offset:0 sc1
    s_waitcnt lgkmcnt(6)
    v_mfma_f32_32x32x16_bf16 v[224:239], a[248:251], v[72:75], v[224:239]
    ds_read_b64_tr_b16 a[232:233], v24 offset:57856
    ds_read_b64_tr_b16 a[234:235], v24 offset:59904
    buffer_load_dwordx4 a[116:119], v1, s[44:47], s52 offen offset:1024 sc1
    buffer_load_dwordx4 a[120:123], v1, s[44:47], s52 offen offset:2048 sc1
    s_waitcnt lgkmcnt(6)
    v_mfma_f32_32x32x16_bf16 v[240:255], a[252:255], v[72:75], v[240:255]
    ds_read_b64_tr_b16 a[236:237], v25 offset:57856
    ds_read_b64_tr_b16 a[238:239], v25 offset:59904
    buffer_load_dwordx4 a[124:127], v1, s[44:47], s52 offen offset:3072 sc1
    s_waitcnt vmcnt(25) lgkmcnt(6)
    v_mfma_f32_32x32x16_bf16 v[192:207], a[224:227], v[76:79], v[192:207]
    ds_read_b64_tr_b16 a[240:241], v26 offset:40448
    ds_read_b64_tr_b16 a[242:243], v26 offset:42496
    s_lshl_b32 s52, s3, 13
    s_add_u32 s52, s52, s100
    s_add_u32 s3, s3, 1
    s_cmp_eq_u32 s3, 7
    s_cselect_b32 s3, 0, s3
    buffer_load_dwordx4 a[128:131], v1, s[44:47], s52 offen offset:0 sc1
    s_waitcnt lgkmcnt(6)
    v_mfma_f32_32x32x16_bf16 v[208:223], a[228:231], v[76:79], v[208:223]
    ds_read_b64_tr_b16 a[244:245], v27 offset:40448
    ds_read_b64_tr_b16 a[246:247], v27 offset:42496
    buffer_load_dwordx4 a[132:135], v1, s[44:47], s52 offen offset:1024 sc1
    s_waitcnt lgkmcnt(6)
    v_mfma_f32_32x32x16_bf16 v[224:239], a[232:235], v[76:79], v[224:239]
    ds_read_b64_tr_b16 a[248:249], v26 offset:44544
    ds_read_b64_tr_b16 a[250:251], v26 offset:46592
    buffer_load_dwordx4 a[136:139], v1, s[44:47], s52 offen offset:2048 sc1
    buffer_load_dwordx4 a[140:143], v1, s[44:47], s52 offen offset:3072 sc1
    s_waitcnt lgkmcnt(6)
    v_mfma_f32_32x32x16_bf16 v[240:255], a[236:239], v[76:79], v[240:255]
    ds_read_b64_tr_b16 a[252:253], v27 offset:44544
    ds_read_b64_tr_b16 a[254:255], v27 offset:46592
    s_add_u32 s52, s52, 4096
    buffer_load_dwordx4 a[144:147], v1, s[44:47], s52 offen offset:0 sc1
    s_waitcnt vmcnt(27) lgkmcnt(6)
    v_mfma_f32_32x32x16_bf16 v[192:207], a[240:243], v[80:83], v[192:207]
    ds_read_b64_tr_b16 a[224:225], v26 offset:41472
    ds_read_b64_tr_b16 a[226:227], v26 offset:43520
    s_waitcnt vmcnt(13)
    v_mov_b32 v7, s54
    s_mov_b64 exec, 1
    s_cmp_lg_u32 s55, 0
    s_cbranch_scc0 L_slowfl_41
    buffer_store_dword v7, off, s[44:47], s67
    s_branch L_fl_42
L_slowfl_41:
    buffer_store_dword v7, off, s[44:47], s67 sc1
L_fl_42:
    s_mov_b64 exec, -1
    buffer_load_dwordx4 a[148:151], v1, s[44:47], s52 offen offset:1024 sc1
    s_waitcnt lgkmcnt(6)
    v_mfma_f32_32x32x16_bf16 v[208:223], a[244:247], v[80:83], v[208:223]
    ds_read_b64_tr_b16 a[228:229], v27 offset:41472
    ds_read_b64_tr_b16 a[230:231], v27 offset:43520
    buffer_load_dwordx4 a[152:155], v1, s[44:47], s52 offen offset:2048 sc1
    s_waitcnt lgkmcnt(6)
    v_mfma_f32_32x32x16_bf16 v[224:239], a[248:251], v[80:83], v[224:239]
    ds_read_b64_tr_b16 a[232:233], v26 offset:45568
    ds_read_b64_tr_b16 a[234:235], v26 offset:47616
    buffer_load_dwordx4 a[156:159], v1, s[44:47], s52 offen offset:3072 sc1
    s_lshl_b32 s52, s3, 13
    s_add_u32 s52, s52, s100
    s_add_u32 s3, s3, 1
    s_cmp_eq_u32 s3, 7
    s_cselect_b32 s3, 0, s3
    buffer_load_dwordx4 a[160:163], v1, s[44:47], s52 offen offset:0 sc1
    s_waitcnt lgkmcnt(6)
    v_mfma_f32_32x32x16_bf16 v[240:255], a[252:255], v[80:83], v[240:255]
    ds_read_b64_tr_b16 a[236:237], v27 offset:45568
    ds_read_b64_tr_b16 a[238:239], v27 offset:47616
    buffer_load_dwordx4 a[164:167], v1, s[44:47], s52 offen offset:1024 sc1
    s_waitcnt lgkmcnt(6)
    v_mfma_f32_32x32x16_bf16 v[192:207], a[224:227], v[84:87], v[192:207]
    ds_read_b64_tr_b16 a[240:241], v26 offset:48640
    ds_read_b64_tr_b16 a[242:243], v26 offset:50688
    v_min_u32 v30, 6, v0
    v_lshlrev_b32 v30, 2, v30
    buffer_load_dword v31, v30, s[44:47], s70 offen offset:0 sc1
    buffer_load_dwordx4 a[168:171], v1, s[44:47], s52 offen offset:2048 sc1
    s_waitcnt lgkmcnt(6)
    v_mfma_f32_32x32x16_bf16 v[208:223], a[228:231], v[84:87], v[208:223]
    ds_read_b64_tr_b16 a[244:245], v27 offset:48640
    ds_read_b64_tr_b16 a[246:247], v27 offset:50688
    buffer_load_dwordx4 a[172:175], v1, s[44:47], s52 offen offset:3072 sc1
    s_waitcnt lgkmcnt(6)
    v_mfma_f32_32x32x16_bf16 v[224:239], a[232:235], v[84:87], v[224:239]
    ds_read_b64_tr_b16 a[248:249], v26 offset:52736
    ds_read_b64_tr_b16 a[250:251], v26 offset:54784
    s_add_u32 s52, s52, 4096
    buffer_load_dwordx4 a[176:179], v1, s[44:47], s52 offen offset:0 sc1
    buffer_load_dwordx4 a[180:183], v1, s[44:47], s52 offen offset:1024 sc1
    s_waitcnt lgkmcnt(6)
    v_mfma_f32_32x32x16_bf16 v[240:255], a[236:239], v[84:87], v[240:255]
    ds_read_b64_tr_b16 a[252:253], v27 offset:52736
    ds_read_b64_tr_b16 a[254:255], v27 offset:54784
    buffer_load_dwordx4 a[184:187], v1, s[44:47], s52 offen offset:2048 sc1
    s_waitcnt lgkmcnt(6)
    v_mfma_f32_32x32x16_bf16 v[192:207], a[240:243], v[88:91], v[192:207]
    ds_read_b64_tr_b16 a[224:225], v26 offset:49664
    ds_read_b64_tr_b16 a[226:227], v26 offset:51712
    buffer_load_dwordx4 a[188:191], v1, s[44:47], s52 offen offset:3072 sc1
    s_waitcnt lgkmcnt(6)
    v_mfma_f32_32x32x16_bf16 v[208:223], a[244:247], v[88:91], v[208:223]
    ds_read_b64_tr_b16 a[228:229], v27 offset:49664
    ds_read_b64_tr_b16 a[230:231], v27 offset:51712
    s_lshl_b32 s52, s3, 13
    s_add_u32 s52, s52, s100
    s_add_u32 s3, s3, 1
    s_cmp_eq_u32 s3, 7
    s_cselect_b32 s3, 0, s3
    buffer_load_dwordx4 a[192:195], v1, s[44:47], s52 offen offset:0 sc1
    s_waitcnt lgkmcnt(6)
    v_mfma_f32_32x32x16_bf16 v[224:239], a[248:251], v[88:91], v[224:239]
    ds_read_b64_tr_b16 a[232:233], v26 offset:53760
    ds_read_b64_tr_b16 a[234:235], v26 offset:55808
    buffer_load_dwordx4 a[196:199], v1, s[44:47], s52 offen offset:1024 sc1
    buffer_load_dwordx4 a[200:203], v1, s[44:47], s52 offen offset:2048 sc1
    s_waitcnt lgkmcnt(6)
    v_mfma_f32_32x32x16_bf16 v[240:255], a[252:255], v[88:91], v[240:255]
    ds_read_b64_tr_b16 a[236:237], v27 offset:53760
    ds_read_b64_tr_b16 a[238:239], v27 offset:55808
    buffer_load_dwordx4 a[204:207], v1, s[44:47], s52 offen offset:3072 sc1
    s_waitcnt lgkmcnt(6)
    v_mfma_f32_32x32x16_bf16 v[192:207], a[224:227], v[92:95], v[192:207]
    s_waitcnt vmcnt(10)
    v_cmp_ne_u32 vcc, s54, v31
    s_cbranch_vccz L_chkd_44
    s_mov_b32 s63, 0
L_chk_43:
    buffer_load_dword v31, v30, s[44:47], s70 offen offset:0 sc1
    s_add_u32 s63, s63, 1
    s_cmp_ge_u32 s63, 131072
    s_waitcnt vmcnt(0)
    s_cbranch_scc1 L_chkd_44
    v_cmp_ne_u32 vcc, s54, v31
    s_cbranch_vccnz L_chk_43
L_chkd_44:
    s_add_u32 s52, s52, 4096
    buffer_load_dwordx4 a[208:211], v1, s[44:47], s52 offen offset:0 sc1
    s_waitcnt lgkmcnt(4)
    v_mfma_f32_32x32x16_bf16 v[208:223], a[228:231], v[92:95], v[208:223]
    buffer_load_dwordx4 a[212:215], v1, s[44:47], s52 offen offset:1024 sc1
    s_lshl_b32 s80, s74, 12
    s_add_u32 s80, s80, s71
    s_add_u32 s74, s74, 1
    s_cmp_eq_u32 s74, 7
    s_cselect_b32 s74, 0, s74
    buffer_load_dwordx4 v[128:131], v1, s[44:47], s80 offen offset:0 sc1
    s_waitcnt lgkmcnt(2)
    v_mfma_f32_32x32x16_bf16 v[224:239], a[232:235], v[92:95], v[224:239]
    buffer_load_dwordx4 a[216:219], v1, s[44:47], s52 offen offset:2048 sc1
    buffer_load_dwordx4 a[220:223], v1, s[44:47], s52 offen offset:3072 sc1
    buffer_load_dwordx4 v[132:135], v1, s[44:47], s80 offen offset:1024 sc1
    s_waitcnt lgkmcnt(0)
    v_mfma_f32_32x32x16_bf16 v[240:255], a[236:239], v[92:95], v[240:255]
    buffer_load_dwordx4 v[136:139], v1, s[44:47], s80 offen offset:2048 sc1
    v_mfma_f32_32x32x16_bf16 v[192:207], v[48:51], v[116:119], v[192:207]
    buffer_load_dwordx4 v[140:143], v1, s[44:47], s80 offen offset:3072 sc1
    v_mfma_f32_32x32x16_bf16 v[208:223], v[52:55], v[116:119], v[208:223]
    s_lshl_b32 s80, s74, 12
    s_add_u32 s80, s80, s71
    s_add_u32 s74, s74, 1
    s_cmp_eq_u32 s74, 7
    s_cselect_b32 s74, 0, s74
    buffer_load_dwordx4 v[144:147], v1, s[44:47], s80 offen offset:0 sc1
    v_mfma_f32_32x32x16_bf16 v[224:239], v[56:59], v[116:119], v[224:239]
    buffer_load_dwordx4 v[148:151], v1, s[44:47], s80 offen offset:1024 sc1
    v_mfma_f32_32x32x16_bf16 v[240:255], v[60:63], v[116:119], v[240:255]
    buffer_load_dwordx4 v[152:155], v1, s[44:47], s80 offen offset:2048 sc1
    s_waitcnt vmcnt(8)
    v_mfma_f32_32x32x16_bf16 v[160:175], a[0:3], v[128:131], 0
    buffer_load_dwordx4 v[156:159], v1, s[44:47], s80 offen offset:3072 sc1
    v_mfma_f32_32x32x16_bf16 v[176:191], a[4:7], v[128:131], 0
    s_lshl_b32 s80, s74, 12
    s_add_u32 s80, s80, s71
    s_add_u32 s74, s74, 1
    s_cmp_eq_u32 s74, 7
    s_cselect_b32 s74, 0, s74
    buffer_load_dwordx4 v[32:35], v1, s[44:47], s80 offen offset:0 sc1
    v_max_f32 v192, 0, v192
    v_mul_f32 v224, v121, v224
    v_max_f32 v193, 0, v193
    v_mul_f32 v225, v121, v225
    v_mul_f32 v192, v192, v224
    v_mul_f32 v193, v193, v225
    s_waitcnt vmcnt(7)
    v_mfma_f32_32x32x16_bf16 v[160:175], a[8:11], v[132:135], v[160:175]
    buffer_load_dwordx4 v[36:39], v1, s[44:47], s80 offen offset:1024 sc1
    v_cvt_pk_bf16_f32 v192, v192, v193
    v_max_f32 v194, 0, v194
    v_mul_f32 v226, v121, v226
    v_max_f32 v195, 0, v195
    v_mul_f32 v227, v121, v227
    v_mul_f32 v194, v194, v226
    v_mfma_f32_32x32x16_bf16 v[176:191], a[12:15], v[132:135], v[176:191]
    buffer_load_dwordx4 v[40:43], v1, s[44:47], s80 offen offset:2048 sc1
    v_mul_f32 v195, v195, v227
    v_cvt_pk_bf16_f32 v193, v194, v195
    v_max_f32 v196, 0, v196
    v_mul_f32 v228, v121, v228
    v_max_f32 v197, 0, v197
    s_waitcnt vmcnt(8)
    v_mfma_f32_32x32x16_bf16 v[160:175], a[16:19], v[136:139], v[160:175]
    buffer_load_dwordx4 v[44:47], v1, s[44:47], s80 offen offset:3072 sc1
    v_mul_f32 v229, v121, v229
    v_mul_f32 v196, v196, v228
    v_mul_f32 v197, v197, v229
    v_cvt_pk_bf16_f32 v194, v196, v197
    v_max_f32 v198, 0, v198
    v_mul_f32 v230, v121, v230
    v_mfma_f32_32x32x16_bf16 v[176:191], a[20:23], v[136:139], v[176:191]
    s_lshl_b32 s80, s74, 12
    s_add_u32 s80, s80, s71
    s_add_u32 s74, s74, 1
    s_cmp_eq_u32 s74, 7
    s_cselect_b32 s74, 0, s74
    buffer_load_dwordx4 v[16:19], v1, s[44:47], s80 offen offset:0 sc1
    v_max_f32 v199, 0, v199
    v_mul_f32 v231, v121, v231
    v_mul_f32 v198, v198, v230
    v_mul_f32 v199, v199, v231
    v_cvt_pk_bf16_f32 v195, v198, v199
    s_waitcnt vmcnt(9)
    v_mfma_f32_32x32x16_bf16 v[160:175], a[24:27], v[140:143], v[160:175]
    buffer_load_dwordx4 v[20:23], v1, s[44:47], s80 offen offset:1024 sc1
    buffer_store_dwordx4 v[192:195], v1, s[44:47], s66 offen offset:0 sc1
    v_max_f32 v200, 0, v200
    v_mul_f32 v232, v121, v232
    v_max_f32 v201, 0, v201
    v_mul_f32 v233, v121, v233
    v_mul_f32 v200, v200, v232
    v_mfma_f32_32x32x16_bf16 v[176:191], a[28:31], v[140:143], v[176:191]
    v_mul_f32 v201, v201, v233
    v_cvt_pk_bf16_f32 v196, v200, v201
    v_max_f32 v202, 0, v202
    v_mul_f32 v234, v121, v234
    v_max_f32 v203, 0, v203
    s_waitcnt vmcnt(10)
    v_mfma_f32_32x32x16_bf16 v[160:175], a[32:35], v[144:147], v[160:175]
    buffer_load_dwordx4 v[128:131], v1, s[44:47], s80 offen offset:2048 sc1
    v_mul_f32 v235, v121, v235
    v_mul_f32 v202, v202, v234
    v_mul_f32 v203, v203, v235
    v_cvt_pk_bf16_f32 v197, v202, v203
    v_max_f32 v204, 0, v204
    v_mul_f32 v236, v121, v236
    v_mfma_f32_32x32x16_bf16 v[176:191], a[36:39], v[144:147], v[176:191]
    v_max_f32 v205, 0, v205
    v_mul_f32 v237, v121, v237
    v_mul_f32 v204, v204, v236
    v_mul_f32 v205, v205, v237
    v_cvt_pk_bf16_f32 v198, v204, v205
    s_waitcnt vmcnt(10)
    v_mfma_f32_32x32x16_bf16 v[160:175], a[40:43], v[148:151], v[160:175]
    buffer_load_dwordx4 v[132:135], v1, s[44:47], s80 offen offset:3072 sc1
    v_max_f32 v206, 0, v206
    v_mul_f32 v238, v121, v238
    v_max_f32 v207, 0, v207
    v_mul_f32 v239, v121, v239
    v_mul_f32 v206, v206, v238
    v_mul_f32 v207, v207, v239
    v_mfma_f32_32x32x16_bf16 v[176:191], a[44:47], v[148:151], v[176:191]
    v_cvt_pk_bf16_f32 v199, v206, v207
    buffer_store_dwordx4 v[196:199], v1, s[44:47], s66 offen offset:1024 sc1
    v_max_f32 v208, 0, v208
    v_mul_f32 v240, v121, v240
    v_max_f32 v209, 0, v209
    s_waitcnt vmcnt(11)
    v_mfma_f32_32x32x16_bf16 v[160:175], a[48:51], v[152:155], v[160:175]
    s_lshl_b32 s80, s74, 12
    s_add_u32 s80, s80, s71
    s_add_u32 s74, s74, 1
    s_cmp_eq_u32 s74, 7
    s_cselect_b32 s74, 0, s74
    buffer_load_dwordx4 v[136:139], v1, s[44:47], s80 offen offset:0 sc1
    v_mul_f32 v241, v121, v241
    v_mul_f32 v208, v208, v240
    v_mul_f32 v209, v209, v241
    v_cvt_pk_bf16_f32 v208, v208, v209
    v_max_f32 v210, 0, v210
    v_mul_f32 v242, v121, v242
    v_mfma_f32_32x32x16_bf16 v[176:191], a[52:55], v[152:155], v[176:191]
    v_max_f32 v211, 0, v211
    v_mul_f32 v243, v121, v243
    v_mul_f32 v210, v210, v242
    v_mul_f32 v211, v211, v243
    v_cvt_pk_bf16_f32 v209, v210, v211
    s_waitcnt vmcnt(11)
    v_mfma_f32_32x32x16_bf16 v[160:175], a[56:59], v[156:159], v[160:175]
    buffer_load_dwordx4 v[140:143], v1, s[44:47], s80 offen offset:1024 sc1
    v_max_f32 v212, 0, v212
    v_mul_f32 v244, v121, v244
    v_max_f32 v213, 0, v213
    v_mul_f32 v245, v121, v245
    v_mul_f32 v212, v212, v244
    v_mul_f32 v213, v213, v245
    v_mfma_f32_32x32x16_bf16 v[176:191], a[60:63], v[156:159], v[176:191]
    v_cvt_pk_bf16_f32 v210, v212, v213
    v_max_f32 v214, 0, v214
    v_mul_f32 v246, v121, v246
    v_max_f32 v215, 0, v215
    v_mul_f32 v247, v121, v247
    s_waitcnt vmcnt(11)
    v_mfma_f32_32x32x16_bf16 v[160:175], a[64:67], v[32:35], v[160:175]
    buffer_load_dwordx4 v[144:147], v1, s[44:47], s80 offen offset:2048 sc1
    v_mul_f32 v214, v214, v246
    v_mul_f32 v215, v215, v247
    v_cvt_pk_bf16_f32 v211, v214, v215
    buffer_store_dwordx4 v[208:211], v1, s[44:47], s66 offen offset:2048 sc1
    v_max_f32 v216, 0, v216
    v_mul_f32 v248, v121, v248
    v_mfma_f32_32x32x16_bf16 v[176:191], a[68:71], v[32:35], v[176:191]
    v_max_f32 v217, 0, v217
    v_mul_f32 v249, v121, v249
    v_mul_f32 v216, v216, v248
    v_mul_f32 v217, v217, v249
    v_cvt_pk_bf16_f32 v212, v216, v217
    s_waitcnt vmcnt(12)
    v_mfma_f32_32x32x16_bf16 v[160:175], a[72:75], v[36:39], v[160:175]
    buffer_load_dwordx4 v[148:151], v1, s[44:47], s80 offen offset:3072 sc1
    v_max_f32 v218, 0, v218
    v_mul_f32 v250, v121, v250
    v_max_f32 v219, 0, v219
    v_mul_f32 v251, v121, v251
    v_mul_f32 v218, v218, v250
    v_mul_f32 v219, v219, v251
    v_mfma_f32_32x32x16_bf16 v[176:191], a[76:79], v[36:39], v[176:191]
    v_cvt_pk_bf16_f32 v213, v218, v219
    v_max_f32 v220, 0, v220
    v_mul_f32 v252, v121, v252
    v_max_f32 v221, 0, v221
    v_mul_f32 v253, v121, v253
    s_waitcnt vmcnt(12)
    v_mfma_f32_32x32x16_bf16 v[160:175], a[80:83], v[40:43], v[160:175]
    s_lshl_b32 s80, s74, 12
    s_add_u32 s80, s80, s71
    s_add_u32 s74, s74, 1
    s_cmp_eq_u32 s74, 7
    s_cselect_b32 s74, 0, s74
    buffer_load_dwordx4 v[152:155], v1, s[44:47], s80 offen offset:0 sc1
    v_mul_f32 v220, v220, v252
    v_mul_f32 v221, v221, v253
    v_cvt_pk_bf16_f32 v214, v220, v221
    v_max_f32 v222, 0, v222
    v_mul_f32 v254, v121, v254
    v_max_f32 v223, 0, v223
    v_mfma_f32_32x32x16_bf16 v[176:191], a[84:87], v[40:43], v[176:191]
    v_mul_f32 v255, v121, v255
    v_mul_f32 v222, v222, v254
    v_mul_f32 v223, v223, v255
    v_cvt_pk_bf16_f32 v215, v222, v223
    buffer_store_dwordx4 v[212:215], v1, s[44:47], s66 offen offset:3072 sc1
    s_waitcnt vmcnt(13)
    v_mfma_f32_32x32x16_bf16 v[160:175], a[88:91], v[44:47], v[160:175]
    buffer_load_dwordx4 v[156:159], v1, s[44:47], s80 offen offset:1024 sc1
    v_and_b32 v4, 31, v0
    v_and_b32 v5, 7, v0
    v_lshrrev_b32 v6, 5, v0
    v_xor_b32 v5, v5, v6
    v_mfma_f32_32x32x16_bf16 v[176:191], a[92:95], v[44:47], v[176:191]
    v_lshlrev_b32 v4, 8, v4
    v_add_u32 v4, s92, v4
    v_xor_b32 v6, 0, v5
    v_lshl_add_u32 v64, v6, 4, v4
    s_waitcnt vmcnt(13)
    v_mfma_f32_32x32x16_bf16 v[160:175], a[96:99], v[16:19], v[160:175]
    buffer_load_dwordx4 v[32:35], v1, s[44:47], s80 offen offset:2048 sc1
    v_xor_b32 v6, 2, v5
    v_lshl_add_u32 v65, v6, 4, v4
    v_xor_b32 v6, 4, v5
    v_lshl_add_u32 v66, v6, 4, v4
    v_mfma_f32_32x32x16_bf16 v[176:191], a[100:103], v[16:19], v[176:191]
    v_xor_b32 v6, 6, v5
    v_lshl_add_u32 v67, v6, 4, v4
    v_xor_b32 v6, 8, v5
    v_lshl_add_u32 v68, v6, 4, v4
    s_waitcnt vmcnt(13)
    v_mfma_f32_32x32x16_bf16 v[160:175], a[104:107], v[20:23], v[160:175]
    buffer_load_dwordx4 v[36:39], v1, s[44:47], s80 offen offset:3072 sc1
    v_xor_b32 v6, 10, v5
    v_lshl_add_u32 v69, v6, 4, v4
    v_xor_b32 v6, 12, v5
    v_lshl_add_u32 v70, v6, 4, v4
    v_mfma_f32_32x32x16_bf16 v[176:191], a[108:111], v[20:23], v[176:191]
    v_xor_b32 v6, 14, v5
    v_lshl_add_u32 v71, v6, 4, v4
    v_lshrrev_b32 v4, 3, v0
    v_and_b32 v6, 7, v0
    s_waitcnt vmcnt(12)
    v_mfma_f32_32x32x16_bf16 v[160:175], a[112:115], v[128:131], v[160:175]
    s_lshl_b32 s80, s74, 12
    s_add_u32 s80, s80, s71
    s_add_u32 s74, s74, 1
    s_cmp_eq_u32 s74, 7
    s_cselect_b32 s74, 0, s74
    buffer_load_dwordx4 v[40:43], v1, s[44:47], s80 offen offset:0 sc1
    v_lshlrev_b32 v5, 1, v6
    v_xor_b32 v5, v5, v4
    s_lshl_b32 s56, s50, 11
    s_add_u32 s56, s56, 130560
    v_mfma_f32_32x32x16_bf16 v[176:191], a[116:119], v[128:131], v[176:191]
    v_lshl_add_u32 v7, v4, 8, s56
    v_lshl_add_u32 v72, v5, 4, v7
    v_xor_b32 v73, 16, v72
    v_mul_u32_u24 v4, 896, v4
    s_waitcnt vmcnt(12)
    v_mfma_f32_32x32x16_bf16 v[160:175], a[120:123], v[132:135], v[160:175]
    buffer_load_dwordx4 v[44:47], v1, s[44:47], s80 offen offset:1024 sc1
    v_lshl_add_u32 v74, v6, 4, v4
    v_lshlrev_b32 v6, 5, v6
    ds_read_b128 v[76:79], v6 offset:2304
    ds_read_b128 v[80:83], v6 offset:2320
    v_mfma_f32_32x32x16_bf16 v[176:191], a[124:127], v[132:135], v[176:191]
    s_lshl_b32 s56, s50, 10
    s_add_u32 s56, s56, 122368
    v_add_u32 v75, s56, v1
    s_waitcnt vmcnt(11)
    v_mfma_f32_32x32x16_bf16 v[160:175], a[128:131], v[136:139], v[160:175]
    buffer_load_dwordx4 v[16:19], v1, s[44:47], s80 offen offset:2048 sc1
    v_mfma_f32_32x32x16_bf16 v[176:191], a[132:135], v[136:139], v[176:191]
    s_waitcnt vmcnt(11)
    v_mfma_f32_32x32x16_bf16 v[160:175], a[136:139], v[140:143], v[160:175]
    buffer_load_dwordx4 v[20:23], v1, s[44:47], s80 offen offset:3072 sc1
    v_mfma_f32_32x32x16_bf16 v[176:191], a[140:143], v[140:143], v[176:191]
    s_waitcnt vmcnt(11)
    v_mfma_f32_32x32x16_bf16 v[160:175], a[144:147], v[144:147], v[160:175]
    v_mfma_f32_32x32x16_bf16 v[176:191], a[148:151], v[144:147], v[176:191]
    s_waitcnt vmcnt(9)
    v_mfma_f32_32x32x16_bf16 v[160:175], a[152:155], v[148:151], v[160:175]
    buffer_load_dword v31, v30, s[44:47], s70 offen offset:128 sc1
    v_mfma_f32_32x32x16_bf16 v[176:191], a[156:159], v[148:151], v[176:191]
    s_waitcnt vmcnt(9)
    v_mfma_f32_32x32x16_bf16 v[160:175], a[160:163], v[152:155], v[160:175]
    s_waitcnt vmcnt(8)
    v_mov_b32 v7, s54
    s_mov_b64 exec, 1
    s_cmp_lg_u32 s55, 0
    s_cbranch_scc0 L_slowfl_45
    buffer_store_dword v7, off, s[44:47], s68
    s_branch L_fl_46
L_slowfl_45:
    buffer_store_dword v7, off, s[44:47], s68 sc1
L_fl_46:
    s_mov_b64 exec, -1
    v_mfma_f32_32x32x16_bf16 v[176:191], a[164:167], v[152:155], v[176:191]
    s_waitcnt vmcnt(8)
    v_mfma_f32_32x32x16_bf16 v[160:175], a[168:171], v[156:159], v[160:175]
    v_mfma_f32_32x32x16_bf16 v[176:191], a[172:175], v[156:159], v[176:191]
    s_waitcnt vmcnt(7)
    v_mfma_f32_32x32x16_bf16 v[160:175], a[176:179], v[32:35], v[160:175]
    v_mfma_f32_32x32x16_bf16 v[176:191], a[180:183], v[32:35], v[176:191]
    s_waitcnt vmcnt(6)
    v_mfma_f32_32x32x16_bf16 v[160:175], a[184:187], v[36:39], v[160:175]
    s_waitcnt vmcnt(1)
    v_cmp_ne_u32 vcc, s54, v31
    s_cbranch_vccz L_chkd_48
    s_mov_b32 s63, 0
L_chk_47:
    buffer_load_dword v31, v30, s[44:47], s70 offen offset:128 sc1
    s_add_u32 s63, s63, 1
    s_cmp_ge_u32 s63, 131072
    s_waitcnt vmcnt(0)
    s_cbranch_scc1 L_chkd_48
    v_cmp_ne_u32 vcc, s54, v31
    s_cbranch_vccnz L_chk_47
L_chkd_48:
    s_add_u32 s71, s71, 114688
    s_lshl_b32 s80, s74, 12
    s_add_u32 s80, s80, s71
    s_add_u32 s74, s74, 1
    s_cmp_eq_u32 s74, 7
    s_cselect_b32 s74, 0, s74
    buffer_load_dwordx4 v[128:131], v1, s[44:47], s80 offen offset:0 sc1
    v_mfma_f32_32x32x16_bf16 v[176:191], a[188:191], v[36:39], v[176:191]
    buffer_load_dwordx4 v[132:135], v1, s[44:47], s80 offen offset:1024 sc1
    v_mfma_f32_32x32x16_bf16 v[160:175], a[192:195], v[40:43], v[160:175]
    buffer_load_dwordx4 v[136:139], v1, s[44:47], s80 offen offset:2048 sc1
    v_mfma_f32_32x32x16_bf16 v[176:191], a[196:199], v[40:43], v[176:191]
    buffer_load_dwordx4 v[140:143], v1, s[44:47], s80 offen offset:3072 sc1
    v_mfma_f32_32x32x16_bf16 v[160:175], a[200:203], v[44:47], v[160:175]
    s_lshl_b32 s80, s74, 12
    s_add_u32 s80, s80, s71
    s_add_u32 s74, s74, 1
    s_cmp_eq_u32 s74, 7
    s_cselect_b32 s74, 0, s74
    buffer_load_dwordx4 v[144:147], v1, s[44:47], s80 offen offset:0 sc1
    v_mfma_f32_32x32x16_bf16 v[176:191], a[204:207], v[44:47], v[176:191]
    buffer_load_dwordx4 v[148:151], v1, s[44:47], s80 offen offset:1024 sc1
    v_mfma_f32_32x32x16_bf16 v[160:175], a[208:211], v[16:19], v[160:175]
    buffer_load_dwordx4 v[152:155], v1, s[44:47], s80 offen offset:2048 sc1
    v_mfma_f32_32x32x16_bf16 v[176:191], a[212:215], v[16:19], v[176:191]
    buffer_load_dwordx4 v[156:159], v1, s[44:47], s80 offen offset:3072 sc1
    v_mfma_f32_32x32x16_bf16 v[160:175], a[216:219], v[20:23], v[160:175]
    s_lshl_b32 s80, s74, 12
    s_add_u32 s80, s80, s71
    s_add_u32 s74, s74, 1
    s_cmp_eq_u32 s74, 7
    s_cselect_b32 s74, 0, s74
    buffer_load_dwordx4 v[32:35], v1, s[44:47], s80 offen offset:0 sc1
    v_mfma_f32_32x32x16_bf16 v[176:191], a[220:223], v[20:23], v[176:191]
    buffer_load_dwordx4 v[36:39], v1, s[44:47], s80 offen offset:1024 sc1
    s_waitcnt vmcnt(9)
    v_mfma_f32_32x32x16_bf16 v[224:239], a[0:3], v[128:131], 0
    buffer_load_dwordx4 v[40:43], v1, s[44:47], s80 offen offset:2048 sc1
    v_mfma_f32_32x32x16_bf16 v[240:255], a[4:7], v[128:131], 0
    s_waitcnt vmcnt(9)
    v_mfma_f32_32x32x16_bf16 v[224:239], a[8:11], v[132:135], v[224:239]
    buffer_load_dwordx4 v[44:47], v1, s[44:47], s80 offen offset:3072 sc1
    ds_write_b128 v64, v[160:163]
    v_mfma_f32_32x32x16_bf16 v[240:255], a[12:15], v[132:135], v[240:255]
    ds_write_b128 v65, v[164:167]
    s_waitcnt vmcnt(9)
    v_mfma_f32_32x32x16_bf16 v[224:239], a[16:19], v[136:139], v[224:239]
    s_lshl_b32 s80, s74, 12
    s_add_u32 s80, s80, s71
    s_add_u32 s74, s74, 1
    s_cmp_eq_u32 s74, 7
    s_cselect_b32 s74, 0, s74
    buffer_load_dwordx4 v[16:19], v1, s[44:47], s80 offen offset:0 sc1
    ds_write_b128 v66, v[168:171]
    v_mfma_f32_32x32x16_bf16 v[240:255], a[20:23], v[136:139], v[240:255]
    ds_write_b128 v67, v[172:175]
    s_waitcnt vmcnt(9)
    v_mfma_f32_32x32x16_bf16 v[224:239], a[24:27], v[140:143], v[224:239]
    buffer_load_dwordx4 v[20:23], v1, s[44:47], s80 offen offset:1024 sc1
    ds_write_b128 v68, v[176:179]
    v_mfma_f32_32x32x16_bf16 v[240:255], a[28:31], v[140:143], v[240:255]
    ds_write_b128 v69, v[180:183]
    s_waitcnt vmcnt(9)
    v_mfma_f32_32x32x16_bf16 v[224:239], a[32:35], v[144:147], v[224:239]
    buffer_load_dwordx4 v[128:131], v1, s[44:47], s80 offen offset:2048 sc1
    ds_write_b128 v70, v[184:187]
    v_mfma_f32_32x32x16_bf16 v[240:255], a[36:39], v[144:147], v[240:255]
    ds_write_b128 v71, v[188:191]
    s_waitcnt vmcnt(9)
    v_mfma_f32_32x32x16_bf16 v[224:239], a[40:43], v[148:151], v[224:239]
    buffer_load_dwordx4 v[132:135], v1, s[44:47], s80 offen offset:3072 sc1
    v_mfma_f32_32x32x16_bf16 v[240:255], a[44:47], v[148:151], v[240:255]
    s_waitcnt vmcnt(9)
    v_mfma_f32_32x32x16_bf16 v[224:239], a[48:51], v[152:155], v[224:239]
    s_lshl_b32 s80, s74, 12
    s_add_u32 s80, s80, s71
    s_add_u32 s74, s74, 1
    s_cmp_eq_u32 s74, 7
    s_cselect_b32 s74, 0, s74
    buffer_load_dwordx4 v[136:139], v1, s[44:47], s80 offen offset:0 sc1
    v_mfma_f32_32x32x16_bf16 v[240:255], a[52:55], v[152:155], v[240:255]
    s_waitcnt vmcnt(9)
    v_mfma_f32_32x32x16_bf16 v[224:239], a[56:59], v[156:159], v[224:239]
    buffer_load_dwordx4 v[140:143], v1, s[44:47], s80 offen offset:1024 sc1
    s_waitcnt lgkmcnt(0)
    s_barrier
    v_mfma_f32_32x32x16_bf16 v[240:255], a[60:63], v[156:159], v[240:255]
    ds_read_b128 v[84:87], v75 offset:0
    ds_read_b128 v[88:91], v72 offset:0
    s_waitcnt vmcnt(9)
    v_mfma_f32_32x32x16_bf16 v[224:239], a[64:67], v[32:35], v[224:239]
    buffer_load_dwordx4 v[144:147], v1, s[44:47], s80 offen offset:2048 sc1
    ds_read_b128 v[92:95], v72 offset:8192
    ds_read_b128 v[96:99], v72 offset:16384
    v_mfma_f32_32x32x16_bf16 v[240:255], a[68:71], v[32:35], v[240:255]
    ds_read_b128 v[100:103], v72 offset:24576
    ds_read_b128 v[104:107], v73 offset:0
    s_waitcnt vmcnt(9)
    v_mfma_f32_32x32x16_bf16 v[224:239], a[72:75], v[36:39], v[224:239]
    buffer_load_dwordx4 v[148:151], v1, s[44:47], s80 offen offset:3072 sc1
    ds_read_b128 v[108:111], v73 offset:8192
    ds_read_b128 v[112:115], v73 offset:16384
    v_mfma_f32_32x32x16_bf16 v[240:255], a[76:79], v[36:39], v[240:255]
    ds_read_b128 v[116:119], v73 offset:24576
    s_waitcnt lgkmcnt(4)
    s_waitcnt vmcnt(9)
    v_mfma_f32_32x32x16_bf16 v[224:239], a[80:83], v[40:43], v[224:239]
    s_lshl_b32 s80, s74, 12
    s_add_u32 s80, s80, s71
    s_add_u32 s74, s74, 1
    s_cmp_eq_u32 s74, 7
    s_cselect_b32 s74, 0, s74
    buffer_load_dwordx4 v[152:155], v1, s[44:47], s80 offen offset:0 sc1
    v_lshlrev_b32 v120, 16, v84
    v_and_b32 v121, 0xffff0000, v84
    v_mfma_f32_32x32x16_bf16 v[240:255], a[84:87], v[40:43], v[240:255]
    v_lshlrev_b32 v122, 16, v85
    v_and_b32 v123, 0xffff0000, v85
    s_waitcnt vmcnt(9)
    v_mfma_f32_32x32x16_bf16 v[224:239], a[88:91], v[44:47], v[224:239]
    buffer_load_dwordx4 v[156:159], v1, s[44:47], s80 offen offset:1024 sc1
    v_lshlrev_b32 v124, 16, v86
    v_and_b32 v125, 0xffff0000, v86
    v_mfma_f32_32x32x16_bf16 v[240:255], a[92:95], v[44:47], v[240:255]
    v_lshlrev_b32 v126, 16, v87
    s_waitcnt vmcnt(9)
    v_mfma_f32_32x32x16_bf16 v[224:239], a[96:99], v[16:19], v[224:239]
    buffer_load_dwordx4 v[32:35], v1, s[44:47], s80 offen offset:2048 sc1
    v_and_b32 v127, 0xffff0000, v87
    v_add_f32 v88, v88, v92
    v_mfma_f32_32x32x16_bf16 v[240:255], a[100:103], v[16:19], v[240:255]
    v_add_f32 v96, v96, v100
    v_add_f32 v89, v89, v93
    s_waitcnt vmcnt(9)
    v_mfma_f32_32x32x16_bf16 v[224:239], a[104:107], v[20:23], v[224:239]
    buffer_load_dwordx4 v[36:39], v1, s[44:47], s80 offen offset:3072 sc1
    v_add_f32 v97, v97, v101
    v_add_f32 v90, v90, v94
    v_mfma_f32_32x32x16_bf16 v[240:255], a[108:111], v[20:23], v[240:255]
    v_add_f32 v98, v98, v102
    v_add_f32 v91, v91, v95
    s_waitcnt vmcnt(9)
    v_mfma_f32_32x32x16_bf16 v[224:239], a[112:115], v[128:131], v[224:239]
    s_lshl_b32 s80, s74, 12
    s_add_u32 s80, s80, s71
    s_add_u32 s74, s74, 1
    s_cmp_eq_u32 s74, 7
    s_cselect_b32 s74, 0, s74
    buffer_load_dwordx4 v[40:43], v1, s[44:47], s80 offen offset:0 sc1
    v_add_f32 v99, v99, v103
    v_add_f32 v88, v88, v96
    v_mfma_f32_32x32x16_bf16 v[240:255], a[116:119], v[128:131], v[240:255]
    v_add_f32 v89, v89, v97
    v_add_f32 v90, v90, v98
    s_waitcnt vmcnt(9)
    v_mfma_f32_32x32x16_bf16 v[224:239], a[120:123], v[132:135], v[224:239]
    buffer_load_dwordx4 v[44:47], v1, s[44:47], s80 offen offset:1024 sc1
    v_add_f32 v91, v91, v99
    v_fmac_f32 v120, v76, v88
    v_mfma_f32_32x32x16_bf16 v[240:255], a[124:127], v[132:135], v[240:255]
    v_fmac_f32 v121, v77, v89
    v_fmac_f32 v122, v78, v90
    s_waitcnt vmcnt(9)
    v_mfma_f32_32x32x16_bf16 v[224:239], a[128:131], v[136:139], v[224:239]
    buffer_load_dwordx4 v[16:19], v1, s[44:47], s80 offen offset:2048 sc1
    v_fmac_f32 v123, v79, v91
    v_mfma_f32_32x32x16_bf16 v[240:255], a[132:135], v[136:139], v[240:255]
    v_cvt_pk_bf16_f32 v84, v120, v121
    v_cvt_pk_bf16_f32 v85, v122, v123
    s_waitcnt vmcnt(9)
    v_mfma_f32_32x32x16_bf16 v[224:239], a[136:139], v[140:143], v[224:239]
    buffer_load_dwordx4 v[20:23], v1, s[44:47], s80 offen offset:3072 sc1
    s_waitcnt lgkmcnt(0)
    v_add_f32 v104, v104, v108
    v_mfma_f32_32x32x16_bf16 v[240:255], a[140:143], v[140:143], v[240:255]
    v_add_f32 v112, v112, v116
    v_add_f32 v105, v105, v109
    s_waitcnt vmcnt(9)
    v_mfma_f32_32x32x16_bf16 v[224:239], a[144:147], v[144:147], v[224:239]
    v_add_f32 v113, v113, v117
    v_add_f32 v106, v106, v110
    v_mfma_f32_32x32x16_bf16 v[240:255], a[148:151], v[144:147], v[240:255]
    v_add_f32 v114, v114, v118
    v_add_f32 v107, v107, v111
    s_waitcnt vmcnt(8)
    v_mfma_f32_32x32x16_bf16 v[224:239], a[152:155], v[148:151], v[224:239]
    v_add_f32 v115, v115, v119
    v_add_f32 v104, v104, v112
    v_mfma_f32_32x32x16_bf16 v[240:255], a[156:159], v[148:151], v[240:255]
    v_add_f32 v105, v105, v113
    v_add_f32 v106, v106, v114
    s_waitcnt vmcnt(7)
    v_mfma_f32_32x32x16_bf16 v[224:239], a[160:163], v[152:155], v[224:239]
    v_add_f32 v107, v107, v115
    v_fmac_f32 v124, v80, v104
    v_mfma_f32_32x32x16_bf16 v[240:255], a[164:167], v[152:155], v[240:255]
    v_fmac_f32 v125, v81, v105
    s_waitcnt vmcnt(6)
    v_mfma_f32_32x32x16_bf16 v[224:239], a[168:171], v[156:159], v[224:239]
    v_fmac_f32 v126, v82, v106
    v_fmac_f32 v127, v83, v107
    v_mfma_f32_32x32x16_bf16 v[240:255], a[172:175], v[156:159], v[240:255]
    v_cvt_pk_bf16_f32 v86, v124, v125
    v_cvt_pk_bf16_f32 v87, v126, v127
    s_waitcnt vmcnt(5)
    v_mfma_f32_32x32x16_bf16 v[224:239], a[176:179], v[32:35], v[224:239]
    buffer_store_dwordx4 v[84:87], v74, s[36:39], s77 offen
    v_add_u32 v64, -126976, v64
    v_mfma_f32_32x32x16_bf16 v[240:255], a[180:183], v[32:35], v[240:255]
    v_add_u32 v65, -126976, v65
    v_add_u32 v66, -126976, v66
    s_waitcnt vmcnt(5)
    v_mfma_f32_32x32x16_bf16 v[224:239], a[184:187], v[36:39], v[224:239]
    v_add_u32 v67, -126976, v67
    v_add_u32 v68, -126976, v68
    v_mfma_f32_32x32x16_bf16 v[240:255], a[188:191], v[36:39], v[240:255]
    v_add_u32 v69, -126976, v69
    v_add_u32 v70, -126976, v70
    s_waitcnt vmcnt(4)
    v_mfma_f32_32x32x16_bf16 v[224:239], a[192:195], v[40:43], v[224:239]
    v_add_u32 v71, -126976, v71
    v_add_u32 v72, -126976, v72
    v_mfma_f32_32x32x16_bf16 v[240:255], a[196:199], v[40:43], v[240:255]
    v_add_u32 v73, -126976, v73
    s_waitcnt vmcnt(3)
    v_mfma_f32_32x32x16_bf16 v[224:239], a[200:203], v[44:47], v[224:239]
    v_mfma_f32_32x32x16_bf16 v[240:255], a[204:207], v[44:47], v[240:255]
    s_waitcnt vmcnt(2)
    v_mfma_f32_32x32x16_bf16 v[224:239], a[208:211], v[16:19], v[224:239]
    v_mfma_f32_32x32x16_bf16 v[240:255], a[212:215], v[16:19], v[240:255]
    s_waitcnt vmcnt(1)
    v_mfma_f32_32x32x16_bf16 v[224:239], a[216:219], v[20:23], v[224:239]
    v_mfma_f32_32x32x16_bf16 v[240:255], a[220:223], v[20:23], v[240:255]
    s_nop 10
    ds_write_b128 v64, v[224:227]
    ds_write_b128 v65, v[228:231]
    ds_write_b128 v66, v[232:235]
    ds_write_b128 v67, v[236:239]
    ds_write_b128 v68, v[240:243]
    ds_write_b128 v69, v[244:247]
    ds_write_b128 v70, v[248:251]
    ds_write_b128 v71, v[252:255]
    s_waitcnt lgkmcnt(0)
    s_barrier
    ds_read_b128 v[84:87], v75 offset:4096
    ds_read_b128 v[88:91], v72 offset:0
    ds_read_b128 v[92:95], v72 offset:8192
    ds_read_b128 v[96:99], v72 offset:16384
    ds_read_b128 v[100:103], v72 offset:24576
    ds_read_b128 v[104:107], v73 offset:0
    ds_read_b128 v[108:111], v73 offset:8192
    ds_read_b128 v[112:115], v73 offset:16384
    ds_read_b128 v[116:119], v73 offset:24576
    s_waitcnt lgkmcnt(4)
    v_lshlrev_b32 v120, 16, v84
    v_and_b32 v121, 0xffff0000, v84
    v_lshlrev_b32 v122, 16, v85
    v_and_b32 v123, 0xffff0000, v85
    v_lshlrev_b32 v124, 16, v86
    v_and_b32 v125, 0xffff0000, v86
    v_lshlrev_b32 v126, 16, v87
    v_and_b32 v127, 0xffff0000, v87
    v_add_f32 v88, v88, v92
    v_add_f32 v96, v96, v100
    v_add_f32 v89, v89, v93
    v_add_f32 v97, v97, v101
    v_add_f32 v90, v90, v94
    v_add_f32 v98, v98, v102
    v_add_f32 v91, v91, v95
    v_add_f32 v99, v99, v103
    v_add_f32 v88, v88, v96
    v_add_f32 v89, v89, v97
    v_add_f32 v90, v90, v98
    v_add_f32 v91, v91, v99
    v_fmac_f32 v120, v76, v88
    v_fmac_f32 v121, v77, v89
    v_fmac_f32 v122, v78, v90
    v_fmac_f32 v123, v79, v91
    v_cvt_pk_bf16_f32 v84, v120, v121
    v_cvt_pk_bf16_f32 v85, v122, v123
    s_waitcnt lgkmcnt(0)
    v_add_f32 v104, v104, v108
    v_add_f32 v112, v112, v116
    v_add_f32 v105, v105, v109
    v_add_f32 v113, v113, v117
    v_add_f32 v106, v106, v110
    v_add_f32 v114, v114, v118
    v_add_f32 v107, v107, v111
    v_add_f32 v115, v115, v119
    v_add_f32 v104, v104, v112
    v_add_f32 v105, v105, v113
    v_add_f32 v106, v106, v114
    v_add_f32 v107, v107, v115
    v_fmac_f32 v124, v80, v104
    v_fmac_f32 v125, v81, v105
    v_fmac_f32 v126, v82, v106
    v_fmac_f32 v127, v83, v107
    v_cvt_pk_bf16_f32 v86, v124, v125
    v_cvt_pk_bf16_f32 v87, v126, v127
    buffer_store_dwordx4 v[84:87], v74, s[36:39], s78 offen
    s_branch L_fin
L_spare:
    s_barrier
    s_sub_u32 s74, s49, 28
    s_lshl_b32 s74, s74, 3
    s_add_u32 s74, s74, s48
    s_cmp_lt_u32 s74, 28
    s_cbranch_scc1 L_bias
    s_cmp_lg_u32 s74, 31
    s_cbranch_scc1 L_fin
    s_cmp_lg_u32 s50, 0
    s_cbranch_scc1 L_fin
    v_lshlrev_b32 v4, 7, v0
    s_mov_b32 s63, 0
L_bump_49:
    s_mov_b32 s56, 655360
    buffer_load_dword v8, v4, s[44:47], s56 offen sc1
    s_mov_b32 s56, 663552
    buffer_load_dword v9, v4, s[44:47], s56 offen sc1
    s_mov_b32 s56, 671744
    buffer_load_dword v10, v4, s[44:47], s56 offen sc1
    s_mov_b32 s56, 679936
    buffer_load_dword v11, v4, s[44:47], s56 offen sc1
    s_add_u32 s63, s63, 1
    s_cmp_ge_u32 s63, 131072
    s_waitcnt vmcnt(0)
    s_cbranch_scc1 L_bumpd_50
    v_xor_b32 v8, s54, v8
    v_xor_b32 v9, s54, v9
    v_xor_b32 v10, s54, v10
    v_xor_b32 v11, s54, v11
    v_or3_b32 v8, v8, v9, v10
    v_or_b32 v8, v8, v11
    v_cmp_ne_u32 vcc, 0, v8
    s_cbranch_vccnz L_bump_49
L_bumpd_50:
    v_mov_b32 v4, s54
    s_mov_b64 exec, 1
    buffer_store_dword v4, off, s[44:47], 0 sc1
    s_mov_b64 exec, -1
    s_branch L_fin
L_bias:
    s_lshl_b32 s56, s50, 6
    v_add_u32 v4, s56, v0
    v_min_u32 v4, 223, v4
    v_cmp_gt_u32 vcc, 112, v4
    v_subrev_u32 v5, 112, v4
    s_nop 0
    v_cndmask_b32 v5, v5, v4, vcc
    v_mov_b32 v6, 336
    v_mov_b32 v7, 448
    v_cndmask_b32 v6, v6, v7, vcc
    v_add_u32 v6, v6, v5
    v_lshlrev_b32 v208, 4, v6
    v_lshrrev_b32 v6, 3, v5
    v_lshlrev_b32 v6, 6, v6
    v_and_b32 v7, 3, v5
    v_lshl_add_u32 v6, v7, 4, v6
    v_bfe_u32 v7, v5, 2, 1
    v_lshl_add_u32 v6, v7, 3, v6
    v_mov_b32 v7, 896
    v_cndmask_b32 v7, v7, 0, vcc
    v_add_u32 v209, v6, v7
    v_cndmask_b32 v210, 0, 1.0, vcc
    s_mov_b32 s56, 65536
    buffer_load_dwordx4 v[216:219], v208, s[44:47], s56 offen sc1
    s_mov_b32 s56, 76288
    buffer_load_dwordx4 v[220:223], v208, s[44:47], s56 offen sc1
    s_mov_b32 s56, 87040
    buffer_load_dwordx4 v[224:227], v208, s[44:47], s56 offen sc1
    s_mov_b32 s56, 97792
    buffer_load_dwordx4 v[228:231], v208, s[44:47], s56 offen sc1
    s_add_u32 s59, s99, 458752
    s_add_u32 m0, s101, 77824
    s_nop 0
    buffer_load_dwordx4 v12, s[16:19], s59 offen lds
    s_add_u32 s59, s99, 458752
    s_add_u32 m0, s101, 81920
    s_nop 0
    buffer_load_dwordx4 v12, s[20:23], s59 offen lds
    s_add_u32 s59, s99, 573440
    s_add_u32 m0, s101, 3584
    s_nop 0
    buffer_load_dwordx4 v12, s[16:19], s59 offen lds
    s_add_u32 s59, s99, 573440
    s_add_u32 m0, s101, 7680
    s_nop 0
    buffer_load_dwordx4 v12, s[20:23], s59 offen lds
    s_add_u32 s59, s99, 688128
    s_add_u32 m0, s101, 11776
    s_nop 0
    buffer_load_dwordx4 v12, s[16:19], s59 offen lds
    s_add_u32 s59, s99, 688128
    s_add_u32 m0, s101, 15872
    s_nop 0
    buffer_load_dwordx4 v12, s[20:23], s59 offen lds
    s_add_u32 s59, s99, 802816
    s_add_u32 m0, s101, 19968
    s_nop 0
    buffer_load_dwordx4 v12, s[16:19], s59 offen lds
    s_add_u32 s59, s99, 802816
    s_add_u32 m0, s101, 24064
    s_nop 0
    buffer_load_dwordx4 v12, s[20:23], s59 offen lds
    s_add_u32 s59, s99, 917504
    s_add_u32 m0, s101, 28160
    s_nop 0
    buffer_load_dwordx4 v12, s[16:19], s59 offen lds
    s_add_u32 s59, s99, 917504
    s_add_u32 m0, s101, 32256
    s_nop 0
    buffer_load_dwordx4 v12, s[20:23], s59 offen lds
    s_add_u32 s59, s99, 1032192
    s_add_u32 m0, s101, 36352
    s_nop 0
    buffer_load_dwordx4 v12, s[16:19], s59 offen lds
    s_add_u32 s59, s99, 1032192
    s_add_u32 m0, s101, 40448
    s_nop 0
    buffer_load_dwordx4 v12, s[20:23], s59 offen lds
    s_add_u32 s59, s99, 1146880
    s_add_u32 m0, s101, 44544
    s_nop 0
    buffer_load_dwordx4 v12, s[16:19], s59 offen lds
    s_add_u32 s59, s99, 1146880
    s_add_u32 m0, s101, 48640
    s_nop 0
    buffer_load_dwordx4 v12, s[20:23], s59 offen lds
    s_add_u32 s59, s99, 1261568
    s_add_u32 m0, s101, 52736
    s_nop 0
    buffer_load_dwordx4 v12, s[16:19], s59 offen lds
    s_add_u32 s59, s99, 1261568
    s_add_u32 m0, s101, 56832
    s_nop 0
    buffer_load_dwordx4 v12, s[20:23], s59 offen lds
    s_add_u32 s59, s99, 1376256
    s_add_u32 m0, s101, 105984
    s_nop 0
    buffer_load_dwordx4 v12, s[16:19], s59 offen lds
    s_add_u32 s59, s99, 1376256
    s_add_u32 m0, s101, 110080
    s_nop 0
    buffer_load_dwordx4 v12, s[20:23], s59 offen lds
    s_add_u32 s59, s99, 1490944
    s_add_u32 m0, s101, 114176
    s_nop 0
    buffer_load_dwordx4 v12, s[16:19], s59 offen lds
    s_add_u32 s59, s99, 1490944
    s_add_u32 m0, s101, 118272
    s_nop 0
    buffer_load_dwordx4 v12, s[20:23], s59 offen lds
    v_lshrrev_b32 v24, 5, v0
    v_mul_u32_u24 v24, 4, v24
    v_bfe_u32 v5, v0, 2, 2
    v_add_u32 v24, v24, v5
    v_lshlrev_b32 v24, 7, v24
    v_bfe_u32 v4, v0, 4, 1
    v_lshl_add_u32 v24, v4, 5, v24
    v_and_b32 v4, 3, v0
    v_lshl_add_u32 v24, v4, 3, v24
    v_lshrrev_b32 v5, 1, v5
    v_lshl_add_u32 v24, v5, 6, v24
    v_xor_b32 v25, 64, v24
    v_add_u32 v26, 65536, v24
    v_add_u32 v27, 65536, v25
    v_add_u32 v28, 131072, v24
    v_add_u32 v29, 131072, v25
    s_and_b32 s56, s50, 1
    s_lshl_b32 s56, s56, 6
    v_xor_b32 v26, s56, v24
    s_lshr_b32 s56, s50, 1
    s_lshl_b32 s56, s56, 12
    v_add_u32 v26, s56, v26
    v_add_u32 v28, 65536, v26
    v_add_u32 v30, 131072, v26
    v_and_b32 v4, 1, v0
    v_mul_u32_u24 v4, 896, v4
    v_lshrrev_b32 v5, 5, v0
    v_lshl_add_u32 v27, v5, 4, v4
    s_mov_b32 s63, 0
    s_mov_b32 s59, 0x0c0c0400
    s_mov_b32 s60, 0x04000c0c
    s_waitcnt vmcnt(20)
L_gath_51:
    v_perm_b32 v232, v217, v216, s59
    v_perm_b32 v233, v219, v218, s60
    v_or_b32 v232, v232, v233
    v_xor_b32 v234, s54, v232
    v_perm_b32 v232, v221, v220, s59
    v_perm_b32 v233, v223, v222, s60
    v_or_b32 v232, v232, v233
    v_xor_b32 v235, s54, v232
    v_perm_b32 v232, v225, v224, s59
    v_perm_b32 v233, v227, v226, s60
    v_or_b32 v232, v232, v233
    v_xor_b32 v236, s54, v232
    v_perm_b32 v232, v229, v228, s59
    v_perm_b32 v233, v231, v230, s60
    v_or_b32 v232, v232, v233
    v_xor_b32 v237, s54, v232
    v_or3_b32 v232, v234, v235, v236
    v_or_b32 v232, v232, v237
    v_cmp_ne_u32 vcc, 0, v232
    s_cbranch_vccz L_gathd_52
    s_mov_b32 s56, 65536
    buffer_load_dwordx4 v[216:219], v208, s[44:47], s56 offen sc1
    s_mov_b32 s56, 76288
    buffer_load_dwordx4 v[220:223], v208, s[44:47], s56 offen sc1
    s_mov_b32 s56, 87040
    buffer_load_dwordx4 v[224:227], v208, s[44:47], s56 offen sc1
    s_mov_b32 s56, 97792
    buffer_load_dwordx4 v[228:231], v208, s[44:47], s56 offen sc1
    s_add_u32 s63, s63, 1
    s_cmp_ge_u32 s63, 131072
    s_waitcnt vmcnt(0)
    s_cbranch_scc0 L_gath_51
L_gathd_52:
    v_and_b32 v216, 0xffffff00, v216
    v_and_b32 v217, 0xffffff00, v217
    v_and_b32 v218, 0xffffff00, v218
    v_and_b32 v219, 0xffffff00, v219
    v_and_b32 v220, 0xffffff00, v220
    v_and_b32 v221, 0xffffff00, v221
    v_and_b32 v222, 0xffffff00, v222
    v_and_b32 v223, 0xffffff00, v223
    v_and_b32 v224, 0xffffff00, v224
    v_and_b32 v225, 0xffffff00, v225
    v_and_b32 v226, 0xffffff00, v226
    v_and_b32 v227, 0xffffff00, v227
    v_and_b32 v228, 0xffffff00, v228
    v_and_b32 v229, 0xffffff00, v229
    v_and_b32 v230, 0xffffff00, v230
    v_and_b32 v231, 0xffffff00, v231
    v_add_f32 v216, v216, v220
    v_add_f32 v224, v224, v228
    v_add_f32 v217, v217, v221
    v_add_f32 v225, v225, v229
    v_add_f32 v218, v218, v222
    v_add_f32 v226, v226, v230
    v_add_f32 v219, v219, v223
    v_add_f32 v227, v227, v231
    v_add_f32 v216, v216, v224
    v_add_f32 v217, v217, v225
    v_add_f32 v218, v218, v226
    v_add_f32 v219, v219, v227
    v_cvt_pk_bf16_f32 v232, v216, v217
    v_lshlrev_b32 v216, 16, v232
    v_and_b32 v217, 0xffff0000, v232
    v_cvt_pk_bf16_f32 v232, v218, v219
    v_lshlrev_b32 v218, 16, v232
    v_and_b32 v219, 0xffff0000, v232
    v_add_f32 v216, v216, v210
    v_add_f32 v217, v217, v210
    v_add_f32 v218, v218, v210
    v_add_f32 v219, v219, v210
    v_cvt_pk_bf16_f32 v220, v216, v217
    v_cvt_pk_bf16_f32 v221, v218, v219
    ds_write_b64 v209, v[220:221] offset:0
    s_waitcnt vmcnt(0)
    s_waitcnt lgkmcnt(0)
    s_barrier
    ds_read_b128 a[224:227], v27 offset:0
    ds_read_b64_tr_b16 a[228:229], v28 offset:24064
    ds_read_b64_tr_b16 a[230:231], v28 offset:26112
    ds_read_b128 a[232:235], v27 offset:32
    ds_read_b64_tr_b16 a[236:237], v28 offset:25088
    ds_read_b64_tr_b16 a[238:239], v28 offset:27136
    ds_read_b128 a[240:243], v27 offset:64
    ds_read_b64_tr_b16 a[244:245], v28 offset:32256
    ds_read_b64_tr_b16 a[246:247], v28 offset:34304
    s_waitcnt lgkmcnt(6)
    v_mfma_f32_32x32x16_bf16 v[32:47], a[224:227], a[228:231], 0
    ds_read_b128 a[248:251], v27 offset:96
    ds_read_b64_tr_b16 a[252:253], v28 offset:33280
    ds_read_b64_tr_b16 a[254:255], v28 offset:35328
    s_waitcnt lgkmcnt(6)
    v_mfma_f32_32x32x16_bf16 v[32:47], a[232:235], a[236:239], v[32:47]
    ds_read_b128 a[224:227], v27 offset:128
    ds_read_b64_tr_b16 a[228:229], v26 offset:61440
    ds_read_b64_tr_b16 a[230:231], v26 offset:63488
    s_waitcnt lgkmcnt(6)
    v_mfma_f32_32x32x16_bf16 v[32:47], a[240:243], a[244:247], v[32:47]
    ds_read_b128 a[232:235], v27 offset:160
    ds_read_b64_tr_b16 a[236:237], v26 offset:62464
    ds_read_b64_tr_b16 a[238:239], v26 offset:64512
    s_waitcnt lgkmcnt(6)
    v_mfma_f32_32x32x16_bf16 v[32:47], a[248:251], a[252:255], v[32:47]
    ds_read_b128 a[240:243], v27 offset:192
    ds_read_b64_tr_b16 a[244:245], v28 offset:4096
    ds_read_b64_tr_b16 a[246:247], v28 offset:6144
    s_waitcnt lgkmcnt(6)
    v_mfma_f32_32x32x16_bf16 v[32:47], a[224:227], a[228:231], v[32:47]
    ds_read_b128 a[248:251], v27 offset:224
    ds_read_b64_tr_b16 a[252:253], v28 offset:5120
    ds_read_b64_tr_b16 a[254:255], v28 offset:7168
    s_waitcnt lgkmcnt(6)
    v_mfma_f32_32x32x16_bf16 v[32:47], a[232:235], a[236:239], v[32:47]
    ds_read_b128 a[224:227], v27 offset:256
    ds_read_b64_tr_b16 a[228:229], v28 offset:12288
    ds_read_b64_tr_b16 a[230:231], v28 offset:14336
    s_waitcnt lgkmcnt(6)
    v_mfma_f32_32x32x16_bf16 v[32:47], a[240:243], a[244:247], v[32:47]
    ds_read_b128 a[232:235], v27 offset:288
    ds_read_b64_tr_b16 a[236:237], v28 offset:13312
    ds_read_b64_tr_b16 a[238:239], v28 offset:15360
    s_waitcnt lgkmcnt(6)
    v_mfma_f32_32x32x16_bf16 v[32:47], a[248:251], a[252:255], v[32:47]
    ds_read_b128 a[240:243], v27 offset:320
    ds_read_b64_tr_b16 a[244:245], v26 offset:3584
    ds_read_b64_tr_b16 a[246:247], v26 offset:5632
    s_waitcnt lgkmcnt(6)
    v_mfma_f32_32x32x16_bf16 v[32:47], a[224:227], a[228:231], v[32:47]
    ds_read_b128 a[248:251], v27 offset:352
    ds_read_b64_tr_b16 a[252:253], v26 offset:4608
    ds_read_b64_tr_b16 a[254:255], v26 offset:6656
    s_waitcnt lgkmcnt(6)
    v_mfma_f32_32x32x16_bf16 v[32:47], a[232:235], a[236:239], v[32:47]
    ds_read_b128 a[224:227], v27 offset:384
    ds_read_b64_tr_b16 a[228:229], v26 offset:11776
    ds_read_b64_tr_b16 a[230:231], v26 offset:13824
    s_waitcnt lgkmcnt(6)
    v_mfma_f32_32x32x16_bf16 v[32:47], a[240:243], a[244:247], v[32:47]
    ds_read_b128 a[232:235], v27 offset:416
    ds_read_b64_tr_b16 a[236:237], v26 offset:12800
    ds_read_b64_tr_b16 a[238:239], v26 offset:14848
    s_waitcnt lgkmcnt(6)
    v_mfma_f32_32x32x16_bf16 v[32:47], a[248:251], a[252:255], v[32:47]
    ds_read_b128 a[240:243], v27 offset:448
    ds_read_b64_tr_b16 a[244:245], v26 offset:19968
    ds_read_b64_tr_b16 a[246:247], v26 offset:22016
    s_waitcnt lgkmcnt(6)
    v_mfma_f32_32x32x16_bf16 v[32:47], a[224:227], a[228:231], v[32:47]
    ds_read_b128 a[248:251], v27 offset:480
    ds_read_b64_tr_b16 a[252:253], v26 offset:20992
    ds_read_b64_tr_b16 a[254:255], v26 offset:23040
    s_waitcnt lgkmcnt(6)
    v_mfma_f32_32x32x16_bf16 v[32:47], a[232:235], a[236:239], v[32:47]
    ds_read_b128 a[224:227], v27 offset:512
    ds_read_b64_tr_b16 a[228:229], v26 offset:28160
    ds_read_b64_tr_b16 a[230:231], v26 offset:30208
    s_waitcnt lgkmcnt(6)
    v_mfma_f32_32x32x16_bf16 v[32:47], a[240:243], a[244:247], v[32:47]
    ds_read_b128 a[232:235], v27 offset:544
    ds_read_b64_tr_b16 a[236:237], v26 offset:29184
    ds_read_b64_tr_b16 a[238:239], v26 offset:31232
    s_waitcnt lgkmcnt(6)
    v_mfma_f32_32x32x16_bf16 v[32:47], a[248:251], a[252:255], v[32:47]
    ds_read_b128 a[240:243], v27 offset:576
    ds_read_b64_tr_b16 a[244:245], v26 offset:36352
    ds_read_b64_tr_b16 a[246:247], v26 offset:38400
    s_waitcnt lgkmcnt(6)
    v_mfma_f32_32x32x16_bf16 v[32:47], a[224:227], a[228:231], v[32:47]
    ds_read_b128 a[248:251], v27 offset:608
    ds_read_b64_tr_b16 a[252:253], v26 offset:37376
    ds_read_b64_tr_b16 a[254:255], v26 offset:39424
    s_waitcnt lgkmcnt(6)
    v_mfma_f32_32x32x16_bf16 v[32:47], a[232:235], a[236:239], v[32:47]
    ds_read_b128 a[224:227], v27 offset:640
    ds_read_b64_tr_b16 a[228:229], v26 offset:44544
    ds_read_b64_tr_b16 a[230:231], v26 offset:46592
    s_waitcnt lgkmcnt(6)
    v_mfma_f32_32x32x16_bf16 v[32:47], a[240:243], a[244:247], v[32:47]
    ds_read_b128 a[232:235], v27 offset:672
    ds_read_b64_tr_b16 a[236:237], v26 offset:45568
    ds_read_b64_tr_b16 a[238:239], v26 offset:47616
    s_waitcnt lgkmcnt(6)
    v_mfma_f32_32x32x16_bf16 v[32:47], a[248:251], a[252:255], v[32:47]
    ds_read_b128 a[240:243], v27 offset:704
    ds_read_b64_tr_b16 a[244:245], v26 offset:52736
    ds_read_b64_tr_b16 a[246:247], v26 offset:54784
    s_waitcnt lgkmcnt(6)
    v_mfma_f32_32x32x16_bf16 v[32:47], a[224:227], a[228:231], v[32:47]
    ds_read_b128 a[248:251], v27 offset:736
    ds_read_b64_tr_b16 a[252:253], v26 offset:53760
    ds_read_b64_tr_b16 a[254:255], v26 offset:55808
    s_waitcnt lgkmcnt(6)
    v_mfma_f32_32x32x16_bf16 v[32:47], a[232:235], a[236:239], v[32:47]
    ds_read_b128 a[224:227], v27 offset:768
    ds_read_b64_tr_b16 a[228:229], v28 offset:40448
    ds_read_b64_tr_b16 a[230:231], v28 offset:42496
    s_waitcnt lgkmcnt(6)
    v_mfma_f32_32x32x16_bf16 v[32:47], a[240:243], a[244:247], v[32:47]
    ds_read_b128 a[232:235], v27 offset:800
    ds_read_b64_tr_b16 a[236:237], v28 offset:41472
    ds_read_b64_tr_b16 a[238:239], v28 offset:43520
    s_waitcnt lgkmcnt(6)
    v_mfma_f32_32x32x16_bf16 v[32:47], a[248:251], a[252:255], v[32:47]
    ds_read_b128 a[240:243], v27 offset:832
    ds_read_b64_tr_b16 a[244:245], v28 offset:48640
    ds_read_b64_tr_b16 a[246:247], v28 offset:50688
    s_waitcnt lgkmcnt(6)
    v_mfma_f32_32x32x16_bf16 v[32:47], a[224:227], a[228:231], v[32:47]
    ds_read_b128 a[248:251], v27 offset:864
    ds_read_b64_tr_b16 a[252:253], v28 offset:49664
    ds_read_b64_tr_b16 a[254:255], v28 offset:51712
    s_waitcnt lgkmcnt(6)
    v_mfma_f32_32x32x16_bf16 v[32:47], a[232:235], a[236:239], v[32:47]
    s_waitcnt lgkmcnt(3)
    v_mfma_f32_32x32x16_bf16 v[32:47], a[240:243], a[244:247], v[32:47]
    s_waitcnt lgkmcnt(0)
    v_mfma_f32_32x32x16_bf16 v[32:47], a[248:251], a[252:255], v[32:47]
    s_nop 11
    v_cvt_pk_bf16_f32 v4, v32, v33
    v_lshlrev_b32 v5, 16, v4
    v_and_b32 v6, 0xffff0000, v4
    v_sub_f32 v5, v32, v5
    v_sub_f32 v6, v33, v6
    v_cvt_pk_bf16_f32 v5, v5, v6
    s_mov_b32 s56, 0x05040100
    s_mov_b32 s57, 0x03020706
    v_perm_b32 v48, v5, v4, s56
    v_mov_b32 v49, v4
    v_perm_b32 v50, v5, v4, s57
    v_mov_b32 v51, 0
    v_cndmask_b32 v48, v48, 0, s[96:97]
    v_cndmask_b32 v49, v49, 0, s[96:97]
    v_cndmask_b32 v50, v50, 0, s[96:97]
    s_lshl_b32 s56, s98, 2
    s_add_u32 s56, s56, s50
    s_lshl_b32 s56, s56, 10
    s_add_u32 s56, s56, 524288
    buffer_store_dwordx4 v[48:51], v1, s[44:47], s56 offen sc1
    s_lshl_b32 s56, s98, 5
    s_add_u32 s56, s56, s50
    s_lshl_b32 s56, s56, 2
    s_add_u32 s56, s56, 24576
    s_waitcnt vmcnt(0)
    v_mov_b32 v7, s54
    s_mov_b64 exec, 1
    buffer_store_dword v7, off, s[44:47], s56 sc1
    s_mov_b64 exec, -1
    s_branch L_fin
L_helper:
    v_lshrrev_b32 v6, 3, v0
    v_and_b32 v7, 7, v0
    v_lshrrev_b32 v8, 1, v6
    v_xor_b32 v8, v8, v7
    v_mul_u32_u24 v6, 896, v6
    v_lshl_add_u32 v9, v8, 4, v6
    v_xor_b32 v8, 4, v8
    v_lshl_add_u32 v8, v8, 4, v6
    v_add_u32 v8, 7168, v8
    s_sub_u32 s91, s49, 28
    s_lshl_b32 s56, s48, 2
    s_add_u32 s91, s91, s56
    s_lshl_b32 s56, s91, 2
    s_add_u32 s56, s56, s50
    s_mul_i32 s56, s56, 14336
    s_mul_i32 s57, s50, 14336
    s_add_u32 m0, s57, 105984
    s_nop 0
    buffer_load_dwordx4 v9, s[4:7], s56 offen lds
    s_add_u32 m0, s57, 113152
    s_nop 0
    buffer_load_dwordx4 v8, s[4:7], s56 offen lds
    s_add_u32 s56, s56, 128
    s_add_u32 m0, s57, 107008
    s_nop 0
    buffer_load_dwordx4 v9, s[4:7], s56 offen lds
    s_add_u32 m0, s57, 114176
    s_nop 0
    buffer_load_dwordx4 v8, s[4:7], s56 offen lds
    s_add_u32 s56, s56, 128
    s_add_u32 m0, s57, 108032
    s_nop 0
    buffer_load_dwordx4 v9, s[4:7], s56 offen lds
    s_add_u32 m0, s57, 115200
    s_nop 0
    buffer_load_dwordx4 v8, s[4:7], s56 offen lds
    s_add_u32 s56, s56, 128
    s_add_u32 m0, s57, 109056
    s_nop 0
    buffer_load_dwordx4 v9, s[4:7], s56 offen lds
    s_add_u32 m0, s57, 116224
    s_nop 0
    buffer_load_dwordx4 v8, s[4:7], s56 offen lds
    s_add_u32 s56, s56, 128
    s_add_u32 m0, s57, 110080
    s_nop 0
    buffer_load_dwordx4 v9, s[4:7], s56 offen lds
    s_add_u32 m0, s57, 117248
    s_nop 0
    buffer_load_dwordx4 v8, s[4:7], s56 offen lds
    s_add_u32 s56, s56, 128
    s_add_u32 m0, s57, 111104
    s_nop 0
    buffer_load_dwordx4 v9, s[4:7], s56 offen lds
    s_add_u32 m0, s57, 118272
    s_nop 0
    buffer_load_dwordx4 v8, s[4:7], s56 offen lds
    s_add_u32 s56, s56, 128
    s_add_u32 m0, s57, 112128
    s_nop 0
    buffer_load_dwordx4 v9, s[4:7], s56 offen lds
    s_add_u32 m0, s57, 119296
    s_nop 0
    buffer_load_dwordx4 v8, s[4:7], s56 offen lds
    s_mul_i32 s90, s91, 57344
    s_mul_i32 s56, s50, 7168
    s_add_u32 s90, s90, s56
    s_add_u32 s90, s90, 1114112
    v_lshrrev_b32 v10, 2, v0
    v_mul_u32_u24 v10, 2688, v10
    v_and_b32 v6, 3, v0
    v_lshl_add_u32 v10, v6, 4, v10
    v_lshrrev_b32 v6, 3, v0
    v_and_b32 v7, 7, v0
    v_and_b32 v8, 2, v6
    v_lshlrev_b32 v8, 1, v8
    v_xor_b32 v8, v8, v7
    v_lshlrev_b32 v8, 4, v8
    v_mul_u32_u24 v11, 2688, v6
    v_add_u32 v11, v11, v8
    v_mul_u32_u24 v12, 3584, v6
    v_add_u32 v12, v12, v8
    v_mul_u32_u24 v13, 896, v6
    v_add_u32 v14, v13, v8
    v_and_b32 v8, 6, v6
    v_xor_b32 v8, v8, v7
    v_lshl_add_u32 v13, v8, 4, v13
    s_lshl_b32 s99, s98, 7
    s_mul_i32 s56, s50, 28672
    s_add_u32 s99, s99, s56
    s_lshl_b32 s101, s50, 10
    s_mul_i32 s92, s51, 56
    s_sub_u32 s92, s92, s3
    s_mul_i32 s56, s50, 43008
    s_add_u32 s92, s92, s56
    s_mul_i32 s56, s49, 37
    s_lshr_b32 s56, s56, 8
    s_mul_i32 s56, s56, 7
    s_sub_u32 s94, s49, s56
    v_lshrrev_b32 v4, 4, v0
    v_and_b32 v5, 15, v0
    v_lshrrev_b32 v6, 3, v5
    v_mul_u32_u24 v6, 7168, v6
    v_and_b32 v7, 7, v5
    v_lshl_add_u32 v6, v7, 7, v6
    v_add_u32 v6, 105984, v6
    v_lshrrev_b32 v7, 1, v5
    s_mul_i32 s56, s50, 14
    v_add_u32 v8, s56, v4
    v_add_u32 v9, 0, v8
    v_min_u32 v9, 55, v9
    v_lshrrev_b32 v16, 3, v9
    v_and_b32 v9, 7, v9
    v_xor_b32 v9, v9, v7
    v_lshl_add_u32 v16, v16, 10, v6
    v_lshl_add_u32 v20, v9, 4, v16
    v_add_u32 v9, 4, v8
    v_min_u32 v9, 55, v9
    v_lshrrev_b32 v16, 3, v9
    v_and_b32 v9, 7, v9
    v_xor_b32 v9, v9, v7
    v_lshl_add_u32 v16, v16, 10, v6
    v_lshl_add_u32 v21, v9, 4, v16
    v_add_u32 v9, 8, v8
    v_min_u32 v9, 55, v9
    v_lshrrev_b32 v16, 3, v9
    v_and_b32 v9, 7, v9
    v_xor_b32 v9, v9, v7
    v_lshl_add_u32 v16, v16, 10, v6
    v_lshl_add_u32 v22, v9, 4, v16
    v_add_u32 v9, 12, v8
    v_min_u32 v9, 55, v9
    v_lshrrev_b32 v16, 3, v9
    v_and_b32 v9, 7, v9
    v_xor_b32 v9, v9, v7
    v_lshl_add_u32 v16, v16, 10, v6
    v_lshl_add_u32 v23, v9, 4, v16
    s_waitcnt vmcnt(14)
    v_readfirstlane_b32 s54, v3
    s_nop 0
    s_mul_i32 s54, s54, 1664525
    s_add_u32 s54, s54, 1013904223
    s_cmp_lg_u32 s50, 3
    s_cbranch_scc1 L_noxcc_53
    s_getreg_b32 s56, hwreg(HW_REG_XCC_ID, 0, 4)
    v_mov_b32 v60, s54
    v_mov_b32 v61, s56
    s_lshl_b32 s56, s48, 5
    s_add_u32 s56, s56, s49
    s_lshl_b32 s56, s56, 7
    s_add_u32 s56, s56, 655360
    s_mov_b64 exec, 1
    buffer_store_dwordx2 v[60:61], off, s[44:47], s56 sc1
    s_mov_b64 exec, -1
L_noxcc_53:
    s_waitcnt vmcnt(0)
    s_barrier
    ds_read_b128 v[64:67], v20 offset:0
    ds_read_b128 v[68:71], v21 offset:0
    ds_read_b128 v[72:75], v22 offset:0
    ds_read_b128 v[76:79], v23 offset:0
    ds_read_b128 v[80:83], v20 offset:14336
    ds_read_b128 v[84:87], v21 offset:14336
    ds_read_b128 v[88:91], v22 offset:14336
    ds_read_b128 v[92:95], v23 offset:14336
    ds_read_b128 v[96:99], v20 offset:28672
    ds_read_b128 v[100:103], v21 offset:28672
    ds_read_b128 v[104:107], v22 offset:28672
    ds_read_b128 v[108:111], v23 offset:28672
    ds_read_b128 v[112:115], v20 offset:43008
    ds_read_b128 v[116:119], v21 offset:43008
    ds_read_b128 v[120:123], v22 offset:43008
    ds_read_b128 v[124:127], v23 offset:43008
    s_mov_b32 s88, 0x3f803f80
    s_waitcnt lgkmcnt(12)
    v_cndmask_b32 v76, v76, 0, s[96:97]
    v_cndmask_b32 v77, v77, 0, s[96:97]
    v_cndmask_b32 v78, v78, 0, s[96:97]
    v_cndmask_b32 v79, v79, 0, s[96:97]
    s_waitcnt lgkmcnt(8)
    v_cndmask_b32 v92, v92, 0, s[96:97]
    v_cndmask_b32 v93, v93, 0, s[96:97]
    v_cndmask_b32 v94, v94, 0, s[96:97]
    v_cndmask_b32 v95, v95, 0, s[96:97]
    s_waitcnt lgkmcnt(4)
    v_cndmask_b32 v108, v108, 0, s[96:97]
    v_cndmask_b32 v109, v109, 0, s[96:97]
    v_cndmask_b32 v110, v110, 0, s[96:97]
    v_cndmask_b32 v111, v111, 0, s[96:97]
    s_waitcnt lgkmcnt(0)
    v_cndmask_b32 v124, v124, 0, s[96:97]
    v_cndmask_b32 v125, v125, 0, s[96:97]
    v_cndmask_b32 v126, v126, 0, s[96:97]
    v_cndmask_b32 v127, v127, 0, s[96:97]
    v_dot2_f32_bf16 v24, v64, s88, 0
    v_dot2_f32_bf16 v25, v80, s88, 0
    v_dot2_f32_bf16 v26, v96, s88, 0
    v_dot2_f32_bf16 v27, v112, s88, 0
    v_dot2_f32_bf16 v28, v64, v64, 0
    v_dot2_f32_bf16 v29, v80, v80, 0
    v_dot2_f32_bf16 v30, v96, v96, 0
    v_dot2_f32_bf16 v31, v112, v112, 0
    v_dot2_f32_bf16 v24, v65, s88, v24
    v_dot2_f32_bf16 v25, v81, s88, v25
    v_dot2_f32_bf16 v26, v97, s88, v26
    v_dot2_f32_bf16 v27, v113, s88, v27
    v_dot2_f32_bf16 v28, v65, v65, v28
    v_dot2_f32_bf16 v29, v81, v81, v29
    v_dot2_f32_bf16 v30, v97, v97, v30
    v_dot2_f32_bf16 v31, v113, v113, v31
    v_dot2_f32_bf16 v24, v66, s88, v24
    v_dot2_f32_bf16 v25, v82, s88, v25
    v_dot2_f32_bf16 v26, v98, s88, v26
    v_dot2_f32_bf16 v27, v114, s88, v27
    v_dot2_f32_bf16 v28, v66, v66, v28
    v_dot2_f32_bf16 v29, v82, v82, v29
    v_dot2_f32_bf16 v30, v98, v98, v30
    v_dot2_f32_bf16 v31, v114, v114, v31
    v_dot2_f32_bf16 v24, v67, s88, v24
    v_dot2_f32_bf16 v25, v83, s88, v25
    v_dot2_f32_bf16 v26, v99, s88, v26
    v_dot2_f32_bf16 v27, v115, s88, v27
    v_dot2_f32_bf16 v28, v67, v67, v28
    v_dot2_f32_bf16 v29, v83, v83, v29
    v_dot2_f32_bf16 v30, v99, v99, v30
    v_dot2_f32_bf16 v31, v115, v115, v31
    v_dot2_f32_bf16 v24, v68, s88, v24
    v_dot2_f32_bf16 v25, v84, s88, v25
    v_dot2_f32_bf16 v26, v100, s88, v26
    v_dot2_f32_bf16 v27, v116, s88, v27
    v_dot2_f32_bf16 v28, v68, v68, v28
    v_dot2_f32_bf16 v29, v84, v84, v29
    v_dot2_f32_bf16 v30, v100, v100, v30
    v_dot2_f32_bf16 v31, v116, v116, v31
    v_dot2_f32_bf16 v24, v69, s88, v24
    v_dot2_f32_bf16 v25, v85, s88, v25
    v_dot2_f32_bf16 v26, v101, s88, v26
    v_dot2_f32_bf16 v27, v117, s88, v27
    v_dot2_f32_bf16 v28, v69, v69, v28
    v_dot2_f32_bf16 v29, v85, v85, v29
    v_dot2_f32_bf16 v30, v101, v101, v30
    v_dot2_f32_bf16 v31, v117, v117, v31
    v_dot2_f32_bf16 v24, v70, s88, v24
    v_dot2_f32_bf16 v25, v86, s88, v25
    v_dot2_f32_bf16 v26, v102, s88, v26
    v_dot2_f32_bf16 v27, v118, s88, v27
    v_dot2_f32_bf16 v28, v70, v70, v28
    v_dot2_f32_bf16 v29, v86, v86, v29
    v_dot2_f32_bf16 v30, v102, v102, v30
    v_dot2_f32_bf16 v31, v118, v118, v31
    v_dot2_f32_bf16 v24, v71, s88, v24
    v_dot2_f32_bf16 v25, v87, s88, v25
    v_dot2_f32_bf16 v26, v103, s88, v26
    v_dot2_f32_bf16 v27, v119, s88, v27
    v_dot2_f32_bf16 v28, v71, v71, v28
    v_dot2_f32_bf16 v29, v87, v87, v29
    v_dot2_f32_bf16 v30, v103, v103, v30
    v_dot2_f32_bf16 v31, v119, v119, v31
    v_dot2_f32_bf16 v24, v72, s88, v24
    v_dot2_f32_bf16 v25, v88, s88, v25
    v_dot2_f32_bf16 v26, v104, s88, v26
    v_dot2_f32_bf16 v27, v120, s88, v27
    v_dot2_f32_bf16 v28, v72, v72, v28
    v_dot2_f32_bf16 v29, v88, v88, v29
    v_dot2_f32_bf16 v30, v104, v104, v30
    v_dot2_f32_bf16 v31, v120, v120, v31
    v_dot2_f32_bf16 v24, v73, s88, v24
    v_dot2_f32_bf16 v25, v89, s88, v25
    v_dot2_f32_bf16 v26, v105, s88, v26
    v_dot2_f32_bf16 v27, v121, s88, v27
    v_dot2_f32_bf16 v28, v73, v73, v28
    v_dot2_f32_bf16 v29, v89, v89, v29
    v_dot2_f32_bf16 v30, v105, v105, v30
    v_dot2_f32_bf16 v31, v121, v121, v31
    v_dot2_f32_bf16 v24, v74, s88, v24
    v_dot2_f32_bf16 v25, v90, s88, v25
    v_dot2_f32_bf16 v26, v106, s88, v26
    v_dot2_f32_bf16 v27, v122, s88, v27
    v_dot2_f32_bf16 v28, v74, v74, v28
    v_dot2_f32_bf16 v29, v90, v90, v29
    v_dot2_f32_bf16 v30, v106, v106, v30
    v_dot2_f32_bf16 v31, v122, v122, v31
    v_dot2_f32_bf16 v24, v75, s88, v24
    v_dot2_f32_bf16 v25, v91, s88, v25
    v_dot2_f32_bf16 v26, v107, s88, v26
    v_dot2_f32_bf16 v27, v123, s88, v27
    v_dot2_f32_bf16 v28, v75, v75, v28
    v_dot2_f32_bf16 v29, v91, v91, v29
    v_dot2_f32_bf16 v30, v107, v107, v30
    v_dot2_f32_bf16 v31, v123, v123, v31
    v_dot2_f32_bf16 v24, v76, s88, v24
    v_dot2_f32_bf16 v25, v92, s88, v25
    v_dot2_f32_bf16 v26, v108, s88, v26
    v_dot2_f32_bf16 v27, v124, s88, v27
    v_dot2_f32_bf16 v28, v76, v76, v28
    v_dot2_f32_bf16 v29, v92, v92, v29
    v_dot2_f32_bf16 v30, v108, v108, v30
    v_dot2_f32_bf16 v31, v124, v124, v31
    v_dot2_f32_bf16 v24, v77, s88, v24
    v_dot2_f32_bf16 v25, v93, s88, v25
    v_dot2_f32_bf16 v26, v109, s88, v26
    v_dot2_f32_bf16 v27, v125, s88, v27
    v_dot2_f32_bf16 v28, v77, v77, v28
    v_dot2_f32_bf16 v29, v93, v93, v29
    v_dot2_f32_bf16 v30, v109, v109, v30
    v_dot2_f32_bf16 v31, v125, v125, v31
    v_dot2_f32_bf16 v24, v78, s88, v24
    v_dot2_f32_bf16 v25, v94, s88, v25
    v_dot2_f32_bf16 v26, v110, s88, v26
    v_dot2_f32_bf16 v27, v126, s88, v27
    v_dot2_f32_bf16 v28, v78, v78, v28
    v_dot2_f32_bf16 v29, v94, v94, v29
    v_dot2_f32_bf16 v30, v110, v110, v30
    v_dot2_f32_bf16 v31, v126, v126, v31
    v_dot2_f32_bf16 v24, v79, s88, v24
    v_dot2_f32_bf16 v25, v95, s88, v25
    v_dot2_f32_bf16 v26, v111, s88, v26
    v_dot2_f32_bf16 v27, v127, s88, v27
    v_dot2_f32_bf16 v28, v79, v79, v28
    v_dot2_f32_bf16 v29, v95, v95, v29
    v_dot2_f32_bf16 v30, v111, v111, v30
    v_dot2_f32_bf16 v31, v127, v127, v31
    s_nop 2
    v_permlane16_swap_b32 v24, v25
    v_permlane16_swap_b32 v26, v27
    v_permlane16_swap_b32 v28, v29
    v_permlane16_swap_b32 v30, v31
    v_add_f32 v24, v24, v25
    v_add_f32 v26, v26, v27
    v_add_f32 v28, v28, v29
    v_add_f32 v30, v30, v31
    v_permlane32_swap_b32 v24, v26
    s_nop 0
    v_permlane32_swap_b32 v28, v30
    v_add_f32 v24, v24, v26
    v_add_f32 v25, v28, v30
    s_lshl_b32 s56, s50, 9
    s_add_u32 s56, s56, 89600
    v_lshlrev_b32 v16, 3, v0
    v_add_u32 v17, s56, v16
    v_add_u32 v16, 89600, v16
    ds_write_b64 v17, v[24:25]
    v_lshrrev_b32 v8, 2, v0
    v_min_u32 v8, 13, v8
    s_mul_i32 s56, s50, 14
    v_add_u32 v8, s56, v8
    v_bfe_u32 v9, v0, 1, 1
    v_lshl_add_u32 v8, v8, 1, v9
    v_and_b32 v9, 1, v0
    v_mul_u32_u24 v6, 112, v9
    v_add_u32 v8, v8, v6
    v_lshlrev_b32 v8, 4, v8
    s_waitcnt lgkmcnt(0)
    s_barrier
    ds_read_b64 v[24:25], v16 offset:0
    ds_read_b64 v[26:27], v16 offset:512
    ds_read_b64 v[28:29], v16 offset:1024
    ds_read_b64 v[30:31], v16 offset:1536
    v_lshlrev_b32 v128, 16, v64
    v_and_b32 v129, 0xffff0000, v64
    v_lshlrev_b32 v130, 16, v65
    v_and_b32 v131, 0xffff0000, v65
    v_lshlrev_b32 v132, 16, v66
    v_and_b32 v133, 0xffff0000, v66
    v_lshlrev_b32 v134, 16, v67
    v_and_b32 v135, 0xffff0000, v67
    v_lshlrev_b32 v136, 16, v68
    v_and_b32 v137, 0xffff0000, v68
    v_lshlrev_b32 v138, 16, v69
    v_and_b32 v139, 0xffff0000, v69
    v_lshlrev_b32 v140, 16, v70
    v_and_b32 v141, 0xffff0000, v70
    v_lshlrev_b32 v142, 16, v71
    v_and_b32 v143, 0xffff0000, v71
    v_lshlrev_b32 v144, 16, v72
    v_and_b32 v145, 0xffff0000, v72
    v_lshlrev_b32 v146, 16, v73
    v_and_b32 v147, 0xffff0000, v73
    v_lshlrev_b32 v148, 16, v74
    v_and_b32 v149, 0xffff0000, v74
    v_lshlrev_b32 v150, 16, v75
    v_and_b32 v151, 0xffff0000, v75
    v_lshlrev_b32 v152, 16, v76
    v_and_b32 v153, 0xffff0000, v76
    v_lshlrev_b32 v154, 16, v77
    v_and_b32 v155, 0xffff0000, v77
    v_lshlrev_b32 v156, 16, v78
    v_and_b32 v157, 0xffff0000, v78
    v_lshlrev_b32 v158, 16, v79
    v_and_b32 v159, 0xffff0000, v79
    s_waitcnt lgkmcnt(0)
    v_pk_add_f32 v[24:25], v[24:25], v[26:27]
    v_pk_add_f32 v[28:29], v[28:29], v[30:31]
    v_pk_add_f32 v[24:25], v[24:25], v[28:29]
    v_mul_f32 v24, 0x3b124925, v24
    v_mul_f32 v25, 0x3b124925, v25
    v_fma_f32 v25, -v24, v24, v25
    v_max_f32 v25, 0, v25
    v_cvt_pk_bf16_f32 v26, v24, v25
    v_lshlrev_b32 v24, 16, v26
    v_and_b32 v25, 0xffff0000, v26
    v_add_f32 v25, 0x3727c5ac, v25
    v_cvt_pk_bf16_f32 v25, v25, v25
    v_lshlrev_b32 v25, 16, v25
    v_sqrt_f32 v25, v25
    s_nop 0
    v_cvt_pk_bf16_f32 v25, v25, v25
    v_lshlrev_b32 v25, 16, v25
    v_rcp_f32 v26, v25
    s_nop 0
    v_mul_f32 v27, -v24, v26
    v_add_u32 v17, 2048, v17
    ds_write_b64 v17, v[26:27]
    s_lshl_b32 s56, s50, 9
    s_add_u32 s56, s56, 91648
    v_lshl_add_u32 v16, v5, 3, s56
    ds_read_b64 v[32:33], v16 offset:0
    ds_read_b64 v[34:35], v16 offset:128
    ds_read_b64 v[36:37], v16 offset:256
    ds_read_b64 v[38:39], v16 offset:384
    v_lshlrev_b32 v160, 16, v80
    v_and_b32 v161, 0xffff0000, v80
    v_lshlrev_b32 v162, 16, v81
    v_and_b32 v163, 0xffff0000, v81
    v_lshlrev_b32 v164, 16, v82
    v_and_b32 v165, 0xffff0000, v82
    v_lshlrev_b32 v166, 16, v83
    v_and_b32 v167, 0xffff0000, v83
    v_lshlrev_b32 v168, 16, v84
    v_and_b32 v169, 0xffff0000, v84
    v_lshlrev_b32 v170, 16, v85
    v_and_b32 v171, 0xffff0000, v85
    v_lshlrev_b32 v172, 16, v86
    v_and_b32 v173, 0xffff0000, v86
    v_lshlrev_b32 v174, 16, v87
    v_and_b32 v175, 0xffff0000, v87
    v_lshlrev_b32 v176, 16, v88
    v_and_b32 v177, 0xffff0000, v88
    v_lshlrev_b32 v178, 16, v89
    v_and_b32 v179, 0xffff0000, v89
    v_lshlrev_b32 v180, 16, v90
    v_and_b32 v181, 0xffff0000, v90
    v_lshlrev_b32 v182, 16, v91
    v_and_b32 v183, 0xffff0000, v91
    v_lshlrev_b32 v184, 16, v92
    v_and_b32 v185, 0xffff0000, v92
    v_lshlrev_b32 v186, 16, v93
    v_and_b32 v187, 0xffff0000, v93
    v_lshlrev_b32 v188, 16, v94
    v_and_b32 v189, 0xffff0000, v94
    v_lshlrev_b32 v190, 16, v95
    v_and_b32 v191, 0xffff0000, v95
    v_and_b32 v62, 31, v0
    v_lshlrev_b32 v62, 7, v62
    s_lshl_b32 s95, s48, 12
    s_add_u32 s95, s95, 655360
    buffer_load_dwordx2 v[60:61], v62, s[44:47], s95 offen sc1
    s_mov_b32 s56, 65536
    buffer_load_dwordx4 v[40:43], v8, s[44:47], s56 offen sc1
    s_mov_b32 s56, 76288
    buffer_load_dwordx4 v[44:47], v8, s[44:47], s56 offen sc1
    s_mov_b32 s56, 87040
    buffer_load_dwordx4 v[48:51], v8, s[44:47], s56 offen sc1
    s_mov_b32 s56, 97792
    buffer_load_dwordx4 v[52:55], v8, s[44:47], s56 offen sc1
    v_lshlrev_b32 v192, 16, v96
    v_and_b32 v193, 0xffff0000, v96
    v_lshlrev_b32 v194, 16, v97
    v_and_b32 v195, 0xffff0000, v97
    v_lshlrev_b32 v196, 16, v98
    v_and_b32 v197, 0xffff0000, v98
    v_lshlrev_b32 v198, 16, v99
    v_and_b32 v199, 0xffff0000, v99
    v_lshlrev_b32 v200, 16, v100
    v_and_b32 v201, 0xffff0000, v100
    v_lshlrev_b32 v202, 16, v101
    v_and_b32 v203, 0xffff0000, v101
    v_lshlrev_b32 v204, 16, v102
    v_and_b32 v205, 0xffff0000, v102
    v_lshlrev_b32 v206, 16, v103
    v_and_b32 v207, 0xffff0000, v103
    v_lshlrev_b32 v208, 16, v104
    v_and_b32 v209, 0xffff0000, v104
    v_lshlrev_b32 v210, 16, v105
    v_and_b32 v211, 0xffff0000, v105
    v_lshlrev_b32 v212, 16, v106
    v_and_b32 v213, 0xffff0000, v106
    v_lshlrev_b32 v214, 16, v107
    v_and_b32 v215, 0xffff0000, v107
    v_lshlrev_b32 v216, 16, v108
    v_and_b32 v217, 0xffff0000, v108
    v_lshlrev_b32 v218, 16, v109
    v_and_b32 v219, 0xffff0000, v109
    v_lshlrev_b32 v220, 16, v110
    v_and_b32 v221, 0xffff0000, v110
    v_lshlrev_b32 v222, 16, v111
    v_and_b32 v223, 0xffff0000, v111
    v_lshlrev_b32 v224, 16, v112
    v_and_b32 v225, 0xffff0000, v112
    v_lshlrev_b32 v226, 16, v113
    v_and_b32 v227, 0xffff0000, v113
    v_lshlrev_b32 v228, 16, v114
    v_and_b32 v229, 0xffff0000, v114
    v_lshlrev_b32 v230, 16, v115
    v_and_b32 v231, 0xffff0000, v115
    v_lshlrev_b32 v232, 16, v116
    v_and_b32 v233, 0xffff0000, v116
    v_lshlrev_b32 v234, 16, v117
    v_and_b32 v235, 0xffff0000, v117
    v_lshlrev_b32 v236, 16, v118
    v_and_b32 v237, 0xffff0000, v118
    v_lshlrev_b32 v238, 16, v119
    v_and_b32 v239, 0xffff0000, v119
    v_lshlrev_b32 v240, 16, v120
    v_and_b32 v241, 0xffff0000, v120
    v_lshlrev_b32 v242, 16, v121
    v_and_b32 v243, 0xffff0000, v121
    v_lshlrev_b32 v244, 16, v122
    v_and_b32 v245, 0xffff0000, v122
    v_lshlrev_b32 v246, 16, v123
    v_and_b32 v247, 0xffff0000, v123
    v_lshlrev_b32 v248, 16, v124
    v_and_b32 v249, 0xffff0000, v124
    v_lshlrev_b32 v250, 16, v125
    v_and_b32 v251, 0xffff0000, v125
    v_lshlrev_b32 v252, 16, v126
    v_and_b32 v253, 0xffff0000, v126
    v_lshlrev_b32 v254, 16, v127
    v_and_b32 v255, 0xffff0000, v127
    s_waitcnt lgkmcnt(0)
    v_pk_fma_f32 v[128:129], v[128:129], v[32:33], v[32:33] op_sel:[0,0,1] op_sel_hi:[1,0,1]
    v_pk_fma_f32 v[130:131], v[130:131], v[32:33], v[32:33] op_sel:[0,0,1] op_sel_hi:[1,0,1]
    v_pk_fma_f32 v[132:133], v[132:133], v[32:33], v[32:33] op_sel:[0,0,1] op_sel_hi:[1,0,1]
    v_pk_fma_f32 v[134:135], v[134:135], v[32:33], v[32:33] op_sel:[0,0,1] op_sel_hi:[1,0,1]
    v_pk_fma_f32 v[136:137], v[136:137], v[32:33], v[32:33] op_sel:[0,0,1] op_sel_hi:[1,0,1]
    v_pk_fma_f32 v[138:139], v[138:139], v[32:33], v[32:33] op_sel:[0,0,1] op_sel_hi:[1,0,1]
    v_pk_fma_f32 v[140:141], v[140:141], v[32:33], v[32:33] op_sel:[0,0,1] op_sel_hi:[1,0,1]
    v_pk_fma_f32 v[142:143], v[142:143], v[32:33], v[32:33] op_sel:[0,0,1] op_sel_hi:[1,0,1]
    v_pk_fma_f32 v[144:145], v[144:145], v[32:33], v[32:33] op_sel:[0,0,1] op_sel_hi:[1,0,1]
    v_pk_fma_f32 v[146:147], v[146:147], v[32:33], v[32:33] op_sel:[0,0,1] op_sel_hi:[1,0,1]
    v_pk_fma_f32 v[148:149], v[148:149], v[32:33], v[32:33] op_sel:[0,0,1] op_sel_hi:[1,0,1]
    v_pk_fma_f32 v[150:151], v[150:151], v[32:33], v[32:33] op_sel:[0,0,1] op_sel_hi:[1,0,1]
    v_pk_fma_f32 v[152:153], v[152:153], v[32:33], v[32:33] op_sel:[0,0,1] op_sel_hi:[1,0,1]
    v_pk_fma_f32 v[154:155], v[154:155], v[32:33], v[32:33] op_sel:[0,0,1] op_sel_hi:[1,0,1]
    v_pk_fma_f32 v[156:157], v[156:157], v[32:33], v[32:33] op_sel:[0,0,1] op_sel_hi:[1,0,1]
    v_pk_fma_f32 v[158:159], v[158:159], v[32:33], v[32:33] op_sel:[0,0,1] op_sel_hi:[1,0,1]
    v_pk_fma_f32 v[160:161], v[160:161], v[34:35], v[34:35] op_sel:[0,0,1] op_sel_hi:[1,0,1]
    v_pk_fma_f32 v[162:163], v[162:163], v[34:35], v[34:35] op_sel:[0,0,1] op_sel_hi:[1,0,1]
    v_pk_fma_f32 v[164:165], v[164:165], v[34:35], v[34:35] op_sel:[0,0,1] op_sel_hi:[1,0,1]
    v_pk_fma_f32 v[166:167], v[166:167], v[34:35], v[34:35] op_sel:[0,0,1] op_sel_hi:[1,0,1]
    v_pk_fma_f32 v[168:169], v[168:169], v[34:35], v[34:35] op_sel:[0,0,1] op_sel_hi:[1,0,1]
    v_pk_fma_f32 v[170:171], v[170:171], v[34:35], v[34:35] op_sel:[0,0,1] op_sel_hi:[1,0,1]
    v_pk_fma_f32 v[172:173], v[172:173], v[34:35], v[34:35] op_sel:[0,0,1] op_sel_hi:[1,0,1]
    v_pk_fma_f32 v[174:175], v[174:175], v[34:35], v[34:35] op_sel:[0,0,1] op_sel_hi:[1,0,1]
    v_pk_fma_f32 v[176:177], v[176:177], v[34:35], v[34:35] op_sel:[0,0,1] op_sel_hi:[1,0,1]
    v_pk_fma_f32 v[178:179], v[178:179], v[34:35], v[34:35] op_sel:[0,0,1] op_sel_hi:[1,0,1]
    v_pk_fma_f32 v[180:181], v[180:181], v[34:35], v[34:35] op_sel:[0,0,1] op_sel_hi:[1,0,1]
    v_pk_fma_f32 v[182:183], v[182:183], v[34:35], v[34:35] op_sel:[0,0,1] op_sel_hi:[1,0,1]
    v_pk_fma_f32 v[184:185], v[184:185], v[34:35], v[34:35] op_sel:[0,0,1] op_sel_hi:[1,0,1]
    v_pk_fma_f32 v[186:187], v[186:187], v[34:35], v[34:35] op_sel:[0,0,1] op_sel_hi:[1,0,1]
    v_pk_fma_f32 v[188:189], v[188:189], v[34:35], v[34:35] op_sel:[0,0,1] op_sel_hi:[1,0,1]
    v_pk_fma_f32 v[190:191], v[190:191], v[34:35], v[34:35] op_sel:[0,0,1] op_sel_hi:[1,0,1]
    v_pk_fma_f32 v[192:193], v[192:193], v[36:37], v[36:37] op_sel:[0,0,1] op_sel_hi:[1,0,1]
    v_pk_fma_f32 v[194:195], v[194:195], v[36:37], v[36:37] op_sel:[0,0,1] op_sel_hi:[1,0,1]
    v_pk_fma_f32 v[196:197], v[196:197], v[36:37], v[36:37] op_sel:[0,0,1] op_sel_hi:[1,0,1]
    v_pk_fma_f32 v[198:199], v[198:199], v[36:37], v[36:37] op_sel:[0,0,1] op_sel_hi:[1,0,1]
    v_pk_fma_f32 v[200:201], v[200:201], v[36:37], v[36:37] op_sel:[0,0,1] op_sel_hi:[1,0,1]
    v_pk_fma_f32 v[202:203], v[202:203], v[36:37], v[36:37] op_sel:[0,0,1] op_sel_hi:[1,0,1]
    v_pk_fma_f32 v[204:205], v[204:205], v[36:37], v[36:37] op_sel:[0,0,1] op_sel_hi:[1,0,1]
    v_pk_fma_f32 v[206:207], v[206:207], v[36:37], v[36:37] op_sel:[0,0,1] op_sel_hi:[1,0,1]
    v_pk_fma_f32 v[208:209], v[208:209], v[36:37], v[36:37] op_sel:[0,0,1] op_sel_hi:[1,0,1]
    v_pk_fma_f32 v[210:211], v[210:211], v[36:37], v[36:37] op_sel:[0,0,1] op_sel_hi:[1,0,1]
    v_pk_fma_f32 v[212:213], v[212:213], v[36:37], v[36:37] op_sel:[0,0,1] op_sel_hi:[1,0,1]
    v_pk_fma_f32 v[214:215], v[214:215], v[36:37], v[36:37] op_sel:[0,0,1] op_sel_hi:[1,0,1]
    v_pk_fma_f32 v[216:217], v[216:217], v[36:37], v[36:37] op_sel:[0,0,1] op_sel_hi:[1,0,1]
    v_pk_fma_f32 v[218:219], v[218:219], v[36:37], v[36:37] op_sel:[0,0,1] op_sel_hi:[1,0,1]
    v_pk_fma_f32 v[220:221], v[220:221], v[36:37], v[36:37] op_sel:[0,0,1] op_sel_hi:[1,0,1]
    v_pk_fma_f32 v[222:223], v[222:223], v[36:37], v[36:37] op_sel:[0,0,1] op_sel_hi:[1,0,1]
    v_pk_fma_f32 v[224:225], v[224:225], v[38:39], v[38:39] op_sel:[0,0,1] op_sel_hi:[1,0,1]
    v_pk_fma_f32 v[226:227], v[226:227], v[38:39], v[38:39] op_sel:[0,0,1] op_sel_hi:[1,0,1]
    v_pk_fma_f32 v[228:229], v[228:229], v[38:39], v[38:39] op_sel:[0,0,1] op_sel_hi:[1,0,1]
    v_pk_fma_f32 v[230:231], v[230:231], v[38:39], v[38:39] op_sel:[0,0,1] op_sel_hi:[1,0,1]
    v_pk_fma_f32 v[232:233], v[232:233], v[38:39], v[38:39] op_sel:[0,0,1] op_sel_hi:[1,0,1]
    v_pk_fma_f32 v[234:235], v[234:235], v[38:39], v[38:39] op_sel:[0,0,1] op_sel_hi:[1,0,1]
    v_pk_fma_f32 v[236:237], v[236:237], v[38:39], v[38:39] op_sel:[0,0,1] op_sel_hi:[1,0,1]
    v_pk_fma_f32 v[238:239], v[238:239], v[38:39], v[38:39] op_sel:[0,0,1] op_sel_hi:[1,0,1]
    v_pk_fma_f32 v[240:241], v[240:241], v[38:39], v[38:39] op_sel:[0,0,1] op_sel_hi:[1,0,1]
    v_pk_fma_f32 v[242:243], v[242:243], v[38:39], v[38:39] op_sel:[0,0,1] op_sel_hi:[1,0,1]
    v_pk_fma_f32 v[244:245], v[244:245], v[38:39], v[38:39] op_sel:[0,0,1] op_sel_hi:[1,0,1]
    v_pk_fma_f32 v[246:247], v[246:247], v[38:39], v[38:39] op_sel:[0,0,1] op_sel_hi:[1,0,1]
    v_pk_fma_f32 v[248:249], v[248:249], v[38:39], v[38:39] op_sel:[0,0,1] op_sel_hi:[1,0,1]
    v_pk_fma_f32 v[250:251], v[250:251], v[38:39], v[38:39] op_sel:[0,0,1] op_sel_hi:[1,0,1]
    v_pk_fma_f32 v[252:253], v[252:253], v[38:39], v[38:39] op_sel:[0,0,1] op_sel_hi:[1,0,1]
    v_pk_fma_f32 v[254:255], v[254:255], v[38:39], v[38:39] op_sel:[0,0,1] op_sel_hi:[1,0,1]
    v_cvt_f32_u32 v9, v9
    s_lshl_b32 s56, s50, 11
    s_add_u32 s56, s56, 97792
    v_add_u32 v6, s56, v1
    v_lshl_add_u32 v7, v4, 6, s56
    s_mov_b32 s63, 0
    s_mov_b32 s59, 0x0c0c0400
    s_mov_b32 s60, 0x04000c0c
    s_waitcnt vmcnt(0)
L_gath_54:
    v_perm_b32 v16, v41, v40, s59
    v_perm_b32 v17, v43, v42, s60
    v_or_b32 v16, v16, v17
    v_xor_b32 v18, s54, v16
    v_perm_b32 v16, v45, v44, s59
    v_perm_b32 v17, v47, v46, s60
    v_or_b32 v16, v16, v17
    v_xor_b32 v19, s54, v16
    v_perm_b32 v16, v49, v48, s59
    v_perm_b32 v17, v51, v50, s60
    v_or_b32 v16, v16, v17
    v_xor_b32 v20, s54, v16
    v_perm_b32 v16, v53, v52, s59
    v_perm_b32 v17, v55, v54, s60
    v_or_b32 v16, v16, v17
    v_xor_b32 v21, s54, v16
    v_or3_b32 v16, v18, v19, v20
    v_or_b32 v16, v16, v21
    v_cmp_ne_u32 vcc, 0, v16
    s_cbranch_vccz L_gathd_55
    s_mov_b32 s56, 65536
    buffer_load_dwordx4 v[40:43], v8, s[44:47], s56 offen sc1
    s_mov_b32 s56, 76288
    buffer_load_dwordx4 v[44:47], v8, s[44:47], s56 offen sc1
    s_mov_b32 s56, 87040
    buffer_load_dwordx4 v[48:51], v8, s[44:47], s56 offen sc1
    s_mov_b32 s56, 97792
    buffer_load_dwordx4 v[52:55], v8, s[44:47], s56 offen sc1
    s_add_u32 s63, s63, 1
    s_cmp_ge_u32 s63, 131072
    s_waitcnt vmcnt(0)
    s_cbranch_scc0 L_gath_54
L_gathd_55:
    v_and_b32 v40, 0xffffff00, v40
    v_and_b32 v41, 0xffffff00, v41
    v_and_b32 v42, 0xffffff00, v42
    v_and_b32 v43, 0xffffff00, v43
    v_and_b32 v44, 0xffffff00, v44
    v_and_b32 v45, 0xffffff00, v45
    v_and_b32 v46, 0xffffff00, v46
    v_and_b32 v47, 0xffffff00, v47
    v_and_b32 v48, 0xffffff00, v48
    v_and_b32 v49, 0xffffff00, v49
    v_and_b32 v50, 0xffffff00, v50
    v_and_b32 v51, 0xffffff00, v51
    v_and_b32 v52, 0xffffff00, v52
    v_and_b32 v53, 0xffffff00, v53
    v_and_b32 v54, 0xffffff00, v54
    v_and_b32 v55, 0xffffff00, v55
    v_add_f32 v40, v40, v44
    v_add_f32 v48, v48, v52
    v_add_f32 v41, v41, v45
    v_add_f32 v49, v49, v53
    v_add_f32 v42, v42, v46
    v_add_f32 v50, v50, v54
    v_add_f32 v43, v43, v47
    v_add_f32 v51, v51, v55
    v_add_f32 v40, v40, v48
    v_add_f32 v41, v41, v49
    v_add_f32 v42, v42, v50
    v_add_f32 v43, v43, v51
    v_cvt_pk_bf16_f32 v16, v40, v41
    v_lshlrev_b32 v40, 16, v16
    v_and_b32 v41, 0xffff0000, v16
    v_cvt_pk_bf16_f32 v16, v42, v43
    v_lshlrev_b32 v42, 16, v16
    v_and_b32 v43, 0xffff0000, v16
    v_add_f32 v40, v40, v9
    v_add_f32 v41, v41, v9
    v_add_f32 v42, v42, v9
    v_add_f32 v43, v43, v9
    v_cvt_pk_bf16_f32 v16, v40, v41
    v_lshlrev_b32 v40, 16, v16
    v_and_b32 v41, 0xffff0000, v16
    v_cvt_pk_bf16_f32 v16, v42, v43
    v_lshlrev_b32 v42, 16, v16
    v_and_b32 v43, 0xffff0000, v16
    ds_write_b128 v6, v[40:43]
    ds_read_b128 v[64:67], v7 offset:0
    ds_read_b128 v[68:71], v7 offset:16
    ds_read_b128 v[72:75], v7 offset:32
    ds_read_b128 v[76:79], v7 offset:48
    ds_read_b128 v[80:83], v7 offset:256
    ds_read_b128 v[84:87], v7 offset:272
    ds_read_b128 v[88:91], v7 offset:288
    ds_read_b128 v[92:95], v7 offset:304
    ds_read_b128 v[96:99], v7 offset:512
    ds_read_b128 v[100:103], v7 offset:528
    ds_read_b128 v[104:107], v7 offset:544
    ds_read_b128 v[108:111], v7 offset:560
    ds_read_b128 v[112:115], v7 offset:768
    ds_read_b128 v[116:119], v7 offset:784
    ds_read_b128 v[120:123], v7 offset:800
    ds_read_b128 v[124:127], v7 offset:816
    v_lshlrev_b32 v8, 4, v5
    v_lshl_add_u32 v8, v4, 9, v8
    v_add_u32 v9, 4096, v8
    v_mov_b32 v16, 0x7ffffff0
    v_cndmask_b32 v6, v9, v16, s[96:97]
    s_mov_b32 s63, 0
L_xcc_56:
    v_cmp_ne_u32 vcc, s54, v60
    s_cbranch_vccz L_xccd_57
    buffer_load_dwordx2 v[60:61], v62, s[44:47], s95 offen sc1
    s_add_u32 s63, s63, 1
    s_cmp_ge_u32 s63, 131072
    s_waitcnt vmcnt(0)
    s_cbranch_scc0 L_xcc_56
L_xccd_57:
    s_getreg_b32 s56, hwreg(HW_REG_XCC_ID, 0, 4)
    v_cmp_ne_u32 vcc, s56, v61
    s_nop 0
    s_cmp_eq_u64 vcc, 0
    s_cselect_b32 s55, 1, 0
    s_lshl_b32 s93, s91, 7
    s_lshl_b32 s58, s50, 2
    s_add_u32 s93, s93, s58
    s_add_u32 s93, s93, 4096
    s_waitcnt lgkmcnt(12)
    v_pk_fma_f32 v[128:129], v[128:129], v[68:69], v[64:65]
    v_pk_fma_f32 v[130:131], v[130:131], v[70:71], v[66:67]
    v_pk_fma_f32 v[132:133], v[132:133], v[76:77], v[72:73]
    v_pk_fma_f32 v[134:135], v[134:135], v[78:79], v[74:75]
    v_cvt_pk_bf16_f32 v24, v128, v129
    v_cvt_pk_bf16_f32 v25, v130, v131
    v_cvt_pk_bf16_f32 v26, v132, v133
    v_cvt_pk_bf16_f32 v27, v134, v135
    buffer_store_dwordx4 v[24:27], v8, s[44:47], s90 offen offset:0
    s_waitcnt lgkmcnt(8)
    v_pk_fma_f32 v[136:137], v[136:137], v[84:85], v[80:81]
    v_pk_fma_f32 v[138:139], v[138:139], v[86:87], v[82:83]
    v_pk_fma_f32 v[140:141], v[140:141], v[92:93], v[88:89]
    v_pk_fma_f32 v[142:143], v[142:143], v[94:95], v[90:91]
    v_cvt_pk_bf16_f32 v28, v136, v137
    v_cvt_pk_bf16_f32 v29, v138, v139
    v_cvt_pk_bf16_f32 v30, v140, v141
    v_cvt_pk_bf16_f32 v31, v142, v143
    buffer_store_dwordx4 v[28:31], v8, s[44:47], s90 offen offset:2048
    s_waitcnt lgkmcnt(4)
    v_pk_fma_f32 v[144:145], v[144:145], v[100:101], v[96:97]
    v_pk_fma_f32 v[146:147], v[146:147], v[102:103], v[98:99]
    v_pk_fma_f32 v[148:149], v[148:149], v[108:109], v[104:105]
    v_pk_fma_f32 v[150:151], v[150:151], v[110:111], v[106:107]
    v_cvt_pk_bf16_f32 v32, v144, v145
    v_cvt_pk_bf16_f32 v33, v146, v147
    v_cvt_pk_bf16_f32 v34, v148, v149
    v_cvt_pk_bf16_f32 v35, v150, v151
    buffer_store_dwordx4 v[32:35], v9, s[44:47], s90 offen offset:0
    s_waitcnt lgkmcnt(0)
    v_pk_fma_f32 v[152:153], v[152:153], v[116:117], v[112:113]
    v_pk_fma_f32 v[154:155], v[154:155], v[118:119], v[114:115]
    v_pk_fma_f32 v[156:157], v[156:157], v[124:125], v[120:121]
    v_pk_fma_f32 v[158:159], v[158:159], v[126:127], v[122:123]
    v_cvt_pk_bf16_f32 v36, v152, v153
    v_cvt_pk_bf16_f32 v37, v154, v155
    v_cvt_pk_bf16_f32 v38, v156, v157
    v_cvt_pk_bf16_f32 v39, v158, v159
    buffer_store_dwordx4 v[36:39], v6, s[44:47], s90 offen offset:2048
    s_add_u32 s90, s90, 256
    v_pk_fma_f32 v[160:161], v[160:161], v[68:69], v[64:65]
    v_pk_fma_f32 v[162:163], v[162:163], v[70:71], v[66:67]
    v_pk_fma_f32 v[164:165], v[164:165], v[76:77], v[72:73]
    v_pk_fma_f32 v[166:167], v[166:167], v[78:79], v[74:75]
    v_cvt_pk_bf16_f32 v40, v160, v161
    v_cvt_pk_bf16_f32 v41, v162, v163
    v_cvt_pk_bf16_f32 v42, v164, v165
    v_cvt_pk_bf16_f32 v43, v166, v167
    buffer_store_dwordx4 v[40:43], v8, s[44:47], s90 offen offset:0
    v_pk_fma_f32 v[168:169], v[168:169], v[84:85], v[80:81]
    v_pk_fma_f32 v[170:171], v[170:171], v[86:87], v[82:83]
    v_pk_fma_f32 v[172:173], v[172:173], v[92:93], v[88:89]
    v_pk_fma_f32 v[174:175], v[174:175], v[94:95], v[90:91]
    v_cvt_pk_bf16_f32 v44, v168, v169
    v_cvt_pk_bf16_f32 v45, v170, v171
    v_cvt_pk_bf16_f32 v46, v172, v173
    v_cvt_pk_bf16_f32 v47, v174, v175
    buffer_store_dwordx4 v[44:47], v8, s[44:47], s90 offen offset:2048
    v_pk_fma_f32 v[176:177], v[176:177], v[100:101], v[96:97]
    v_pk_fma_f32 v[178:179], v[178:179], v[102:103], v[98:99]
    v_pk_fma_f32 v[180:181], v[180:181], v[108:109], v[104:105]
    v_pk_fma_f32 v[182:183], v[182:183], v[110:111], v[106:107]
    v_cvt_pk_bf16_f32 v48, v176, v177
    v_cvt_pk_bf16_f32 v49, v178, v179
    v_cvt_pk_bf16_f32 v50, v180, v181
    v_cvt_pk_bf16_f32 v51, v182, v183
    buffer_store_dwordx4 v[48:51], v9, s[44:47], s90 offen offset:0
    v_pk_fma_f32 v[184:185], v[184:185], v[116:117], v[112:113]
    v_pk_fma_f32 v[186:187], v[186:187], v[118:119], v[114:115]
    v_pk_fma_f32 v[188:189], v[188:189], v[124:125], v[120:121]
    v_pk_fma_f32 v[190:191], v[190:191], v[126:127], v[122:123]
    v_cvt_pk_bf16_f32 v52, v184, v185
    v_cvt_pk_bf16_f32 v53, v186, v187
    v_cvt_pk_bf16_f32 v54, v188, v189
    v_cvt_pk_bf16_f32 v55, v190, v191
    buffer_store_dwordx4 v[52:55], v6, s[44:47], s90 offen offset:2048
    s_add_u32 s90, s90, 28416
    v_pk_fma_f32 v[192:193], v[192:193], v[68:69], v[64:65]
    v_pk_fma_f32 v[194:195], v[194:195], v[70:71], v[66:67]
    v_pk_fma_f32 v[196:197], v[196:197], v[76:77], v[72:73]
    v_pk_fma_f32 v[198:199], v[198:199], v[78:79], v[74:75]
    v_cvt_pk_bf16_f32 v24, v192, v193
    v_cvt_pk_bf16_f32 v25, v194, v195
    v_cvt_pk_bf16_f32 v26, v196, v197
    v_cvt_pk_bf16_f32 v27, v198, v199
    buffer_store_dwordx4 v[24:27], v8, s[44:47], s90 offen offset:0
    v_pk_fma_f32 v[200:201], v[200:201], v[84:85], v[80:81]
    v_pk_fma_f32 v[202:203], v[202:203], v[86:87], v[82:83]
    v_pk_fma_f32 v[204:205], v[204:205], v[92:93], v[88:89]
    v_pk_fma_f32 v[206:207], v[206:207], v[94:95], v[90:91]
    v_cvt_pk_bf16_f32 v28, v200, v201
    v_cvt_pk_bf16_f32 v29, v202, v203
    v_cvt_pk_bf16_f32 v30, v204, v205
    v_cvt_pk_bf16_f32 v31, v206, v207
    buffer_store_dwordx4 v[28:31], v8, s[44:47], s90 offen offset:2048
    v_pk_fma_f32 v[208:209], v[208:209], v[100:101], v[96:97]
    v_pk_fma_f32 v[210:211], v[210:211], v[102:103], v[98:99]
    v_pk_fma_f32 v[212:213], v[212:213], v[108:109], v[104:105]
    v_pk_fma_f32 v[214:215], v[214:215], v[110:111], v[106:107]
    v_cvt_pk_bf16_f32 v32, v208, v209
    v_cvt_pk_bf16_f32 v33, v210, v211
    v_cvt_pk_bf16_f32 v34, v212, v213
    v_cvt_pk_bf16_f32 v35, v214, v215
    buffer_store_dwordx4 v[32:35], v9, s[44:47], s90 offen offset:0
    v_pk_fma_f32 v[216:217], v[216:217], v[116:117], v[112:113]
    v_pk_fma_f32 v[218:219], v[218:219], v[118:119], v[114:115]
    v_pk_fma_f32 v[220:221], v[220:221], v[124:125], v[120:121]
    v_pk_fma_f32 v[222:223], v[222:223], v[126:127], v[122:123]
    v_cvt_pk_bf16_f32 v36, v216, v217
    v_cvt_pk_bf16_f32 v37, v218, v219
    v_cvt_pk_bf16_f32 v38, v220, v221
    v_cvt_pk_bf16_f32 v39, v222, v223
    buffer_store_dwordx4 v[36:39], v6, s[44:47], s90 offen offset:2048
    s_add_u32 s90, s90, 256
    v_pk_fma_f32 v[224:225], v[224:225], v[68:69], v[64:65]
    v_pk_fma_f32 v[226:227], v[226:227], v[70:71], v[66:67]
    v_pk_fma_f32 v[228:229], v[228:229], v[76:77], v[72:73]
    v_pk_fma_f32 v[230:231], v[230:231], v[78:79], v[74:75]
    v_cvt_pk_bf16_f32 v40, v224, v225
    v_cvt_pk_bf16_f32 v41, v226, v227
    v_cvt_pk_bf16_f32 v42, v228, v229
    v_cvt_pk_bf16_f32 v43, v230, v231
    buffer_store_dwordx4 v[40:43], v8, s[44:47], s90 offen offset:0
    v_pk_fma_f32 v[232:233], v[232:233], v[84:85], v[80:81]
    v_pk_fma_f32 v[234:235], v[234:235], v[86:87], v[82:83]
    v_pk_fma_f32 v[236:237], v[236:237], v[92:93], v[88:89]
    v_pk_fma_f32 v[238:239], v[238:239], v[94:95], v[90:91]
    v_cvt_pk_bf16_f32 v44, v232, v233
    v_cvt_pk_bf16_f32 v45, v234, v235
    v_cvt_pk_bf16_f32 v46, v236, v237
    v_cvt_pk_bf16_f32 v47, v238, v239
    buffer_store_dwordx4 v[44:47], v8, s[44:47], s90 offen offset:2048
    v_pk_fma_f32 v[240:241], v[240:241], v[100:101], v[96:97]
    v_pk_fma_f32 v[242:243], v[242:243], v[102:103], v[98:99]
    v_pk_fma_f32 v[244:245], v[244:245], v[108:109], v[104:105]
    v_pk_fma_f32 v[246:247], v[246:247], v[110:111], v[106:107]
    v_cvt_pk_bf16_f32 v48, v240, v241
    v_cvt_pk_bf16_f32 v49, v242, v243
    v_cvt_pk_bf16_f32 v50, v244, v245
    v_cvt_pk_bf16_f32 v51, v246, v247
    buffer_store_dwordx4 v[48:51], v9, s[44:47], s90 offen offset:0
    v_pk_fma_f32 v[248:249], v[248:249], v[116:117], v[112:113]
    v_pk_fma_f32 v[250:251], v[250:251], v[118:119], v[114:115]
    v_pk_fma_f32 v[252:253], v[252:253], v[124:125], v[120:121]
    v_pk_fma_f32 v[254:255], v[254:255], v[126:127], v[122:123]
    v_cvt_pk_bf16_f32 v52, v248, v249
    v_cvt_pk_bf16_f32 v53, v250, v251
    v_cvt_pk_bf16_f32 v54, v252, v253
    v_cvt_pk_bf16_f32 v55, v254, v255
    buffer_store_dwordx4 v[52:55], v6, s[44:47], s90 offen offset:2048
    s_waitcnt vmcnt(0)
    v_mov_b32 v7, s54
    s_cmp_lg_u32 s55, 0
    s_cbranch_scc0 L_slowpub_58
    s_mov_b64 exec, 1
    buffer_store_dword v7, off, s[44:47], s93
    buffer_store_dword v7, off, s[44:47], s93 offset:64
    s_branch L_pub_59
L_slowpub_58:
    buffer_wbl2 sc1
    s_waitcnt vmcnt(0)
    s_mov_b64 exec, 1
    buffer_store_dword v7, off, s[44:47], s93 sc1
    buffer_store_dword v7, off, s[44:47], s93 offset:64 sc1
L_pub_59:
    s_mov_b64 exec, -1
    s_mul_i32 s56, s94, 172032
    s_add_u32 s56, s56, s92
    s_lshl_b32 s57, s94, 12
    s_add_u32 s57, s57, s101
    s_add_u32 m0, s57, 60928
    s_add_u32 s94, s94, 1
    buffer_load_dwordx4 v10, s[8:11], s56 offen lds
    s_cmp_eq_u32 s94, 7
    s_cselect_b32 s94, 0, s94
    s_mul_i32 s56, s94, 172032
    s_add_u32 s56, s56, s92
    s_lshl_b32 s57, s94, 12
    s_add_u32 s57, s57, s101
    s_add_u32 m0, s57, 60928
    s_add_u32 s94, s94, 1
    buffer_load_dwordx4 v10, s[8:11], s56 offen lds
    s_cmp_eq_u32 s94, 7
    s_cselect_b32 s94, 0, s94
    s_mul_i32 s56, s94, 172032
    s_add_u32 s56, s56, s92
    s_lshl_b32 s57, s94, 12
    s_add_u32 s57, s57, s101
    s_add_u32 m0, s57, 60928
    s_add_u32 s94, s94, 1
    buffer_load_dwordx4 v10, s[8:11], s56 offen lds
    s_cmp_eq_u32 s94, 7
    s_cselect_b32 s94, 0, s94
    s_mul_i32 s56, s94, 172032
    s_add_u32 s56, s56, s92
    s_lshl_b32 s57, s94, 12
    s_add_u32 s57, s57, s101
    s_add_u32 m0, s57, 60928
    s_add_u32 s94, s94, 1
    buffer_load_dwordx4 v10, s[8:11], s56 offen lds
    s_cmp_eq_u32 s94, 7
    s_cselect_b32 s94, 0, s94
    s_mul_i32 s56, s94, 172032
    s_add_u32 s56, s56, s92
    s_lshl_b32 s57, s94, 12
    s_add_u32 s57, s57, s101
    s_add_u32 m0, s57, 60928
    s_add_u32 s94, s94, 1
    buffer_load_dwordx4 v10, s[8:11], s56 offen lds
    s_cmp_eq_u32 s94, 7
    s_cselect_b32 s94, 0, s94
    s_mul_i32 s56, s94, 172032
    s_add_u32 s56, s56, s92
    s_lshl_b32 s57, s94, 12
    s_add_u32 s57, s57, s101
    s_add_u32 m0, s57, 60928
    s_add_u32 s94, s94, 1
    buffer_load_dwordx4 v10, s[8:11], s56 offen lds
    s_cmp_eq_u32 s94, 7
    s_cselect_b32 s94, 0, s94
    s_mul_i32 s56, s94, 172032
    s_add_u32 s56, s56, s92
    s_lshl_b32 s57, s94, 12
    s_add_u32 s57, s57, s101
    s_add_u32 m0, s57, 60928
    s_add_u32 s94, s94, 1
    buffer_load_dwordx4 v10, s[8:11], s56 offen lds
    s_cmp_eq_u32 s94, 7
    s_cselect_b32 s94, 0, s94
    s_waitcnt vmcnt(0)
    s_branch L_p1
L_fin:
L_end:
    s_endpgm
.section .rodata,"a"
.p2align 6
.amdhsa_kernel adaLN_cond__sliding_block__glu_gated_reglu__prompt_kernel
  .amdhsa_next_free_vgpr 512
  .amdhsa_next_free_sgpr 102
  .amdhsa_accum_offset 256
  .amdhsa_group_segment_fixed_size 0
  .amdhsa_kernarg_size 96
  .amdhsa_user_sgpr_count 2
  .amdhsa_user_sgpr_kernarg_segment_ptr 1
  .amdhsa_system_sgpr_workgroup_id_x 1
  .amdhsa_float_denorm_mode_32 3
.end_amdhsa_kernel
```
